```python
import torch

def _softmax(x, axis=-1):
    return torch.softmax(x, dim=axis)
def _gelu(x):
    return torch.nn.functional.gelu(x, approximate="tanh")
def _silu(x):
    return torch.nn.functional.silu(x)
def _sigmoid(x):
    return torch.sigmoid(x)
def _layernorm(x, axis=-1, eps=1e-5):
    m = x.mean(dim=axis, keepdim=True)
    v = x.var(dim=axis, keepdim=True, unbiased=False)
    return (x - m) / torch.sqrt(v + eps)
def _scatter_add(tgt, idx, src, axis=0):
    return tgt.clone().index_add_(axis, idx, src)
def _segment_sum(src, seg, n):
    out = torch.zeros((n,) + src.shape[1:], dtype=src.dtype)
    return out.index_add_(0, seg, src)
def _pad(x, pw):
    flat = tuple(v for pair in reversed(pw) for v in pair)
    return torch.nn.functional.pad(x, flat)

kernel_name = 'recurrent_scan__linear_attn_block__mixer_channel_mlp__prompt'

def setup_inputs():

    _w = (lambda a: (lambda t: t.to(torch.bfloat16) if t.is_floating_point() else t)(torch.as_tensor(a)))
    def _A_setup():
        B, S, D = 1, 2048, 640
        return {
            "x": _w((lambda *s: torch.randn(*s, dtype=torch.bfloat16) * 0.05)(B, S, D)),
            "wqkv": _w((lambda *s: torch.randn(*s, dtype=torch.bfloat16) * 0.2)(D, 3 * D)),
            "wo": _w((lambda *s: torch.randn(*s, dtype=torch.bfloat16) * 0.2)(D, D)),
        }
    _A_in = _A_setup()

    def _B_setup():
        B, S, D, F = 1, 2048, 640, 1536
        return {
            "x": _w((lambda *s: torch.randn(*s, dtype=torch.bfloat16) * 0.05)(B, S, D)),
            "w1": _w((lambda *s: torch.randn(*s, dtype=torch.bfloat16) * 0.8)(D, F) * (D ** -0.5)),
            "b1": _w((lambda *s: torch.randn(*s, dtype=torch.bfloat16) * 0.8)(F)),
            "w2": _w((lambda *s: torch.randn(*s, dtype=torch.bfloat16) * 0.1)(F, D) * (F ** -0.5)),
            "b2": _w((lambda *s: torch.randn(*s, dtype=torch.bfloat16) * 0.1)(D)),
        }
    _B_in = _B_setup()

    return {
        "A_x": _A_in["x"],
        "A_wqkv": _A_in["wqkv"],
        "A_wo": _A_in["wo"],
        "B_x": _B_in["x"],
        "B_w1": _B_in["w1"],
        "B_b1": _B_in["b1"],
        "B_w2": _B_in["w2"],
        "B_b2": _B_in["b2"],
    }

def reference(A_x, A_wqkv, A_wo, B_x, B_w1, B_b1, B_w2, B_b2):
    def _A_ref(x, wqkv, wo):
        B, S, D = x.shape
        H = 32; Dh = D // H
        qkv = (lambda x, *d: x.permute(*d))((x @ wqkv).reshape(B, S, 3, H, Dh), 2, 0, 3, 1, 4)
        q, k, v = qkv[0], qkv[1], qkv[2]
        phi = lambda t: torch.where(t > 0, t + 1, torch.exp(t)) + 1e-6
        pq, pk = phi(q), phi(k)
        kv = torch.einsum("bhsd,bhse->bhde", pk, v)
        z = torch.einsum("bhsd->bhd", pk)
        num = torch.einsum("bhqd,bhde->bhqe", pq, kv)
        den = torch.einsum("bhqd,bhd->bhq", pq, z)[..., None] + 1e-6
        o = num / den
        return (lambda x, *d: x.permute(*d))(o, 0, 2, 1, 3).reshape(B, S, D) @ wo

    def _B_ref(x, w1, b1, w2, b2):
        y = _layernorm(x, axis=-1)
        h = _gelu(torch.einsum("bsd,df->bsf", y, w1) + b1)
        return torch.einsum("bsf,fd->bsd", h, w2) + b2

    x = A_x
    xn = _layernorm(x, axis=-1)
    s = _A_ref(xn, A_wqkv, A_wo)
    g = _silu(_B_ref(xn, B_w1, B_b1, B_w2, B_b2))
    return x + s * g
```

```asm
; @launch grid=(256,1,1) block=(256,1,1) lds=163840
.amdgcn_target "amdgcn-amd-amdhsa--gfx950"
.text
.globl recurrent_scan__linear_attn_block__mixer_channel_mlp__prompt_kernel
.p2align 8
.type recurrent_scan__linear_attn_block__mixer_channel_mlp__prompt_kernel,@function
recurrent_scan__linear_attn_block__mixer_channel_mlp__prompt_kernel:
  s_cmp_ge_u32 s2, 256
  s_cbranch_scc1 LEND
  s_load_dwordx16 s[4:19], s[0:1], 0
  s_load_dwordx4 s[20:23], s[0:1], 64
  s_load_dwordx2 s[24:25], s[0:1], 80
  s_getpc_b64 s[26:27]
  s_lshr_b32 s69, s2, 3
  v_lshrrev_b32 v2, 6, v0
  v_and_b32 v1, 63, v0
  s_lshl_b32 s70, s69, 2
  v_readfirstlane_b32 s56, v2
  v_add_u32 v2, s70, v2
  v_min_u32 v3, 3, v1
  v_mad_u32_u24 v2, v2, 4, v3
  v_min_u32 v2, 402, v2
  v_lshlrev_b32 v2, 7, v2
  global_load_dword v127, v2, s[26:27]
  s_bfe_u32 s59, s2, 65536
  s_bfe_u32 s60, s2, 131073
  s_and_b32 s61, s69, 15
  s_and_b32 s70, s61, 7
  s_lshl_b32 s57, s59, 3
  s_add_u32 s57, s57, s70
  s_lshr_b32 s70, s61, 3
  s_lshl_b32 s58, s60, 1
  s_add_u32 s58, s58, s70
  s_mov_b32 s26, s2
  s_lshr_b32 s70, s69, 3
  v_lshrrev_b32 v4, 3, v1
  v_lshrrev_b32 v5, 4, v1
  v_and_b32 v6, 7, v1
  s_lshl_b32 s71, s56, 5
  v_add_u32 v4, s71, v4
  v_mul_u32_u24 v4, 1280, v4
  v_xor_b32 v7, v6, v5
  s_lshl_b32 s71, s56, 12
  s_add_u32 s72, s70, 0
  s_and_b32 s72, s72, 3
  s_lshl_b32 s73, s72, 2
  s_and_b32 s73, s73, 4
  v_xor_b32 v6, s73, v7
  s_mul_i32 s73, s72, 10240
  v_lshl_add_u32 v6, v6, 4, v4
  s_lshl_b32 s72, s72, 10
  v_add_u32 v20, s73, v6
  s_add_u32 s81, s71, s72
  s_add_u32 s72, s70, 1
  s_and_b32 s72, s72, 3
  s_lshl_b32 s73, s72, 2
  s_and_b32 s73, s73, 4
  v_xor_b32 v6, s73, v7
  s_mul_i32 s73, s72, 10240
  v_lshl_add_u32 v6, v6, 4, v4
  s_lshl_b32 s72, s72, 10
  v_add_u32 v21, s73, v6
  s_add_u32 s83, s71, s72
  s_add_u32 s72, s70, 2
  s_and_b32 s72, s72, 3
  s_lshl_b32 s73, s72, 2
  s_and_b32 s73, s73, 4
  v_xor_b32 v6, s73, v7
  s_mul_i32 s73, s72, 10240
  v_lshl_add_u32 v6, v6, 4, v4
  s_lshl_b32 s72, s72, 10
  v_add_u32 v22, s73, v6
  s_add_u32 s87, s71, s72
  s_add_u32 s72, s70, 3
  s_and_b32 s72, s72, 3
  s_lshl_b32 s73, s72, 2
  s_and_b32 s73, s73, 4
  v_xor_b32 v6, s73, v7
  s_mul_i32 s73, s72, 10240
  v_lshl_add_u32 v6, v6, 4, v4
  s_lshl_b32 s72, s72, 10
  v_add_u32 v23, s73, v6
  s_add_u32 s89, s71, s72
  s_lshl_b32 s71, s59, 0
  s_xor_b32 s99, s60, s71
  s_and_b32 s100, s99, 1
  s_mul_i32 s93, s57, 163840
  s_and_b32 s68, s61, 7
  v_lshlrev_b32 v2, 21, v1
  s_mov_b32 s30, 2621440
  s_mov_b32 s31, 0x20000
  s_mov_b32 s34, 1966080
  s_mov_b32 s35, 0x20000
  s_cmp_ge_u32 s69, 16
  s_waitcnt lgkmcnt(0)
  s_mov_b32 s28, s4
  s_mov_b32 s29, s5
  s_cselect_b32 s32, s12, s6
  s_cselect_b32 s33, s13, s7
  s_cselect_b32 s34, s34, 2457600
  s_cbranch_scc1 LH
  v_lshrrev_b32 v4, 5, v1
  v_and_b32 v5, 31, v1
  s_lshl_b32 s70, s56, 4
  v_add_u32 v6, s70, v4
  v_mul_u32_u24 v6, 3840, v6
  s_mul_i32 s70, s58, 160
  v_add_u32 v6, s70, v6
  v_lshlrev_b32 v7, 2, v4
  v_sub_u32 v11, v5, v7
  s_and_b32 s71, s68, 1
  s_lshl_b32 s71, s71, 3
  s_and_b32 s74, s58, 1
  s_lshl_b32 s74, s74, 1
  v_subrev_u32 v7, s71, v11
  v_and_b32 v7, 31, v7
  v_subrev_u32 v9, s74, v7
  v_add_u32 v8, s74, v7
  v_min_i32 v10, 21, v9
  v_max_i32 v10, 12, v10
  v_cmp_gt_u32 vcc, 24, v7
  v_add_u32 v10, 148, v10
  v_subrev_u32 v5, 24, v8
  v_cndmask_b32 v5, v5, v10, vcc
  v_cmp_gt_u32 vcc, 10, v9
  v_add_u32 v10, 80, v9
  v_subrev_u32 v8, 2, v8
  v_cndmask_b32 v8, v8, v10, vcc
  v_cmp_gt_u32 vcc, 12, v7
  s_xor_b32 s71, s71, 8
  s_nop 0
  v_cndmask_b32 v8, v5, v8, vcc
  v_lshl_add_u32 v12, v8, 4, v6
  v_subrev_u32 v7, s71, v11
  v_and_b32 v7, 31, v7
  v_subrev_u32 v9, s74, v7
  v_add_u32 v8, s74, v7
  v_min_i32 v10, 21, v9
  v_max_i32 v10, 12, v10
  v_cmp_gt_u32 vcc, 24, v7
  v_add_u32 v10, 148, v10
  v_subrev_u32 v5, 24, v8
  v_cndmask_b32 v5, v5, v10, vcc
  v_cmp_gt_u32 vcc, 10, v9
  v_add_u32 v10, 80, v9
  v_subrev_u32 v8, 2, v8
  v_cndmask_b32 v8, v8, v10, vcc
  v_cmp_gt_u32 vcc, 12, v7
  s_xor_b32 s71, s71, 8
  s_nop 0
  v_cndmask_b32 v8, v5, v8, vcc
  v_lshl_add_u32 v13, v8, 4, v6
  s_lshl_b32 s70, s56, 13
  s_add_u32 s70, s70, 16384
  s_mov_b32 s94, 0
  s_mov_b32 s36, s24
  s_mov_b32 s37, s25
  s_mov_b32 s38, 0xb00000
  s_mov_b32 s39, 0x20000
  s_mov_b32 s0, s22
  s_mov_b32 s1, s23
  s_mov_b32 s2, 0x100
  s_mov_b32 s3, 0x20000
  s_add_u32 s72, s68, 0
  s_and_b32 s72, s72, 7
  s_mul_i32 s73, s72, 7680
  s_lshl_b32 s72, s72, 10
  v_add_u32 v24, s73, v12
  s_add_u32 s91, s70, s72
  s_add_u32 s72, s68, 1
  s_and_b32 s72, s72, 7
  s_mul_i32 s73, s72, 7680
  s_lshl_b32 s72, s72, 10
  v_add_u32 v25, s73, v13
  s_add_u32 s101, s70, s72
  s_add_u32 s72, s68, 2
  s_and_b32 s72, s72, 7
  s_mul_i32 s73, s72, 7680
  s_lshl_b32 s72, s72, 10
  v_add_u32 v26, s73, v12
  s_add_u32 s22, s70, s72
  s_add_u32 s72, s68, 3
  s_and_b32 s72, s72, 7
  s_mul_i32 s73, s72, 7680
  s_lshl_b32 s72, s72, 10
  v_add_u32 v27, s73, v13
  s_add_u32 s23, s70, s72
  s_add_u32 s72, s68, 4
  s_and_b32 s72, s72, 7
  s_mul_i32 s73, s72, 7680
  s_lshl_b32 s72, s72, 10
  v_add_u32 v28, s73, v12
  s_add_u32 s24, s70, s72
  s_add_u32 s72, s68, 5
  s_and_b32 s72, s72, 7
  s_mul_i32 s73, s72, 7680
  s_lshl_b32 s72, s72, 10
  v_add_u32 v29, s73, v13
  s_add_u32 s25, s70, s72
  s_add_u32 s72, s68, 6
  s_and_b32 s72, s72, 7
  s_mul_i32 s73, s72, 7680
  s_lshl_b32 s72, s72, 10
  v_add_u32 v36, s73, v12
  s_add_u32 s66, s70, s72
  s_add_u32 s72, s68, 7
  s_and_b32 s72, s72, 7
  s_mul_i32 s73, s72, 7680
  s_lshl_b32 s72, s72, 10
  v_add_u32 v37, s73, v13
  s_add_u32 s67, s70, s72
  s_xor_b32 s98, 0, s99
  s_mul_i32 s65, s98, 245760
  s_add_u32 m0, s91, 0
  s_add_u32 s65, s65, s94
  buffer_load_dwordx4 v24, s[32:35], s65 offen  lds
  s_lshl_b32 s64, s98, 7
  s_add_u32 m0, s81, 0
  s_add_u32 s64, s64, s93
  buffer_load_dwordx4 v20, s[28:31], s64 offen  lds
  s_add_u32 m0, s101, 0
  s_nop 0
  buffer_load_dwordx4 v25, s[32:35], s65 offen  lds
  s_add_u32 m0, s22, 0
  s_nop 0
  buffer_load_dwordx4 v26, s[32:35], s65 offen  lds
  s_add_u32 m0, s83, 0
  s_nop 0
  buffer_load_dwordx4 v21, s[28:31], s64 offen  lds
  s_add_u32 m0, s23, 0
  s_nop 0
  buffer_load_dwordx4 v27, s[32:35], s65 offen  lds
  s_add_u32 m0, s24, 0
  s_nop 0
  buffer_load_dwordx4 v28, s[32:35], s65 offen  lds
  s_add_u32 m0, s87, 0
  s_nop 0
  buffer_load_dwordx4 v22, s[28:31], s64 offen  lds
  s_add_u32 m0, s25, 0
  s_nop 0
  buffer_load_dwordx4 v29, s[32:35], s65 offen  lds
  s_add_u32 m0, s66, 0
  s_nop 0
  buffer_load_dwordx4 v36, s[32:35], s65 offen  lds
  s_add_u32 m0, s89, 0
  s_nop 0
  buffer_load_dwordx4 v23, s[28:31], s64 offen  lds
  s_add_u32 m0, s67, 0
  s_nop 0
  buffer_load_dwordx4 v37, s[32:35], s65 offen  lds
  v_mov_b32 v125, 1
  v_and_b32 v30, 31, v1
  v_lshrrev_b32 v31, 5, v1
  v_bfe_u32 v40, v1, 1, 3
  v_xor_b32 v40, v40, v31
  v_lshlrev_b32 v30, 7, v30
  s_and_b32 s78, s56, 1
  s_lshr_b32 s77, s56, 1
  s_cmp_eq_u32 s56, 0
  s_cselect_b32 s53, 1, 0
  s_cselect_b32 s54, 0, 0x40000000
  v_xor_b32 v41, 0, v40
  v_lshl_add_u32 v2, v41, 4, v30
  v_xor_b32 v41, 2, v40
  v_lshl_add_u32 v3, v41, 4, v30
  v_xor_b32 v41, 4, v40
  v_lshl_add_u32 v4, v41, 4, v30
  v_xor_b32 v41, 6, v40
  v_lshl_add_u32 v5, v41, 4, v30
  v_lshrrev_b32 v40, 4, v1
  v_bfe_u32 v41, v1, 2, 2
  v_and_b32 v42, 3, v1
  v_and_b32 v43, 1, v40
  v_lshl_add_u32 v44, v31, 3, v41
  v_lshl_add_u32 v45, v43, 2, v42
  s_mul_i32 s70, s56, 5
  s_and_b32 s71, s58, 1
  s_lshl_b32 s71, s71, 2
  s_add_u32 s72, s70, s71
  s_sub_u32 s73, s70, s71
  v_add_u32 v30, s73, v45
  v_add_u32 v30, -5, v30
  v_cmp_gt_u32 vcc, 16, v30
  v_add_u32 v46, 4, v30
  v_add_u32 v30, 48, v30
  v_cndmask_b32 v46, v46, v30, vcc
  v_add_u32 v30, s73, v45
  v_add_u32 v30, 3, v30
  v_cmp_gt_u32 vcc, 16, v30
  v_add_u32 v47, 4, v30
  v_add_u32 v30, 48, v30
  v_cndmask_b32 v47, v47, v30, vcc
  v_add_u32 v30, s72, v45
  v_cmp_gt_u32 vcc, 5, v45
  v_add_u32 v63, 22, v30
  s_nop 0
  v_cndmask_b32 v46, v46, v30, vcc
  v_cmp_lt_u32 vcc, 1, v45
  v_subrev_u32 v30, 1, v30
  s_nop 0
  v_cndmask_b32 v47, v47, v63, vcc
  v_cmp_eq_u32 vcc, 7, v45
  v_lshl_add_u32 v46, v41, 3, v46
  v_and_b32 v46, 63, v46
  v_cndmask_b32 v47, v47, v30, vcc
  v_lshlrev_b32 v46, 3, v46
  v_lshl_add_u32 v47, v41, 3, v47
  v_and_b32 v47, 63, v47
  v_lshlrev_b32 v47, 3, v47
  v_lshl_add_u32 v46, v44, 9, v46
  v_lshl_add_u32 v47, v44, 9, v47
  v_add_u32 v14, 16384, v46
  v_add_u32 v15, 16384, v47
  v_and_b32 v30, 15, v1
  v_cmp_eq_u32 vcc, v30, v43
  v_mov_b32 v46, 0x3f803f80
  s_nop 0
  v_cndmask_b32 v46, 0, v46, vcc
  v_accvgpr_write_b32 a232, v46
  v_accvgpr_write_b32 a233, v46
  v_accvgpr_write_b32 a234, v46
  v_accvgpr_write_b32 a235, v46
  v_lshrrev_b32 v46, 2, v30
  v_cmp_eq_u32 vcc, v46, v31
  v_mov_b32 v46, 0x3f803f80
  v_and_b32 v47, 2, v1
  v_cndmask_b32 v46, 0, v46, vcc
  v_cmp_eq_u32 vcc, 0, v47
  v_and_b32 v30, 1, v1
  v_mul_u32_u24 v115, 0xaaaa, v30
  v_cndmask_b32 v47, 0, v46, vcc
  v_cndmask_b32 v46, v46, 0, vcc
  v_add_u32 v115, 0x4444, v115
  v_accvgpr_write_b32 a236, v47
  v_accvgpr_write_b32 a220, 0
  v_accvgpr_write_b32 a237, v47
  v_accvgpr_write_b32 a221, 0
  v_accvgpr_write_b32 a238, v46
  v_accvgpr_write_b32 a222, 0
  v_accvgpr_write_b32 a239, v46
  v_accvgpr_write_b32 a223, 0
  s_mov_b32 s40, s16
  s_mov_b32 s41, s17
  s_mov_b32 s42, 0x1e0000
  s_mov_b32 s43, 0x20000
  s_mov_b32 s44, s8
  s_mov_b32 s45, s9
  s_mov_b32 s46, 0xc8000
  s_mov_b32 s47, 0x20000
  s_mov_b32 s48, s20
  s_mov_b32 s49, s21
  s_mov_b32 s50, 0x280000
  s_mov_b32 s51, 0x20000
  v_add_u32 v6, 49152, v2
  v_add_u32 v7, 49152, v3
  v_add_u32 v8, 49152, v4
  v_add_u32 v9, 49152, v5
  v_add_u32 v16, 49152, v14
  v_add_u32 v17, 49152, v15
  v_add_u32 v10, 98304, v2
  v_add_u32 v11, 98304, v3
  v_add_u32 v12, 98304, v4
  v_add_u32 v13, 98304, v5
  v_add_u32 v18, 98304, v14
  v_add_u32 v19, 98304, v15
  s_xor_b32 s98, 1, s99
  s_mul_i32 s65, s98, 245760
  s_add_u32 m0, s91, 49152
  s_add_u32 s65, s65, s94
  buffer_load_dwordx4 v24, s[32:35], s65 offen  lds
  s_lshl_b32 s64, s98, 7
  s_add_u32 m0, s81, 49152
  s_add_u32 s64, s64, s93
  buffer_load_dwordx4 v20, s[28:31], s64 offen  lds
  s_add_u32 m0, s101, 49152
  s_nop 0
  buffer_load_dwordx4 v25, s[32:35], s65 offen  lds
  s_add_u32 m0, s22, 49152
  s_nop 0
  buffer_load_dwordx4 v26, s[32:35], s65 offen  lds
  s_add_u32 m0, s83, 49152
  s_nop 0
  buffer_load_dwordx4 v21, s[28:31], s64 offen  lds
  s_add_u32 m0, s23, 49152
  s_nop 0
  buffer_load_dwordx4 v27, s[32:35], s65 offen  lds
  s_add_u32 m0, s24, 49152
  s_nop 0
  buffer_load_dwordx4 v28, s[32:35], s65 offen  lds
  s_add_u32 m0, s87, 49152
  s_nop 0
  buffer_load_dwordx4 v22, s[28:31], s64 offen  lds
  s_add_u32 m0, s25, 49152
  s_nop 0
  buffer_load_dwordx4 v29, s[32:35], s65 offen  lds
  s_add_u32 m0, s66, 49152
  s_nop 0
  buffer_load_dwordx4 v36, s[32:35], s65 offen  lds
  s_add_u32 m0, s89, 49152
  s_nop 0
  buffer_load_dwordx4 v23, s[28:31], s64 offen  lds
  s_add_u32 m0, s67, 49152
  s_nop 0
  buffer_load_dwordx4 v37, s[32:35], s65 offen  lds
  s_branch LQmain
LH:
  s_mul_i32 s70, s56, 49152
  s_mul_i32 s71, s58, 384
  s_add_u32 s94, s70, s71
  s_mul_i32 s68, s68, 6
  s_lshr_b32 s68, s68, 3
  s_mul_i32 s70, s56, 6144
  s_add_u32 s70, s70, 16384
  s_mov_b32 s36, s24
  s_mov_b32 s37, s25
  s_mov_b32 s38, 0xb00000
  s_mov_b32 s39, 0x20000
  s_mov_b32 s0, s22
  s_mov_b32 s1, s23
  s_mov_b32 s2, 0x100
  s_mov_b32 s3, 0x20000
  s_add_u32 s72, s68, 0
  s_cmp_ge_u32 s72, 6
  s_cselect_b32 s73, 6, 0
  s_sub_u32 s72, s72, s73
  s_lshl_b32 s72, s72, 6
  v_add_u32 v4, s72, v1
  v_mul_u32_u24 v5, 2731, v4
  v_lshrrev_b32 v5, 16, v5
  v_mul_u32_u24 v6, 24, v5
  v_sub_u32 v6, v4, v6
  v_and_b32 v7, 2, v5
  v_lshlrev_b32 v7, 1, v7
  v_xor_b32 v6, v6, v7
  v_mul_u32_u24 v5, 3072, v5
  s_lshl_b32 s71, s72, 4
  v_lshl_add_u32 v24, v6, 4, v5
  s_add_u32 s91, s70, s71
  s_add_u32 s72, s68, 1
  s_cmp_ge_u32 s72, 6
  s_cselect_b32 s73, 6, 0
  s_sub_u32 s72, s72, s73
  s_lshl_b32 s72, s72, 6
  v_add_u32 v4, s72, v1
  v_mul_u32_u24 v5, 2731, v4
  v_lshrrev_b32 v5, 16, v5
  v_mul_u32_u24 v6, 24, v5
  v_sub_u32 v6, v4, v6
  v_and_b32 v7, 2, v5
  v_lshlrev_b32 v7, 1, v7
  v_xor_b32 v6, v6, v7
  v_mul_u32_u24 v5, 3072, v5
  s_lshl_b32 s71, s72, 4
  v_lshl_add_u32 v25, v6, 4, v5
  s_add_u32 s101, s70, s71
  s_add_u32 s72, s68, 2
  s_cmp_ge_u32 s72, 6
  s_cselect_b32 s73, 6, 0
  s_sub_u32 s72, s72, s73
  s_lshl_b32 s72, s72, 6
  v_add_u32 v4, s72, v1
  v_mul_u32_u24 v5, 2731, v4
  v_lshrrev_b32 v5, 16, v5
  v_mul_u32_u24 v6, 24, v5
  v_sub_u32 v6, v4, v6
  v_and_b32 v7, 2, v5
  v_lshlrev_b32 v7, 1, v7
  v_xor_b32 v6, v6, v7
  v_mul_u32_u24 v5, 3072, v5
  s_lshl_b32 s71, s72, 4
  v_lshl_add_u32 v26, v6, 4, v5
  s_add_u32 s22, s70, s71
  s_add_u32 s72, s68, 3
  s_cmp_ge_u32 s72, 6
  s_cselect_b32 s73, 6, 0
  s_sub_u32 s72, s72, s73
  s_lshl_b32 s72, s72, 6
  v_add_u32 v4, s72, v1
  v_mul_u32_u24 v5, 2731, v4
  v_lshrrev_b32 v5, 16, v5
  v_mul_u32_u24 v6, 24, v5
  v_sub_u32 v6, v4, v6
  v_and_b32 v7, 2, v5
  v_lshlrev_b32 v7, 1, v7
  v_xor_b32 v6, v6, v7
  v_mul_u32_u24 v5, 3072, v5
  s_lshl_b32 s71, s72, 4
  v_lshl_add_u32 v27, v6, 4, v5
  s_add_u32 s23, s70, s71
  s_add_u32 s72, s68, 4
  s_cmp_ge_u32 s72, 6
  s_cselect_b32 s73, 6, 0
  s_sub_u32 s72, s72, s73
  s_lshl_b32 s72, s72, 6
  v_add_u32 v4, s72, v1
  v_mul_u32_u24 v5, 2731, v4
  v_lshrrev_b32 v5, 16, v5
  v_mul_u32_u24 v6, 24, v5
  v_sub_u32 v6, v4, v6
  v_and_b32 v7, 2, v5
  v_lshlrev_b32 v7, 1, v7
  v_xor_b32 v6, v6, v7
  v_mul_u32_u24 v5, 3072, v5
  s_lshl_b32 s71, s72, 4
  v_lshl_add_u32 v28, v6, 4, v5
  s_add_u32 s24, s70, s71
  s_add_u32 s72, s68, 5
  s_cmp_ge_u32 s72, 6
  s_cselect_b32 s73, 6, 0
  s_sub_u32 s72, s72, s73
  s_lshl_b32 s72, s72, 6
  v_add_u32 v4, s72, v1
  v_mul_u32_u24 v5, 2731, v4
  v_lshrrev_b32 v5, 16, v5
  v_mul_u32_u24 v6, 24, v5
  v_sub_u32 v6, v4, v6
  v_and_b32 v7, 2, v5
  v_lshlrev_b32 v7, 1, v7
  v_xor_b32 v6, v6, v7
  v_mul_u32_u24 v5, 3072, v5
  s_lshl_b32 s71, s72, 4
  v_lshl_add_u32 v29, v6, 4, v5
  s_add_u32 s25, s70, s71
  v_mov_b32 v32, 0
  v_mov_b32 v33, 0
  v_mov_b32 v34, 0
  v_mov_b32 v35, 0
  s_lshl_b32 s70, s56, 8
  s_add_u32 s70, s70, s26
  s_cmp_eq_u32 s70, 128
  s_cbranch_scc1 Linit_11
Linitb_12:
  s_xor_b32 s98, 0, s99
  s_mul_i32 s65, s98, 196608
  s_add_u32 m0, s91, 0
  s_add_u32 s65, s65, s94
  buffer_load_dwordx4 v24, s[32:35], s65 offen  lds
  s_lshl_b32 s64, s98, 7
  s_add_u32 m0, s81, 0
  s_add_u32 s64, s64, s93
  buffer_load_dwordx4 v20, s[28:31], s64 offen  lds
  s_add_u32 m0, s101, 0
  s_nop 0
  buffer_load_dwordx4 v25, s[32:35], s65 offen  lds
  s_add_u32 m0, s83, 0
  s_nop 0
  buffer_load_dwordx4 v21, s[28:31], s64 offen  lds
  s_add_u32 m0, s22, 0
  s_nop 0
  buffer_load_dwordx4 v26, s[32:35], s65 offen  lds
  s_add_u32 m0, s23, 0
  s_nop 0
  buffer_load_dwordx4 v27, s[32:35], s65 offen  lds
  s_add_u32 m0, s87, 0
  s_nop 0
  buffer_load_dwordx4 v22, s[28:31], s64 offen  lds
  s_add_u32 m0, s24, 0
  s_nop 0
  buffer_load_dwordx4 v28, s[32:35], s65 offen  lds
  s_add_u32 m0, s89, 0
  s_nop 0
  buffer_load_dwordx4 v23, s[28:31], s64 offen  lds
  s_add_u32 m0, s25, 0
  s_nop 0
  buffer_load_dwordx4 v29, s[32:35], s65 offen  lds
  v_and_b32 v30, 31, v1
  v_lshrrev_b32 v31, 5, v1
  v_bfe_u32 v40, v1, 1, 3
  v_xor_b32 v40, v40, v31
  v_lshlrev_b32 v30, 7, v30
  s_and_b32 s78, s56, 1
  s_lshr_b32 s77, s56, 1
  s_cmp_eq_u32 s56, 0
  s_cselect_b32 s53, 1, 0
  s_cselect_b32 s54, 0, 0x40000000
  s_lshl_b32 s70, s78, 13
  v_add_u32 v30, s70, v30
  v_xor_b32 v41, 0, v40
  v_lshl_add_u32 v2, v41, 4, v30
  v_xor_b32 v41, 2, v40
  v_lshl_add_u32 v3, v41, 4, v30
  v_xor_b32 v41, 4, v40
  v_lshl_add_u32 v4, v41, 4, v30
  v_xor_b32 v41, 6, v40
  v_lshl_add_u32 v5, v41, 4, v30
  v_lshrrev_b32 v40, 4, v1
  v_bfe_u32 v41, v1, 2, 2
  v_and_b32 v42, 3, v1
  v_and_b32 v43, 1, v40
  v_lshl_add_u32 v44, v31, 3, v41
  v_lshl_add_u32 v45, v43, 2, v42
  v_mul_u32_u24 v46, 384, v44
  v_lshl_add_u32 v46, v45, 3, v46
  v_lshrrev_b32 v47, 1, v41
  s_mul_i32 s71, s77, 192
  s_add_u32 s71, s71, 16384
  v_add_u32 v46, s71, v46
  s_lshl_b32 s70, s77, 7
  s_sub_u32 s70, 64, s70
  v_mul_lo_u32 v47, s70, v47
  v_add_u32 v14, v46, v47
  v_sub_u32 v15, v46, v47
  v_and_b32 v30, 15, v1
  v_cmp_eq_u32 vcc, v30, v43
  v_mov_b32 v46, 0x3f803f80
  s_nop 0
  v_cndmask_b32 v46, 0, v46, vcc
  v_accvgpr_write_b32 a232, v46
  v_accvgpr_write_b32 a233, v46
  v_accvgpr_write_b32 a234, v46
  v_accvgpr_write_b32 a235, v46
  v_lshrrev_b32 v46, 2, v30
  v_cmp_eq_u32 vcc, v46, v31
  v_mov_b32 v46, 0x3f803f80
  v_and_b32 v47, 2, v1
  v_cndmask_b32 v46, 0, v46, vcc
  v_cmp_eq_u32 vcc, 0, v47
  v_and_b32 v30, 1, v1
  v_mul_u32_u24 v95, 0xaaaa, v30
  v_cndmask_b32 v47, 0, v46, vcc
  v_cndmask_b32 v46, v46, 0, vcc
  v_add_u32 v95, 0x4444, v95
  v_accvgpr_write_b32 a236, v47
  v_accvgpr_write_b32 a220, 0
  v_accvgpr_write_b32 a237, v47
  v_accvgpr_write_b32 a221, 0
  v_accvgpr_write_b32 a238, v46
  v_accvgpr_write_b32 a222, 0
  v_accvgpr_write_b32 a239, v46
  v_accvgpr_write_b32 a223, 0
  s_mov_b32 s40, s16
  s_mov_b32 s41, s17
  s_mov_b32 s42, 0x1e0000
  s_mov_b32 s43, 0x20000
  s_mov_b32 s44, s8
  s_mov_b32 s45, s9
  s_mov_b32 s46, 0xc8000
  s_mov_b32 s47, 0x20000
  s_mov_b32 s48, s20
  s_mov_b32 s49, s21
  s_mov_b32 s50, 0x280000
  s_mov_b32 s51, 0x20000
  v_add_u32 v6, 40960, v2
  v_add_u32 v7, 40960, v3
  v_add_u32 v8, 40960, v4
  v_add_u32 v9, 40960, v5
  v_add_u32 v16, 40960, v14
  v_add_u32 v17, 40960, v15
  v_add_u32 v10, 81920, v2
  v_add_u32 v11, 81920, v3
  v_add_u32 v12, 81920, v4
  v_add_u32 v13, 81920, v5
  v_add_u32 v18, 81920, v14
  v_add_u32 v19, 81920, v15
  v_mov_b32 v125, 1
  v_mov_b32 v61, 0x40000000
  v_add_u32 v30, s26, v0
  v_cmp_eq_u32 vcc, 128, v30
  s_cmp_eq_u32 s26, 128
  s_cselect_b64 vcc, vcc, 0
  s_nop 1
  v_cndmask_b32 v61, v61, 0, vcc
  s_xor_b32 s98, 1, s99
  s_mul_i32 s65, s98, 196608
  s_add_u32 m0, s91, 40960
  s_add_u32 s65, s65, s94
  buffer_load_dwordx4 v24, s[32:35], s65 offen  lds
  s_lshl_b32 s64, s98, 7
  s_add_u32 m0, s81, 40960
  s_add_u32 s64, s64, s93
  buffer_load_dwordx4 v20, s[28:31], s64 offen  lds
  s_add_u32 m0, s101, 40960
  s_nop 0
  buffer_load_dwordx4 v25, s[32:35], s65 offen  lds
  s_add_u32 m0, s83, 40960
  s_nop 0
  buffer_load_dwordx4 v21, s[28:31], s64 offen  lds
  s_add_u32 m0, s22, 40960
  s_nop 0
  buffer_load_dwordx4 v26, s[32:35], s65 offen  lds
  s_add_u32 m0, s23, 40960
  s_nop 0
  buffer_load_dwordx4 v27, s[32:35], s65 offen  lds
  s_add_u32 m0, s87, 40960
  s_nop 0
  buffer_load_dwordx4 v22, s[28:31], s64 offen  lds
  s_add_u32 m0, s24, 40960
  s_nop 0
  buffer_load_dwordx4 v28, s[32:35], s65 offen  lds
  s_add_u32 m0, s89, 40960
  s_nop 0
  buffer_load_dwordx4 v23, s[28:31], s64 offen  lds
  s_add_u32 m0, s25, 40960
  s_nop 0
  buffer_load_dwordx4 v29, s[32:35], s65 offen  lds
  s_branch LHmain
LEND:
  s_endpgm
.p2align 12
LQmain:
  s_waitcnt vmcnt(12)
  s_barrier
  ds_read_b64_tr_b16 v[96:97], v14 offset:0
  ds_read_b64_tr_b16 v[98:99], v14 offset:2048
  ds_read_b128 v[64:67], v2 offset:0
  ds_read_b64_tr_b16 v[100:101], v15 offset:0
  ds_read_b64_tr_b16 v[102:103], v15 offset:2048
  ds_read_b128 v[68:71], v2 offset:4096
  ds_read_b128 v[72:75], v2 offset:8192
  ds_read_b128 v[76:79], v2 offset:12288
  s_waitcnt lgkmcnt(0)
  v_mfma_f32_32x32x16_bf16 v[128:143], v[96:99], v[64:67], 0
  ds_read_b64_tr_b16 v[104:105], v14 offset:8192
  ds_read_b64_tr_b16 v[106:107], v14 offset:10240
  s_xor_b32 s98, 2, s99
  s_mul_i32 s65, s98, 245760
  s_add_u32 m0, s91, 98304
  s_add_u32 s65, s65, s94
  buffer_load_dwordx4 v24, s[32:35], s65 offen  lds
  v_mfma_f32_32x32x16_bf16 v[144:159], v[100:103], v[64:67], 0
  ds_read_b128 v[80:83], v3 offset:0
  ds_read_b64_tr_b16 v[108:109], v15 offset:8192
  s_and_b32 s70, s26, 255
  s_lshl_b32 s70, s70, 2
  v_mfma_f32_32x32x16_bf16 v[160:175], v[96:99], v[68:71], 0
  ds_read_b64_tr_b16 v[110:111], v15 offset:10240
  ds_read_b128 v[84:87], v3 offset:4096
  s_lshl_b32 s64, s98, 7
  s_add_u32 m0, s81, 98304
  s_add_u32 s64, s64, s93
  buffer_load_dwordx4 v20, s[28:31], s64 offen  lds
  v_mfma_f32_32x32x16_bf16 v[176:191], v[100:103], v[68:71], 0
  ds_read_b128 v[88:91], v3 offset:8192
  ds_read_b128 v[92:95], v3 offset:12288
  s_add_u32 m0, s101, 98304
  s_add_u32 s70, s70, s56
  v_smfmac_f32_16x16x64_bf16 a[220:223], a[236:239], v[96:103], v115
  v_mfma_f32_32x32x16_bf16 v[192:207], v[96:99], v[72:75], 0
  buffer_load_dwordx4 v25, s[32:35], s65 offen  lds
  s_mul_i32 s71, s70, 1920
  v_min_u32 v30, 14, v1
  v_lshl_add_u32 v112, v30, 7, s71
  v_mfma_f32_32x32x16_bf16 v[208:223], v[100:103], v[72:75], 0
  s_add_u32 m0, s22, 98304
  s_mul_i32 s71, s70, 800
  v_min_u32 v30, 6, v1
  v_lshl_add_u32 v39, v30, 7, s71
  v_mfma_f32_32x32x16_bf16 v[224:239], v[96:99], v[76:79], 0
  buffer_load_dwordx4 v26, s[32:35], s65 offen  lds
  s_lshr_b32 s70, s61, 2
  s_add_u32 s70, s70, 6
  s_and_b32 s71, s61, 3
  v_mfma_f32_32x32x16_bf16 v[240:255], v[100:103], v[76:79], 0
  s_cmp_lt_u32 s61, 8
  s_cselect_b32 s63, s61, s70
  s_cselect_b32 s71, 3, s71
  s_lshl_b32 s62, s71, 2
  s_waitcnt lgkmcnt(0)
  v_mfma_f32_32x32x16_bf16 v[128:143], v[104:107], v[80:83], v[128:143]
  ds_read_b64_tr_b16 v[96:97], v14 offset:16384
  ds_read_b64_tr_b16 v[98:99], v14 offset:18432
  s_add_u32 m0, s83, 98304
  s_nop 0
  buffer_load_dwordx4 v21, s[28:31], s64 offen  lds
  v_mfma_f32_32x32x16_bf16 v[144:159], v[108:111], v[80:83], v[144:159]
  ds_read_b128 v[64:67], v4 offset:0
  ds_read_b64_tr_b16 v[100:101], v15 offset:16384
  s_add_u32 s79, s71, 1
  s_lshl_b32 s70, s59, 2
  v_mfma_f32_32x32x16_bf16 v[160:175], v[104:107], v[84:87], v[160:175]
  ds_read_b64_tr_b16 v[102:103], v15 offset:18432
  ds_read_b128 v[68:71], v4 offset:4096
  s_add_u32 s70, s70, s60
  s_lshl_b32 s70, s70, 4
  v_mfma_f32_32x32x16_bf16 v[176:191], v[108:111], v[84:87], v[176:191]
  ds_read_b128 v[72:75], v4 offset:8192
  ds_read_b128 v[76:79], v4 offset:12288
  s_add_u32 s62, s62, s70
  s_add_u32 s79, s79, s63
  v_smfmac_f32_16x16x64_bf16 a[220:223], a[236:239], v[104:111], v115
  v_mfma_f32_32x32x16_bf16 v[192:207], v[104:107], v[88:91], v[192:207]
  s_and_b32 s70, s26, 7
  s_add_u32 s79, s79, s70
  s_cmp_ge_u32 s79, 8
  s_cselect_b32 s72, 8, 0
  v_mfma_f32_32x32x16_bf16 v[208:223], v[108:111], v[88:91], v[208:223]
  s_sub_u32 s70, s79, s72
  s_cmp_ge_u32 s70, 8
  s_cselect_b32 s72, 8, 0
  s_sub_u32 s70, s70, s72
  v_mfma_f32_32x32x16_bf16 v[224:239], v[104:107], v[92:95], v[224:239]
  s_cmp_ge_u32 s70, 8
  s_cselect_b32 s72, 8, 0
  s_sub_u32 s70, s70, s72
  v_mfma_f32_32x32x16_bf16 v[240:255], v[108:111], v[92:95], v[240:255]
  s_cmp_ge_u32 s70, 8
  s_cselect_b32 s72, 8, 0
  s_sub_u32 s70, s70, s72
  s_add_u32 s71, s70, 0
  s_waitcnt lgkmcnt(0)
  v_mfma_f32_32x32x16_bf16 v[128:143], v[96:99], v[64:67], v[128:143]
  ds_read_b64_tr_b16 v[104:105], v14 offset:24576
  ds_read_b64_tr_b16 v[106:107], v14 offset:26624
  s_cmp_ge_u32 s71, 8
  s_cselect_b32 s72, 8, 0
  v_mfma_f32_32x32x16_bf16 v[144:159], v[100:103], v[64:67], v[144:159]
  ds_read_b128 v[80:83], v5 offset:0
  ds_read_b64_tr_b16 v[108:109], v15 offset:24576
  s_sub_u32 s71, s71, s72
  s_mul_i32 s4, s71, 3072
  v_mfma_f32_32x32x16_bf16 v[160:175], v[96:99], v[68:71], v[160:175]
  ds_read_b64_tr_b16 v[110:111], v15 offset:26624
  ds_read_b128 v[84:87], v5 offset:4096
  s_add_u32 s71, s70, 1
  v_mfma_f32_32x32x16_bf16 v[176:191], v[100:103], v[68:71], v[176:191]
  ds_read_b128 v[88:91], v5 offset:8192
  ds_read_b128 v[92:95], v5 offset:12288
  s_cmp_ge_u32 s71, 8
  s_cselect_b32 s72, 8, 0
  v_smfmac_f32_16x16x64_bf16 a[220:223], a[236:239], v[96:103], v115
  v_mfma_f32_32x32x16_bf16 v[192:207], v[96:99], v[72:75], v[192:207]
  s_sub_u32 s71, s71, s72
  s_mul_i32 s5, s71, 3072
  s_add_u32 s71, s70, 2
  v_mfma_f32_32x32x16_bf16 v[208:223], v[100:103], v[72:75], v[208:223]
  s_cmp_ge_u32 s71, 8
  s_cselect_b32 s72, 8, 0
  s_sub_u32 s71, s71, s72
  s_mul_i32 s6, s71, 3072
  v_mfma_f32_32x32x16_bf16 v[224:239], v[96:99], v[76:79], v[224:239]
  s_add_u32 s71, s70, 3
  s_cmp_ge_u32 s71, 8
  s_cselect_b32 s72, 8, 0
  s_sub_u32 s71, s71, s72
  v_mfma_f32_32x32x16_bf16 v[240:255], v[100:103], v[76:79], v[240:255]
  s_mul_i32 s7, s71, 3072
  s_add_u32 s71, s70, 4
  s_cmp_ge_u32 s71, 8
  s_cselect_b32 s72, 8, 0
  s_waitcnt lgkmcnt(0)
  v_mfma_f32_32x32x16_bf16 v[128:143], v[104:107], v[80:83], v[128:143]
  s_waitcnt vmcnt(5)
  s_barrier
  ds_read_b64_tr_b16 v[96:97], v16 offset:0
  ds_read_b64_tr_b16 v[98:99], v16 offset:2048
  ds_read_b128 v[64:67], v6 offset:0
  v_mfma_f32_32x32x16_bf16 v[144:159], v[108:111], v[80:83], v[144:159]
  ds_read_b64_tr_b16 v[100:101], v17 offset:0
  ds_read_b64_tr_b16 v[102:103], v17 offset:2048
  ds_read_b128 v[68:71], v6 offset:4096
  s_add_u32 m0, s23, 98304
  s_nop 0
  buffer_load_dwordx4 v27, s[32:35], s65 offen  lds
  s_add_u32 m0, s24, 98304
  v_mfma_f32_32x32x16_bf16 v[160:175], v[104:107], v[84:87], v[160:175]
  buffer_load_dwordx4 v28, s[32:35], s65 offen  lds
  ds_read_b128 v[72:75], v6 offset:8192
  ds_read_b128 v[76:79], v6 offset:12288
  s_sub_u32 s71, s71, s72
  v_mfma_f32_32x32x16_bf16 v[176:191], v[108:111], v[84:87], v[176:191]
  s_add_u32 m0, s87, 98304
  s_mul_i32 s8, s71, 3072
  s_add_u32 s71, s70, 5
  v_smfmac_f32_16x16x64_bf16 a[220:223], a[236:239], v[104:111], v115
  v_mfma_f32_32x32x16_bf16 v[192:207], v[104:107], v[88:91], v[192:207]
  buffer_load_dwordx4 v22, s[28:31], s64 offen  lds
  s_cmp_ge_u32 s71, 8
  s_cselect_b32 s72, 8, 0
  s_sub_u32 s71, s71, s72
  v_mfma_f32_32x32x16_bf16 v[208:223], v[108:111], v[88:91], v[208:223]
  s_add_u32 m0, s25, 98304
  s_mul_i32 s9, s71, 3072
  s_add_u32 s71, s70, 6
  v_mfma_f32_32x32x16_bf16 v[224:239], v[104:107], v[92:95], v[224:239]
  buffer_load_dwordx4 v29, s[32:35], s65 offen  lds
  s_cmp_ge_u32 s71, 8
  s_cselect_b32 s72, 8, 0
  s_sub_u32 s71, s71, s72
  v_mfma_f32_32x32x16_bf16 v[240:255], v[108:111], v[92:95], v[240:255]
  s_mul_i32 s20, s71, 3072
  s_add_u32 s71, s70, 7
  s_cmp_ge_u32 s71, 8
  s_cselect_b32 s72, 8, 0
  s_waitcnt lgkmcnt(0)
  v_mfma_f32_32x32x16_bf16 v[128:143], v[96:99], v[64:67], v[128:143]
  ds_read_b64_tr_b16 v[104:105], v16 offset:8192
  ds_read_b64_tr_b16 v[106:107], v16 offset:10240
  s_add_u32 m0, s66, 98304
  s_nop 0
  buffer_load_dwordx4 v36, s[32:35], s65 offen  lds
  v_mfma_f32_32x32x16_bf16 v[144:159], v[100:103], v[64:67], v[144:159]
  ds_read_b128 v[80:83], v7 offset:0
  ds_read_b64_tr_b16 v[108:109], v17 offset:8192
  s_add_u32 m0, s89, 98304
  s_sub_u32 s71, s71, s72
  v_mfma_f32_32x32x16_bf16 v[160:175], v[96:99], v[68:71], v[160:175]
  buffer_load_dwordx4 v23, s[28:31], s64 offen  lds
  ds_read_b64_tr_b16 v[110:111], v17 offset:10240
  ds_read_b128 v[84:87], v7 offset:4096
  s_mul_i32 s21, s71, 3072
  v_mfma_f32_32x32x16_bf16 v[176:191], v[100:103], v[68:71], v[176:191]
  ds_read_b128 v[88:91], v7 offset:8192
  ds_read_b128 v[92:95], v7 offset:12288
  s_add_u32 m0, s67, 98304
  v_smfmac_f32_16x16x64_bf16 a[220:223], a[236:239], v[96:103], v115
  v_mfma_f32_32x32x16_bf16 v[192:207], v[96:99], v[72:75], v[192:207]
  buffer_load_dwordx4 v37, s[32:35], s65 offen  lds
  s_cmp_ge_u32 s79, 5
  s_cselect_b32 s72, 5, 0
  s_sub_u32 s70, s79, s72
  v_mfma_f32_32x32x16_bf16 v[208:223], v[100:103], v[72:75], v[208:223]
  s_cmp_ge_u32 s70, 5
  s_cselect_b32 s72, 5, 0
  s_sub_u32 s70, s70, s72
  v_mfma_f32_32x32x16_bf16 v[224:239], v[96:99], v[76:79], v[224:239]
  s_xor_b32 s98, 3, s99
  s_mul_i32 s65, s98, 245760
  s_add_u32 m0, s91, 0
  s_add_u32 s65, s65, s94
  buffer_load_dwordx4 v24, s[32:35], s65 offen  lds
  v_mfma_f32_32x32x16_bf16 v[240:255], v[100:103], v[76:79], v[240:255]
  s_cmp_ge_u32 s70, 5
  s_cselect_b32 s72, 5, 0
  s_sub_u32 s70, s70, s72
  s_waitcnt lgkmcnt(0)
  v_mfma_f32_32x32x16_bf16 v[128:143], v[104:107], v[80:83], v[128:143]
  ds_read_b64_tr_b16 v[96:97], v16 offset:16384
  ds_read_b64_tr_b16 v[98:99], v16 offset:18432
  s_lshl_b32 s64, s98, 7
  s_add_u32 m0, s81, 0
  s_add_u32 s64, s64, s93
  buffer_load_dwordx4 v20, s[28:31], s64 offen  lds
  v_mfma_f32_32x32x16_bf16 v[144:159], v[108:111], v[80:83], v[144:159]
  ds_read_b128 v[64:67], v8 offset:0
  ds_read_b64_tr_b16 v[100:101], v17 offset:16384
  s_add_u32 m0, s101, 0
  v_mfma_f32_32x32x16_bf16 v[160:175], v[104:107], v[84:87], v[160:175]
  buffer_load_dwordx4 v25, s[32:35], s65 offen  lds
  ds_read_b64_tr_b16 v[102:103], v17 offset:18432
  ds_read_b128 v[68:71], v8 offset:4096
  v_mfma_f32_32x32x16_bf16 v[176:191], v[108:111], v[84:87], v[176:191]
  ds_read_b128 v[72:75], v8 offset:8192
  ds_read_b128 v[76:79], v8 offset:12288
  s_add_u32 m0, s22, 0
  v_smfmac_f32_16x16x64_bf16 a[220:223], a[236:239], v[104:111], v115
  v_mfma_f32_32x32x16_bf16 v[192:207], v[104:107], v[88:91], v[192:207]
  buffer_load_dwordx4 v26, s[32:35], s65 offen  lds
  s_cmp_ge_u32 s70, 5
  s_cselect_b32 s72, 5, 0
  s_sub_u32 s70, s70, s72
  v_mfma_f32_32x32x16_bf16 v[208:223], v[108:111], v[88:91], v[208:223]
  s_add_u32 m0, s83, 0
  s_add_u32 s71, s70, 0
  s_cmp_ge_u32 s71, 5
  s_cselect_b32 s72, 5, 0
  v_mfma_f32_32x32x16_bf16 v[224:239], v[104:107], v[92:95], v[224:239]
  buffer_load_dwordx4 v21, s[28:31], s64 offen  lds
  s_sub_u32 s71, s71, s72
  s_mul_i32 s10, s71, 2048
  s_add_u32 s71, s70, 1
  v_mfma_f32_32x32x16_bf16 v[240:255], v[108:111], v[92:95], v[240:255]
  s_cmp_ge_u32 s71, 5
  s_cselect_b32 s72, 5, 0
  s_sub_u32 s71, s71, s72
  s_mul_i32 s11, s71, 2048
  s_waitcnt lgkmcnt(0)
  v_mfma_f32_32x32x16_bf16 v[128:143], v[96:99], v[64:67], v[128:143]
  ds_read_b64_tr_b16 v[104:105], v16 offset:24576
  ds_read_b64_tr_b16 v[106:107], v16 offset:26624
  s_add_u32 m0, s23, 0
  s_nop 0
  buffer_load_dwordx4 v27, s[32:35], s65 offen  lds
  v_mfma_f32_32x32x16_bf16 v[144:159], v[100:103], v[64:67], v[144:159]
  ds_read_b128 v[80:83], v9 offset:0
  ds_read_b64_tr_b16 v[108:109], v17 offset:24576
  s_add_u32 m0, s24, 0
  s_add_u32 s71, s70, 2
  v_mfma_f32_32x32x16_bf16 v[160:175], v[96:99], v[68:71], v[160:175]
  buffer_load_dwordx4 v28, s[32:35], s65 offen  lds
  ds_read_b64_tr_b16 v[110:111], v17 offset:26624
  ds_read_b128 v[84:87], v9 offset:4096
  v_mfma_f32_32x32x16_bf16 v[176:191], v[100:103], v[68:71], v[176:191]
  ds_read_b128 v[88:91], v9 offset:8192
  ds_read_b128 v[92:95], v9 offset:12288
  s_add_u32 m0, s87, 0
  v_smfmac_f32_16x16x64_bf16 a[220:223], a[236:239], v[96:103], v115
  v_mfma_f32_32x32x16_bf16 v[192:207], v[96:99], v[72:75], v[192:207]
  buffer_load_dwordx4 v22, s[28:31], s64 offen  lds
  s_cmp_ge_u32 s71, 5
  s_cselect_b32 s72, 5, 0
  s_sub_u32 s71, s71, s72
  v_mfma_f32_32x32x16_bf16 v[208:223], v[100:103], v[72:75], v[208:223]
  s_add_u32 m0, s25, 0
  s_mul_i32 s12, s71, 2048
  s_add_u32 s71, s70, 3
  v_mfma_f32_32x32x16_bf16 v[224:239], v[96:99], v[76:79], v[224:239]
  buffer_load_dwordx4 v29, s[32:35], s65 offen  lds
  s_cmp_ge_u32 s71, 5
  s_cselect_b32 s72, 5, 0
  s_sub_u32 s71, s71, s72
  v_mfma_f32_32x32x16_bf16 v[240:255], v[100:103], v[76:79], v[240:255]
  s_mul_i32 s13, s71, 2048
  s_add_u32 s71, s70, 4
  s_cmp_ge_u32 s71, 5
  s_cselect_b32 s72, 5, 0
  s_waitcnt lgkmcnt(0)
  v_mfma_f32_32x32x16_bf16 v[128:143], v[104:107], v[80:83], v[128:143]
  s_waitcnt vmcnt(9)
  s_barrier
  ds_read_b64_tr_b16 v[96:97], v18 offset:0
  ds_read_b64_tr_b16 v[98:99], v18 offset:2048
  ds_read_b128 v[64:67], v10 offset:0
  v_mfma_f32_32x32x16_bf16 v[144:159], v[108:111], v[80:83], v[144:159]
  ds_read_b64_tr_b16 v[100:101], v19 offset:0
  ds_read_b64_tr_b16 v[102:103], v19 offset:2048
  ds_read_b128 v[68:71], v10 offset:4096
  s_add_u32 m0, s66, 0
  s_nop 0
  buffer_load_dwordx4 v36, s[32:35], s65 offen  lds
  v_mfma_f32_32x32x16_bf16 v[160:175], v[104:107], v[84:87], v[160:175]
  ds_read_b128 v[72:75], v10 offset:8192
  ds_read_b128 v[76:79], v10 offset:12288
  s_add_u32 m0, s89, 0
  s_sub_u32 s71, s71, s72
  v_mfma_f32_32x32x16_bf16 v[176:191], v[108:111], v[84:87], v[176:191]
  buffer_load_dwordx4 v23, s[28:31], s64 offen  lds
  s_mul_i32 s16, s71, 2048
  v_lshrrev_b32 v30, 3, v1
  v_and_b32 v46, 7, v1
  v_smfmac_f32_16x16x64_bf16 a[220:223], a[236:239], v[104:111], v115
  v_mfma_f32_32x32x16_bf16 v[192:207], v[104:107], v[88:91], v[192:207]
  s_add_u32 m0, s67, 0
  s_lshl_b32 s70, s56, 3
  v_add_u32 v47, s70, v30
  v_mul_u32_u24 v47, 1280, v47
  v_mfma_f32_32x32x16_bf16 v[208:223], v[108:111], v[88:91], v[208:223]
  buffer_load_dwordx4 v37, s[32:35], s65 offen  lds
  s_lshl_b32 s70, s63, 7
  v_add_u32 v47, s70, v47
  v_and_b32 v52, 6, v30
  v_mfma_f32_32x32x16_bf16 v[224:239], v[104:107], v[92:95], v[224:239]
  v_xor_b32 v52, v52, v46
  v_lshl_add_u32 v48, v52, 4, v47
  v_add_u32 v49, 982016, v48
  v_and_b32 v52, 2, v30
  v_mfma_f32_32x32x16_bf16 v[240:255], v[108:111], v[92:95], v[240:255]
  s_lshl_b32 s70, s78, 2
  v_or_b32 v52, s70, v52
  v_xor_b32 v52, v52, v46
  v_lshl_add_u32 v50, v52, 4, v47
  s_waitcnt lgkmcnt(0)
  v_mfma_f32_32x32x16_bf16 v[128:143], v[96:99], v[64:67], v[128:143]
  ds_read_b64_tr_b16 v[104:105], v18 offset:8192
  ds_read_b64_tr_b16 v[106:107], v18 offset:10240
  s_xor_b32 s98, 4, s99
  s_mul_i32 s65, s98, 245760
  s_add_u32 m0, s91, 49152
  s_add_u32 s65, s65, s94
  buffer_load_dwordx4 v24, s[32:35], s65 offen  lds
  v_mfma_f32_32x32x16_bf16 v[144:159], v[100:103], v[64:67], v[144:159]
  ds_read_b128 v[80:83], v11 offset:0
  ds_read_b64_tr_b16 v[108:109], v19 offset:8192
  v_add_u32 v51, 408576, v50
  s_lshl_b32 s76, s56, 11
  v_mfma_f32_32x32x16_bf16 v[160:175], v[96:99], v[68:71], v[160:175]
  ds_read_b64_tr_b16 v[110:111], v19 offset:10240
  ds_read_b128 v[84:87], v11 offset:4096
  s_lshl_b32 s64, s98, 7
  s_add_u32 m0, s81, 49152
  s_add_u32 s64, s64, s93
  buffer_load_dwordx4 v20, s[28:31], s64 offen  lds
  v_mfma_f32_32x32x16_bf16 v[176:191], v[100:103], v[68:71], v[176:191]
  ds_read_b128 v[88:91], v11 offset:8192
  ds_read_b128 v[92:95], v11 offset:12288
  s_add_u32 m0, s101, 49152
  v_lshrrev_b32 v30, 1, v41
  v_smfmac_f32_16x16x64_bf16 a[220:223], a[236:239], v[96:103], v115
  v_mfma_f32_32x32x16_bf16 v[192:207], v[96:99], v[72:75], v[192:207]
  buffer_load_dwordx4 v25, s[32:35], s65 offen  lds
  v_lshl_add_u32 v30, v43, 1, v30
  v_lshl_add_u32 v46, v43, 2, v41
  v_lshlrev_b32 v46, 7, v46
  v_mfma_f32_32x32x16_bf16 v[208:223], v[100:103], v[72:75], v[208:223]
  s_add_u32 m0, s22, 49152
  v_lshl_add_u32 v46, v31, 12, v46
  v_lshlrev_b32 v47, 7, v41
  v_lshl_add_u32 v47, v40, 11, v47
  v_mfma_f32_32x32x16_bf16 v[224:239], v[96:99], v[76:79], v[224:239]
  buffer_load_dwordx4 v26, s[32:35], s65 offen  lds
  s_lshl_b32 s70, s77, 10
  v_lshl_add_u32 v46, v42, 3, v46
  v_add_u32 v46, s70, v46
  v_mfma_f32_32x32x16_bf16 v[240:255], v[100:103], v[76:79], v[240:255]
  v_lshl_add_u32 v47, v42, 3, v47
  v_add_u32 v47, s70, v47
  s_lshl_b32 s70, s77, 1
  v_xor_b32 v30, s70, v30
  s_waitcnt lgkmcnt(0)
  v_mfma_f32_32x32x16_bf16 v[128:143], v[104:107], v[80:83], v[128:143]
  ds_read_b64_tr_b16 v[96:97], v18 offset:16384
  ds_read_b64_tr_b16 v[98:99], v18 offset:18432
  s_add_u32 m0, s83, 49152
  s_nop 0
  buffer_load_dwordx4 v21, s[28:31], s64 offen  lds
  v_mfma_f32_32x32x16_bf16 v[144:159], v[108:111], v[80:83], v[144:159]
  ds_read_b128 v[64:67], v12 offset:0
  ds_read_b64_tr_b16 v[100:101], v19 offset:16384
  v_xor_b32 v63, 0, v30
  v_lshl_add_u32 v52, v63, 5, v46
  v_mfma_f32_32x32x16_bf16 v[160:175], v[104:107], v[84:87], v[160:175]
  ds_read_b64_tr_b16 v[102:103], v19 offset:18432
  ds_read_b128 v[68:71], v12 offset:4096
  v_lshl_add_u32 v56, v63, 5, v47
  v_xor_b32 v63, 1, v30
  v_mfma_f32_32x32x16_bf16 v[176:191], v[108:111], v[84:87], v[176:191]
  ds_read_b128 v[72:75], v12 offset:8192
  ds_read_b128 v[76:79], v12 offset:12288
  v_lshl_add_u32 v53, v63, 5, v46
  v_lshl_add_u32 v57, v63, 5, v47
  v_smfmac_f32_16x16x64_bf16 a[220:223], a[236:239], v[104:111], v115
  v_mfma_f32_32x32x16_bf16 v[192:207], v[104:107], v[88:91], v[192:207]
  v_xor_b32 v63, 2, v30
  v_lshl_add_u32 v54, v63, 5, v46
  v_lshl_add_u32 v58, v63, 5, v47
  v_xor_b32 v63, 3, v30
  v_mfma_f32_32x32x16_bf16 v[208:223], v[108:111], v[88:91], v[208:223]
  v_lshl_add_u32 v55, v63, 5, v46
  v_lshl_add_u32 v59, v63, 5, v47
  s_mov_b32 s80, 0x3fb8aa3b
  s_mov_b32 s82, 0x358637bd
  v_mfma_f32_32x32x16_bf16 v[224:239], v[104:107], v[92:95], v[224:239]
  s_mov_b32 s86, 0xc0135761
  s_mov_b32 s88, 0xbdd2d3e8
  s_mov_b32 s90, 0x3f800000
  s_mov_b32 s84, 0
  v_mfma_f32_32x32x16_bf16 v[240:255], v[108:111], v[92:95], v[240:255]
  s_mov_b32 s85, -1
  v_lshrrev_b32 v62, 3, v1
  v_and_b32 v30, 7, v1
  v_lshlrev_b32 v62, 7, v62
  s_waitcnt lgkmcnt(0)
  v_mfma_f32_32x32x16_bf16 v[128:143], v[96:99], v[64:67], v[128:143]
  ds_read_b64_tr_b16 v[104:105], v18 offset:24576
  ds_read_b64_tr_b16 v[106:107], v18 offset:26624
  v_lshl_add_u32 v62, v30, 3, v62
  v_add_u32 v62, 10687488, v62
  v_mfma_f32_32x32x16_bf16 v[144:159], v[100:103], v[64:67], v[144:159]
  ds_read_b128 v[80:83], v13 offset:0
  ds_read_b64_tr_b16 v[108:109], v19 offset:24576
  v_and_b32 v63, 31, v1
  v_lshlrev_b32 v63, 3, v63
  v_mfma_f32_32x32x16_bf16 v[160:175], v[96:99], v[68:71], v[160:175]
  ds_read_b64_tr_b16 v[110:111], v19 offset:26624
  ds_read_b128 v[84:87], v13 offset:4096
  s_lshl_b32 s70, s57, 10
  s_add_u32 s70, s70, 10616832
  v_mfma_f32_32x32x16_bf16 v[176:191], v[100:103], v[68:71], v[176:191]
  ds_read_b128 v[88:91], v13 offset:8192
  ds_read_b128 v[92:95], v13 offset:12288
  v_add_u32 v63, s70, v63
  s_lshl_b32 s70, s56, 8
  v_smfmac_f32_16x16x64_bf16 a[220:223], a[236:239], v[96:103], v115
  v_mfma_f32_32x32x16_bf16 v[192:207], v[96:99], v[72:75], v[192:207]
  s_add_u32 s70, s70, 147456
  v_lshl_add_u32 v114, v31, 4, s70
  v_and_b32 v30, 15, v1
  v_lshlrev_b32 v30, 2, v30
  v_mfma_f32_32x32x16_bf16 v[208:223], v[100:103], v[72:75], v[208:223]
  v_lshrrev_b32 v46, 4, v1
  v_lshl_add_u32 v30, v46, 7, v30
  v_add_u32 v30, s70, v30
  v_mfma_f32_32x32x16_bf16 v[224:239], v[96:99], v[76:79], v[224:239]
  v_cmp_gt_u32 vcc, 32, v1
  v_mov_b32 v113, 160768
  s_nop 0
  v_cndmask_b32 v113, v113, v30, vcc
  v_mfma_f32_32x32x16_bf16 v[240:255], v[100:103], v[76:79], v[240:255]
  s_lshl_b32 s70, s56, 12
  v_and_b32 v30, 31, v1
  v_bfe_u32 v46, v1, 1, 3
  v_xor_b32 v46, v46, v31
  s_waitcnt lgkmcnt(0)
  v_mfma_f32_32x32x16_bf16 v[128:143], v[104:107], v[80:83], v[128:143]
  s_waitcnt vmcnt(5)
  s_barrier
  ds_read_b64_tr_b16 v[96:97], v14 offset:0
  ds_read_b64_tr_b16 v[98:99], v14 offset:2048
  ds_read_b128 v[64:67], v2 offset:0
  v_mfma_f32_32x32x16_bf16 v[144:159], v[108:111], v[80:83], v[144:159]
  ds_read_b64_tr_b16 v[100:101], v15 offset:0
  ds_read_b64_tr_b16 v[102:103], v15 offset:2048
  ds_read_b128 v[68:71], v2 offset:4096
  s_add_u32 m0, s23, 49152
  s_nop 0
  buffer_load_dwordx4 v27, s[32:35], s65 offen  lds
  s_add_u32 m0, s24, 49152
  v_mfma_f32_32x32x16_bf16 v[160:175], v[104:107], v[84:87], v[160:175]
  buffer_load_dwordx4 v28, s[32:35], s65 offen  lds
  ds_read_b128 v[72:75], v2 offset:8192
  ds_read_b128 v[76:79], v2 offset:12288
  v_lshl_add_u32 v30, v30, 6, s70
  v_mfma_f32_32x32x16_bf16 v[176:191], v[108:111], v[84:87], v[176:191]
  s_add_u32 m0, s87, 49152
  v_bfe_u32 v46, v1, 1, 3
  v_lshlrev_b32 v47, 2, v31
  v_sub_u32 v47, 4, v47
  v_smfmac_f32_16x16x64_bf16 a[220:223], a[236:239], v[104:111], v115
  v_mfma_f32_32x32x16_bf16 v[192:207], v[104:107], v[88:91], v[192:207]
  buffer_load_dwordx4 v22, s[28:31], s64 offen  lds
  v_xor_b32 v47, v47, v46
  v_lshl_add_u32 v116, v47, 3, v30
  v_add_u32 v47, 1, v31
  v_mfma_f32_32x32x16_bf16 v[208:223], v[108:111], v[88:91], v[208:223]
  s_add_u32 m0, s25, 49152
  v_xor_b32 v47, v47, v46
  v_lshl_add_u32 v117, v47, 3, v30
  v_lshl_add_u32 v47, v31, 1, 3
  v_mfma_f32_32x32x16_bf16 v[224:239], v[104:107], v[92:95], v[224:239]
  buffer_load_dwordx4 v29, s[32:35], s65 offen  lds
  v_xor_b32 v47, v47, v46
  v_lshl_add_u32 v118, v47, 3, v30
  v_lshrrev_b32 v46, 1, v44
  v_mfma_f32_32x32x16_bf16 v[240:255], v[108:111], v[92:95], v[240:255]
  v_xor_b32 v46, v46, v45
  v_lshl_add_u32 v30, v44, 6, s70
  v_lshl_add_u32 v119, v46, 3, v30
  v_xor_b32 v46, 2, v46
  s_waitcnt lgkmcnt(0)
  v_mfma_f32_32x32x16_bf16 v[128:143], v[96:99], v[64:67], v[128:143]
  ds_read_b64_tr_b16 v[104:105], v14 offset:8192
  ds_read_b64_tr_b16 v[106:107], v14 offset:10240
  s_add_u32 m0, s66, 49152
  s_nop 0
  buffer_load_dwordx4 v36, s[32:35], s65 offen  lds
  v_lshl_add_u32 v120, v46, 3, v30
  v_mfma_f32_32x32x16_bf16 v[144:159], v[100:103], v[64:67], v[144:159]
  ds_read_b128 v[80:83], v3 offset:0
  ds_read_b64_tr_b16 v[108:109], v15 offset:8192
  s_add_u32 m0, s89, 49152
  v_add_u32 v120, 256, v120
  s_lshl_b32 s70, s58, 2
  v_mfma_f32_32x32x16_bf16 v[160:175], v[96:99], v[68:71], v[160:175]
  buffer_load_dwordx4 v23, s[28:31], s64 offen  lds
  ds_read_b64_tr_b16 v[110:111], v15 offset:10240
  ds_read_b128 v[84:87], v3 offset:4096
  s_add_u32 s70, s70, s56
  s_lshl_b32 s70, s70, 14
  v_mfma_f32_32x32x16_bf16 v[176:191], v[100:103], v[68:71], v[176:191]
  ds_read_b128 v[88:91], v3 offset:8192
  ds_read_b128 v[92:95], v3 offset:12288
  s_add_u32 m0, s67, 49152
  s_add_u32 s70, s70, 9437184
  s_lshl_b32 s71, s57, 10
  v_smfmac_f32_16x16x64_bf16 a[220:223], a[236:239], v[96:103], v115
  v_mfma_f32_32x32x16_bf16 v[192:207], v[96:99], v[72:75], v[192:207]
  buffer_load_dwordx4 v37, s[32:35], s65 offen  lds
  s_add_u32 s71, s71, s70
  v_and_b32 v30, 31, v1
  v_mul_u32_u24 v46, 384, v31
  v_lshl_add_u32 v46, v30, 4, v46
  v_mfma_f32_32x32x16_bf16 v[208:223], v[100:103], v[72:75], v[208:223]
  v_add_u32 v46, s71, v46
  v_mov_b32 v47, 0x40000000
  v_cmp_gt_u32 vcc, 24, v30
  s_nop 1
  v_cndmask_b32 v121, v47, v46, vcc
  v_mfma_f32_32x32x16_bf16 v[224:239], v[96:99], v[76:79], v[224:239]
  s_xor_b32 s98, 5, s99
  s_mul_i32 s65, s98, 245760
  s_add_u32 m0, s91, 98304
  s_add_u32 s65, s65, s94
  buffer_load_dwordx4 v24, s[32:35], s65 offen  lds
  v_mfma_f32_32x32x16_bf16 v[240:255], v[100:103], v[76:79], v[240:255]
  v_lshl_add_u32 v46, v30, 3, s71
  v_cmp_gt_u32 vcc, 32, v1
  s_nop 1
  v_cndmask_b32 v122, v47, v46, vcc
  v_lshl_add_u32 v47, v1, 4, s70
  s_waitcnt lgkmcnt(0)
  v_mfma_f32_32x32x16_bf16 v[128:143], v[104:107], v[80:83], v[128:143]
  ds_read_b64_tr_b16 v[96:97], v14 offset:16384
  ds_read_b64_tr_b16 v[98:99], v14 offset:18432
  s_lshl_b32 s64, s98, 7
  s_add_u32 m0, s81, 98304
  s_add_u32 s64, s64, s93
  buffer_load_dwordx4 v20, s[28:31], s64 offen  lds
  v_mfma_f32_32x32x16_bf16 v[144:159], v[108:111], v[80:83], v[144:159]
  ds_read_b128 v[64:67], v4 offset:0
  ds_read_b64_tr_b16 v[100:101], v15 offset:16384
  s_add_u32 m0, s101, 98304
  v_accvgpr_write_b32 a203, v47
  s_mul_i32 s70, s78, 2
  v_mfma_f32_32x32x16_bf16 v[160:175], v[104:107], v[84:87], v[160:175]
  buffer_load_dwordx4 v25, s[32:35], s65 offen  lds
  ds_read_b64_tr_b16 v[102:103], v15 offset:18432
  ds_read_b128 v[68:71], v4 offset:4096
  s_add_u32 s70, s70, s62
  s_mul_i32 s71, s70, 69632
  v_mfma_f32_32x32x16_bf16 v[176:191], v[108:111], v[84:87], v[176:191]
  ds_read_b128 v[72:75], v4 offset:8192
  ds_read_b128 v[76:79], v4 offset:12288
  s_add_u32 m0, s22, 98304
  s_mul_i32 s72, s77, 24576
  s_add_u32 s71, s71, s72
  v_smfmac_f32_16x16x64_bf16 a[220:223], a[236:239], v[104:111], v115
  v_mfma_f32_32x32x16_bf16 v[192:207], v[104:107], v[88:91], v[192:207]
  buffer_load_dwordx4 v26, s[32:35], s65 offen  lds
  v_lshl_add_u32 v47, v1, 4, s71
  v_accvgpr_write_b32 a200, v47
  s_mul_i32 s72, s77, 14336
  s_sub_u32 s79, 49152, s72
  v_mfma_f32_32x32x16_bf16 v[208:223], v[108:111], v[88:91], v[208:223]
  s_add_u32 m0, s83, 98304
  s_lshr_b32 s71, s62, 3
  s_add_u32 s72, s62, 3
  s_lshr_b32 s72, s72, 3
  s_sub_u32 s72, s72, s71
  v_mfma_f32_32x32x16_bf16 v[224:239], v[104:107], v[92:95], v[224:239]
  buffer_load_dwordx4 v21, s[28:31], s64 offen  lds
  s_lshl_b32 s72, s72, 7
  s_lshl_b32 s71, s71, 7
  s_add_u32 s71, s71, 10683392
  v_bfe_u32 v30, v1, 3, 1
  v_mfma_f32_32x32x16_bf16 v[240:255], v[108:111], v[92:95], v[240:255]
  v_mul_lo_u32 v30, s72, v30
  v_and_b32 v46, 7, v1
  v_lshl_add_u32 v30, v46, 2, v30
  v_add_u32 v47, s71, v30
  v_accvgpr_write_b32 a201, v47
  s_waitcnt lgkmcnt(0)
  v_mfma_f32_32x32x16_bf16 v[128:143], v[96:99], v[64:67], v[128:143]
  ds_read_b64_tr_b16 v[104:105], v14 offset:24576
  ds_read_b64_tr_b16 v[106:107], v14 offset:26624
  s_add_u32 m0, s23, 98304
  s_nop 0
  buffer_load_dwordx4 v27, s[32:35], s65 offen  lds
  s_lshl_b32 s70, s70, 4
  v_mfma_f32_32x32x16_bf16 v[144:159], v[100:103], v[64:67], v[144:159]
  ds_read_b128 v[80:83], v5 offset:0
  ds_read_b64_tr_b16 v[108:109], v15 offset:24576
  s_add_u32 m0, s24, 98304
  v_and_b32 v30, 15, v1
  v_add_u32 v30, s70, v30
  v_mfma_f32_32x32x16_bf16 v[160:175], v[96:99], v[68:71], v[160:175]
  buffer_load_dwordx4 v28, s[32:35], s65 offen  lds
  ds_read_b64_tr_b16 v[110:111], v15 offset:26624
  ds_read_b128 v[84:87], v5 offset:4096
  v_mul_u32_u24 v30, 1280, v30
  v_bfe_u32 v46, v1, 4, 1
  v_mfma_f32_32x32x16_bf16 v[176:191], v[100:103], v[68:71], v[176:191]
  ds_read_b128 v[88:91], v5 offset:8192
  ds_read_b128 v[92:95], v5 offset:12288
  s_add_u32 m0, s87, 98304
  v_lshl_add_u32 v46, v46, 1, v31
  v_lshl_add_u32 v30, v46, 4, v30
  v_smfmac_f32_16x16x64_bf16 a[220:223], a[236:239], v[96:103], v115
  v_mfma_f32_32x32x16_bf16 v[192:207], v[96:99], v[72:75], v[192:207]
  buffer_load_dwordx4 v22, s[28:31], s64 offen  lds
  s_lshl_b32 s70, s63, 7
  s_lshl_b32 s71, s77, 6
  s_add_u32 s70, s70, s71
  v_add_u32 v47, s70, v30
  v_mfma_f32_32x32x16_bf16 v[208:223], v[100:103], v[72:75], v[208:223]
  s_add_u32 m0, s25, 98304
  v_mov_b32 v123, v47
  v_accvgpr_write_b32 a202, v47
  v_lshrrev_b32 v46, 4, v1
  v_lshl_add_u32 v124, v46, 3, s70
  v_mfma_f32_32x32x16_bf16 v[224:239], v[96:99], v[76:79], v[224:239]
  buffer_load_dwordx4 v29, s[32:35], s65 offen  lds
  s_lshl_b32 s70, s56, 3
  s_xor_b32 s71, s70, 16
  s_lshr_b32 s72, 0x9080706, s70
  s_and_b32 s72, s72, 31
  v_mfma_f32_32x32x16_bf16 v[240:255], v[100:103], v[76:79], v[240:255]
  s_lshl_b32 s72, s72, 13
  v_lshl_add_u32 v47, v1, 4, s72
  v_accvgpr_write_b32 a204, v47
  s_lshr_b32 s72, 0x9080706, s71
  s_and_b32 s72, s72, 31
  s_waitcnt lgkmcnt(0)
  v_mfma_f32_32x32x16_bf16 v[128:143], v[104:107], v[80:83], v[128:143]
  s_waitcnt vmcnt(9)
  s_barrier
  ds_read_b64_tr_b16 v[96:97], v16 offset:0
  ds_read_b64_tr_b16 v[98:99], v16 offset:2048
  ds_read_b128 v[64:67], v6 offset:0
  v_mfma_f32_32x32x16_bf16 v[144:159], v[108:111], v[80:83], v[144:159]
  ds_read_b64_tr_b16 v[100:101], v17 offset:0
  ds_read_b64_tr_b16 v[102:103], v17 offset:2048
  ds_read_b128 v[68:71], v6 offset:4096
  s_add_u32 m0, s66, 98304
  s_nop 0
  buffer_load_dwordx4 v36, s[32:35], s65 offen  lds
  s_add_u32 m0, s89, 98304
  v_mfma_f32_32x32x16_bf16 v[160:175], v[104:107], v[84:87], v[160:175]
  buffer_load_dwordx4 v23, s[28:31], s64 offen  lds
  ds_read_b128 v[72:75], v6 offset:8192
  ds_read_b128 v[76:79], v6 offset:12288
  s_add_u32 m0, s67, 98304
  v_mfma_f32_32x32x16_bf16 v[176:191], v[108:111], v[84:87], v[176:191]
  buffer_load_dwordx4 v37, s[32:35], s65 offen  lds
  s_lshl_b32 s72, s72, 13
  v_lshl_add_u32 v47, v1, 4, s72
  v_accvgpr_write_b32 a205, v47
  v_smfmac_f32_16x16x64_bf16 a[220:223], a[236:239], v[104:111], v115
  v_mfma_f32_32x32x16_bf16 v[192:207], v[104:107], v[88:91], v[192:207]
  buffer_load_dword v60, off, s[0:3], s54 sc1
  s_lshr_b32 s72, 0x1000b0a, s70
  s_and_b32 s72, s72, 31
  s_lshl_b32 s72, s72, 13
  v_mfma_f32_32x32x16_bf16 v[208:223], v[108:111], v[88:91], v[208:223]
  buffer_load_dword v127, v112, s[40:43], 0 offen
  v_lshl_add_u32 v47, v1, 4, s72
  v_accvgpr_write_b32 a206, v47
  s_lshr_b32 s72, 0x1000b0a, s71
  v_mfma_f32_32x32x16_bf16 v[224:239], v[104:107], v[92:95], v[224:239]
  buffer_load_dword v127, v39, s[44:47], 0 offen
  s_and_b32 s72, s72, 31
  s_lshl_b32 s72, s72, 13
  v_lshl_add_u32 v47, v1, 4, s72
  v_mfma_f32_32x32x16_bf16 v[240:255], v[108:111], v[92:95], v[240:255]
  v_accvgpr_write_b32 a207, v47
  s_lshl_b32 s70, s56, 11
  s_add_u32 s70, s70, 148480
  v_lshrrev_b32 v46, 1, v1
  s_waitcnt lgkmcnt(0)
  v_mfma_f32_32x32x16_bf16 v[128:143], v[96:99], v[64:67], v[128:143]
  ds_read_b64_tr_b16 v[104:105], v16 offset:8192
  ds_read_b64_tr_b16 v[106:107], v16 offset:10240
  s_xor_b32 s98, 6, s99
  s_mul_i32 s65, s98, 245760
  s_add_u32 m0, s91, 0
  s_add_u32 s65, s65, s94
  buffer_load_dwordx4 v24, s[32:35], s65 offen  lds
  v_mfma_f32_32x32x16_bf16 v[144:159], v[100:103], v[64:67], v[144:159]
  ds_read_b128 v[80:83], v7 offset:0
  ds_read_b64_tr_b16 v[108:109], v17 offset:8192
  v_and_b32 v30, 1, v1
  v_lshlrev_b32 v46, 6, v46
  v_lshl_add_u32 v46, v30, 4, v46
  v_mfma_f32_32x32x16_bf16 v[160:175], v[96:99], v[68:71], v[160:175]
  ds_read_b64_tr_b16 v[110:111], v17 offset:10240
  ds_read_b128 v[84:87], v7 offset:4096
  s_lshl_b32 s64, s98, 7
  s_add_u32 m0, s81, 0
  s_add_u32 s64, s64, s93
  buffer_load_dwordx4 v20, s[28:31], s64 offen  lds
  v_mfma_f32_32x32x16_bf16 v[176:191], v[100:103], v[68:71], v[176:191]
  ds_read_b128 v[88:91], v7 offset:8192
  ds_read_b128 v[92:95], v7 offset:12288
  s_add_u32 m0, s101, 0
  v_add_u32 v47, s70, v46
  v_accvgpr_write_b32 a208, v47
  v_smfmac_f32_16x16x64_bf16 a[220:223], a[236:239], v[96:103], v115
  v_mfma_f32_32x32x16_bf16 v[192:207], v[96:99], v[72:75], v[192:207]
  buffer_load_dwordx4 v25, s[32:35], s65 offen  lds
  v_lshlrev_b32 v30, 6, v1
  v_subrev_u32 v46, 1520, v30
  v_mfma_f32_32x32x16_bf16 v[208:223], v[100:103], v[72:75], v[208:223]
  s_add_u32 m0, s22, 0
  v_cmp_gt_u32 vcc, 24, v1
  v_lshlrev_b32 v47, 7, v1
  v_subrev_u32 v47, 6112, v47
  v_cndmask_b32 v30, v46, v30, vcc
  v_mfma_f32_32x32x16_bf16 v[224:239], v[96:99], v[76:79], v[224:239]
  buffer_load_dwordx4 v26, s[32:35], s65 offen  lds
  v_mfma_f32_32x32x16_bf16 v[240:255], v[100:103], v[76:79], v[240:255]
  v_cmp_gt_u32 vcc, 48, v1
  s_mov_b32 s71, 0x55032014
  s_nop 0
  v_cndmask_b32 v30, v47, v30, vcc
  v_cndmask_b32 v46, 64, 8, vcc
  s_waitcnt lgkmcnt(0)
  v_mfma_f32_32x32x16_bf16 v[128:143], v[104:107], v[80:83], v[128:143]
  ds_read_b64_tr_b16 v[96:97], v16 offset:16384
  ds_read_b64_tr_b16 v[98:99], v16 offset:18432
  s_add_u32 m0, s83, 0
  s_nop 0
  buffer_load_dwordx4 v21, s[28:31], s64 offen  lds
  v_add_u32 v47, s70, v30
  v_mfma_f32_32x32x16_bf16 v[144:159], v[108:111], v[80:83], v[144:159]
  ds_read_b128 v[64:67], v8 offset:0
  ds_read_b64_tr_b16 v[100:101], v17 offset:16384
  v_accvgpr_write_b32 a209, v47
  v_add_u32 v47, v47, v46
  v_accvgpr_write_b32 a210, v47
  v_mfma_f32_32x32x16_bf16 v[160:175], v[104:107], v[84:87], v[160:175]
  ds_read_b64_tr_b16 v[102:103], v17 offset:18432
  ds_read_b128 v[68:71], v8 offset:4096
  s_cmp_eq_u32 s78, 0
  s_cselect_b32 s71, s71, 0x55043120
  v_bfe_u32 v30, v1, 2, 3
  v_mfma_f32_32x32x16_bf16 v[176:191], v[108:111], v[84:87], v[176:191]
  ds_read_b128 v[72:75], v8 offset:8192
  ds_read_b128 v[76:79], v8 offset:12288
  v_lshlrev_b32 v30, 2, v30
  v_lshrrev_b32 v30, v30, s71
  v_and_b32 v30, 7, v30
  v_smfmac_f32_16x16x64_bf16 a[220:223], a[236:239], v[104:111], v115
  v_mfma_f32_32x32x16_bf16 v[192:207], v[104:107], v[88:91], v[192:207]
  v_and_b32 v46, 3, v1
  v_lshl_add_u32 v30, v30, 2, v46
  v_min_u32 v30, 20, v30
  v_lshlrev_b32 v30, 6, v30
  v_add_u32 v30, s70, v30
  v_mfma_f32_32x32x16_bf16 v[208:223], v[108:111], v[88:91], v[208:223]
  v_lshl_add_u32 v47, v31, 4, v30
  v_accvgpr_write_b32 a211, v47
  v_lshlrev_b32 v46, 4, v31
  v_sub_u32 v47, v30, v46
  v_accvgpr_write_b32 a212, v47
  v_mfma_f32_32x32x16_bf16 v[224:239], v[104:107], v[92:95], v[224:239]
  s_lshl_b32 s70, s58, 2
  s_add_u32 s70, s70, s56
  s_mul_i32 s70, s70, 5
  s_add_u32 s71, s70, 1
  s_lshr_b32 s71, s71, 1
  v_mfma_f32_32x32x16_bf16 v[240:255], v[108:111], v[92:95], v[240:255]
  s_cmp_eq_u32 s78, 0
  s_cselect_b32 s72, 4, 0
  s_add_u32 s70, s70, s72
  s_lshl_b32 s72, s57, 3
  v_bfe_u32 v30, v1, 4, 1
  s_waitcnt lgkmcnt(0)
  v_mfma_f32_32x32x16_bf16 v[128:143], v[96:99], v[64:67], v[128:143]
  ds_read_b64_tr_b16 v[104:105], v16 offset:24576
  ds_read_b64_tr_b16 v[106:107], v16 offset:26624
  v_add_u32 v30, s72, v30
  v_mul_u32_u24 v30, 69632, v30
  v_and_b32 v46, 15, v1
  v_mfma_f32_32x32x16_bf16 v[144:159], v[100:103], v[64:67], v[144:159]
  ds_read_b128 v[80:83], v9 offset:0
  ds_read_b64_tr_b16 v[108:109], v17 offset:24576
  v_lshl_add_u32 v30, v46, 4, v30
  v_add_u32 v30, 49152, v30
  v_add_u32 v46, s71, v31
  v_mfma_f32_32x32x16_bf16 v[160:175], v[96:99], v[68:71], v[160:175]
  ds_read_b64_tr_b16 v[110:111], v17 offset:26624
  ds_read_b128 v[84:87], v9 offset:4096
  v_lshl_add_u32 v47, v46, 8, v30
  v_accvgpr_write_b32 a213, v47
  s_lshr_b32 s71, s70, 1
  v_mfma_f32_32x32x16_bf16 v[176:191], v[100:103], v[68:71], v[176:191]
  ds_read_b128 v[88:91], v9 offset:8192
  ds_read_b128 v[92:95], v9 offset:12288
  s_lshl_b32 s71, s71, 8
  s_and_b32 s70, s70, 1
  s_lshl_b32 s70, s70, 3
  v_smfmac_f32_16x16x64_bf16 a[220:223], a[236:239], v[96:103], v115
  v_mfma_f32_32x32x16_bf16 v[192:207], v[96:99], v[72:75], v[192:207]
  s_add_u32 s70, s70, s71
  v_add_u32 v46, s70, v30
  v_mov_b32 v47, 0x40000000
  v_cndmask_b32 v47, v46, v47, s[84:85]
  v_accvgpr_write_b32 a214, v47
  v_mfma_f32_32x32x16_bf16 v[208:223], v[100:103], v[72:75], v[208:223]
  s_lshl_b32 s70, s57, 7
  s_lshl_b32 s71, s58, 2
  s_add_u32 s70, s70, s71
  s_add_u32 s70, s70, 10685440
  v_mov_b32 v47, 0x40000000
  v_mfma_f32_32x32x16_bf16 v[224:239], v[96:99], v[76:79], v[224:239]
  v_mov_b32 v30, s70
  v_cmp_eq_u32 vcc, 0, v0
  s_nop 1
  v_cndmask_b32 v47, v47, v30, vcc
  v_accvgpr_write_b32 a215, v47
  v_mfma_f32_32x32x16_bf16 v[240:255], v[100:103], v[76:79], v[240:255]
  s_lshl_b32 s70, s58, 2
  s_add_u32 s70, s70, s56
  s_and_b32 s70, s70, 30
  s_mul_i32 s70, s70, 640
  s_add_u32 s70, s70, 49664
  s_waitcnt lgkmcnt(0)
  v_mfma_f32_32x32x16_bf16 v[128:143], v[104:107], v[80:83], v[128:143]
  s_waitcnt vmcnt(8)
  s_barrier
  ds_read_b64_tr_b16 v[96:97], v18 offset:0
  ds_read_b64_tr_b16 v[98:99], v18 offset:2048
  ds_read_b128 v[64:67], v10 offset:0
  v_mfma_f32_32x32x16_bf16 v[144:159], v[108:111], v[80:83], v[144:159]
  ds_read_b64_tr_b16 v[100:101], v19 offset:0
  ds_read_b64_tr_b16 v[102:103], v19 offset:2048
  ds_read_b128 v[68:71], v10 offset:4096
  s_add_u32 m0, s23, 0
  s_nop 0
  buffer_load_dwordx4 v27, s[32:35], s65 offen  lds
  s_add_u32 m0, s24, 0
  v_mfma_f32_32x32x16_bf16 v[160:175], v[104:107], v[84:87], v[160:175]
  buffer_load_dwordx4 v28, s[32:35], s65 offen  lds
  ds_read_b128 v[72:75], v10 offset:8192
  ds_read_b128 v[76:79], v10 offset:12288
  s_lshl_b32 s71, s57, 3
  v_mfma_f32_32x32x16_bf16 v[176:191], v[108:111], v[84:87], v[176:191]
  s_add_u32 m0, s87, 0
  v_bfe_u32 v30, v1, 1, 3
  v_add_u32 v30, s71, v30
  v_mul_u32_u24 v30, 69632, v30
  v_smfmac_f32_16x16x64_bf16 a[220:223], a[236:239], v[104:111], v115
  v_mfma_f32_32x32x16_bf16 v[192:207], v[104:107], v[88:91], v[192:207]
  buffer_load_dwordx4 v22, s[28:31], s64 offen  lds
  v_and_b32 v46, 1, v1
  v_lshl_add_u32 v30, v46, 7, v30
  v_add_u32 v47, s70, v30
  v_mfma_f32_32x32x16_bf16 v[208:223], v[108:111], v[88:91], v[208:223]
  s_add_u32 m0, s25, 0
  v_mfma_f32_32x32x16_bf16 v[224:239], v[104:107], v[92:95], v[224:239]
  buffer_load_dwordx4 v29, s[32:35], s65 offen  lds
  v_mfma_f32_32x32x16_bf16 v[240:255], v[108:111], v[92:95], v[240:255]
  s_waitcnt lgkmcnt(0)
  v_mfma_f32_32x32x16_bf16 v[128:143], v[96:99], v[64:67], v[128:143]
  ds_read_b64_tr_b16 v[104:105], v18 offset:8192
  ds_read_b64_tr_b16 v[106:107], v18 offset:10240
  s_add_u32 m0, s66, 0
  s_nop 0
  buffer_load_dwordx4 v36, s[32:35], s65 offen  lds
  v_mfma_f32_32x32x16_bf16 v[144:159], v[100:103], v[64:67], v[144:159]
  ds_read_b128 v[80:83], v11 offset:0
  ds_read_b64_tr_b16 v[108:109], v19 offset:8192
  s_add_u32 m0, s89, 0
  v_mfma_f32_32x32x16_bf16 v[160:175], v[96:99], v[68:71], v[160:175]
  buffer_load_dwordx4 v23, s[28:31], s64 offen  lds
  ds_read_b64_tr_b16 v[110:111], v19 offset:10240
  ds_read_b128 v[84:87], v11 offset:4096
  v_mfma_f32_32x32x16_bf16 v[176:191], v[100:103], v[68:71], v[176:191]
  ds_read_b128 v[88:91], v11 offset:8192
  ds_read_b128 v[92:95], v11 offset:12288
  s_add_u32 m0, s67, 0
  v_smfmac_f32_16x16x64_bf16 a[220:223], a[236:239], v[96:103], v115
  v_mfma_f32_32x32x16_bf16 v[192:207], v[96:99], v[72:75], v[192:207]
  buffer_load_dwordx4 v37, s[32:35], s65 offen  lds
  v_mfma_f32_32x32x16_bf16 v[208:223], v[100:103], v[72:75], v[208:223]
  v_mfma_f32_32x32x16_bf16 v[224:239], v[96:99], v[76:79], v[224:239]
  s_xor_b32 s98, 7, s99
  s_mul_i32 s65, s98, 245760
  s_add_u32 m0, s91, 49152
  s_add_u32 s65, s65, s94
  buffer_load_dwordx4 v24, s[32:35], s65 offen  lds
  v_mfma_f32_32x32x16_bf16 v[240:255], v[100:103], v[76:79], v[240:255]
  s_waitcnt lgkmcnt(0)
  v_mfma_f32_32x32x16_bf16 v[128:143], v[104:107], v[80:83], v[128:143]
  ds_read_b64_tr_b16 v[96:97], v18 offset:16384
  ds_read_b64_tr_b16 v[98:99], v18 offset:18432
  s_lshl_b32 s64, s98, 7
  s_add_u32 m0, s81, 49152
  s_add_u32 s64, s64, s93
  buffer_load_dwordx4 v20, s[28:31], s64 offen  lds
  v_mfma_f32_32x32x16_bf16 v[144:159], v[108:111], v[80:83], v[144:159]
  ds_read_b128 v[64:67], v12 offset:0
  ds_read_b64_tr_b16 v[100:101], v19 offset:16384
  s_add_u32 m0, s101, 49152
  v_mfma_f32_32x32x16_bf16 v[160:175], v[104:107], v[84:87], v[160:175]
  buffer_load_dwordx4 v25, s[32:35], s65 offen  lds
  ds_read_b64_tr_b16 v[102:103], v19 offset:18432
  ds_read_b128 v[68:71], v12 offset:4096
  v_mfma_f32_32x32x16_bf16 v[176:191], v[108:111], v[84:87], v[176:191]
  ds_read_b128 v[72:75], v12 offset:8192
  ds_read_b128 v[76:79], v12 offset:12288
  s_add_u32 m0, s22, 49152
  v_smfmac_f32_16x16x64_bf16 a[220:223], a[236:239], v[104:111], v115
  v_mfma_f32_32x32x16_bf16 v[192:207], v[104:107], v[88:91], v[192:207]
  buffer_load_dwordx4 v26, s[32:35], s65 offen  lds
  v_mfma_f32_32x32x16_bf16 v[208:223], v[108:111], v[88:91], v[208:223]
  s_add_u32 m0, s83, 49152
  v_mfma_f32_32x32x16_bf16 v[224:239], v[104:107], v[92:95], v[224:239]
  buffer_load_dwordx4 v21, s[28:31], s64 offen  lds
  v_mfma_f32_32x32x16_bf16 v[240:255], v[108:111], v[92:95], v[240:255]
  s_waitcnt lgkmcnt(0)
  v_mfma_f32_32x32x16_bf16 v[128:143], v[96:99], v[64:67], v[128:143]
  ds_read_b64_tr_b16 v[104:105], v18 offset:24576
  ds_read_b64_tr_b16 v[106:107], v18 offset:26624
  s_add_u32 m0, s23, 49152
  s_nop 0
  buffer_load_dwordx4 v27, s[32:35], s65 offen  lds
  v_mfma_f32_32x32x16_bf16 v[144:159], v[100:103], v[64:67], v[144:159]
  ds_read_b128 v[80:83], v13 offset:0
  ds_read_b64_tr_b16 v[108:109], v19 offset:24576
  s_add_u32 m0, s24, 49152
  v_mfma_f32_32x32x16_bf16 v[160:175], v[96:99], v[68:71], v[160:175]
  buffer_load_dwordx4 v28, s[32:35], s65 offen  lds
  ds_read_b64_tr_b16 v[110:111], v19 offset:26624
  ds_read_b128 v[84:87], v13 offset:4096
  v_mfma_f32_32x32x16_bf16 v[176:191], v[100:103], v[68:71], v[176:191]
  ds_read_b128 v[88:91], v13 offset:8192
  ds_read_b128 v[92:95], v13 offset:12288
  s_add_u32 m0, s87, 49152
  v_smfmac_f32_16x16x64_bf16 a[220:223], a[236:239], v[96:103], v115
  v_mfma_f32_32x32x16_bf16 v[192:207], v[96:99], v[72:75], v[192:207]
  buffer_load_dwordx4 v22, s[28:31], s64 offen  lds
  v_mfma_f32_32x32x16_bf16 v[208:223], v[100:103], v[72:75], v[208:223]
  s_add_u32 m0, s25, 49152
  v_mfma_f32_32x32x16_bf16 v[224:239], v[96:99], v[76:79], v[224:239]
  buffer_load_dwordx4 v29, s[32:35], s65 offen  lds
  v_mfma_f32_32x32x16_bf16 v[240:255], v[100:103], v[76:79], v[240:255]
  s_waitcnt lgkmcnt(0)
  v_mfma_f32_32x32x16_bf16 v[128:143], v[104:107], v[80:83], v[128:143]
  s_waitcnt vmcnt(9)
  s_barrier
  ds_read_b64_tr_b16 v[96:97], v14 offset:0
  ds_read_b64_tr_b16 v[98:99], v14 offset:2048
  ds_read_b128 v[64:67], v2 offset:0
  v_mfma_f32_32x32x16_bf16 v[144:159], v[108:111], v[80:83], v[144:159]
  ds_read_b64_tr_b16 v[100:101], v15 offset:0
  ds_read_b64_tr_b16 v[102:103], v15 offset:2048
  ds_read_b128 v[68:71], v2 offset:4096
  s_add_u32 m0, s66, 49152
  s_nop 0
  buffer_load_dwordx4 v36, s[32:35], s65 offen  lds
  s_add_u32 m0, s89, 49152
  v_mfma_f32_32x32x16_bf16 v[160:175], v[104:107], v[84:87], v[160:175]
  buffer_load_dwordx4 v23, s[28:31], s64 offen  lds
  ds_read_b128 v[72:75], v2 offset:8192
  ds_read_b128 v[76:79], v2 offset:12288
  s_add_u32 m0, s67, 49152
  v_mfma_f32_32x32x16_bf16 v[176:191], v[108:111], v[84:87], v[176:191]
  buffer_load_dwordx4 v37, s[32:35], s65 offen  lds
  v_smfmac_f32_16x16x64_bf16 a[220:223], a[236:239], v[104:111], v115
  v_mfma_f32_32x32x16_bf16 v[192:207], v[104:107], v[88:91], v[192:207]
  v_mfma_f32_32x32x16_bf16 v[208:223], v[108:111], v[88:91], v[208:223]
  global_load_dwordx2 a[216:217], v124, s[18:19]
  v_mfma_f32_32x32x16_bf16 v[224:239], v[104:107], v[92:95], v[224:239]
  global_load_dwordx2 a[218:219], v124, s[18:19] offset:32
  v_mfma_f32_32x32x16_bf16 v[240:255], v[108:111], v[92:95], v[240:255]
  s_waitcnt lgkmcnt(0)
  v_mfma_f32_32x32x16_bf16 v[128:143], v[96:99], v[64:67], v[128:143]
  ds_read_b64_tr_b16 v[104:105], v14 offset:8192
  ds_read_b64_tr_b16 v[106:107], v14 offset:10240
  s_xor_b32 s98, 8, s100
  s_mul_i32 s65, s98, 245760
  s_add_u32 m0, s91, 98304
  s_add_u32 s65, s65, s94
  buffer_load_dwordx4 v24, s[32:35], s65 offen  lds
  v_mfma_f32_32x32x16_bf16 v[144:159], v[100:103], v[64:67], v[144:159]
  ds_read_b128 v[80:83], v3 offset:0
  ds_read_b64_tr_b16 v[108:109], v15 offset:8192
  v_mfma_f32_32x32x16_bf16 v[160:175], v[96:99], v[68:71], v[160:175]
  ds_read_b64_tr_b16 v[110:111], v15 offset:10240
  ds_read_b128 v[84:87], v3 offset:4096
  s_lshl_b32 s64, s98, 7
  s_add_u32 m0, s81, 98304
  s_add_u32 s64, s64, s93
  buffer_load_dwordx4 v20, s[28:31], s64 offen  lds
  v_mfma_f32_32x32x16_bf16 v[176:191], v[100:103], v[68:71], v[176:191]
  ds_read_b128 v[88:91], v3 offset:8192
  ds_read_b128 v[92:95], v3 offset:12288
  s_add_u32 m0, s101, 98304
  v_smfmac_f32_16x16x64_bf16 a[220:223], a[236:239], v[96:103], v115
  v_mfma_f32_32x32x16_bf16 v[192:207], v[96:99], v[72:75], v[192:207]
  buffer_load_dwordx4 v25, s[32:35], s65 offen  lds
  v_mfma_f32_32x32x16_bf16 v[208:223], v[100:103], v[72:75], v[208:223]
  s_add_u32 m0, s22, 98304
  v_mfma_f32_32x32x16_bf16 v[224:239], v[96:99], v[76:79], v[224:239]
  buffer_load_dwordx4 v26, s[32:35], s65 offen  lds
  v_mfma_f32_32x32x16_bf16 v[240:255], v[100:103], v[76:79], v[240:255]
  s_waitcnt lgkmcnt(0)
  v_mfma_f32_32x32x16_bf16 v[128:143], v[104:107], v[80:83], v[128:143]
  ds_read_b64_tr_b16 v[96:97], v14 offset:16384
  ds_read_b64_tr_b16 v[98:99], v14 offset:18432
  s_add_u32 m0, s83, 98304
  s_nop 0
  buffer_load_dwordx4 v21, s[28:31], s64 offen  lds
  v_mfma_f32_32x32x16_bf16 v[144:159], v[108:111], v[80:83], v[144:159]
  ds_read_b128 v[64:67], v4 offset:0
  ds_read_b64_tr_b16 v[100:101], v15 offset:16384
  v_mfma_f32_32x32x16_bf16 v[160:175], v[104:107], v[84:87], v[160:175]
  ds_read_b64_tr_b16 v[102:103], v15 offset:18432
  ds_read_b128 v[68:71], v4 offset:4096
  v_mfma_f32_32x32x16_bf16 v[176:191], v[108:111], v[84:87], v[176:191]
  ds_read_b128 v[72:75], v4 offset:8192
  ds_read_b128 v[76:79], v4 offset:12288
  v_smfmac_f32_16x16x64_bf16 a[220:223], a[236:239], v[104:111], v115
  v_mfma_f32_32x32x16_bf16 v[192:207], v[104:107], v[88:91], v[192:207]
  v_mfma_f32_32x32x16_bf16 v[208:223], v[108:111], v[88:91], v[208:223]
  v_mfma_f32_32x32x16_bf16 v[224:239], v[104:107], v[92:95], v[224:239]
  v_mfma_f32_32x32x16_bf16 v[240:255], v[108:111], v[92:95], v[240:255]
  s_waitcnt lgkmcnt(0)
  v_mfma_f32_32x32x16_bf16 v[128:143], v[96:99], v[64:67], v[128:143]
  ds_read_b64_tr_b16 v[104:105], v14 offset:24576
  ds_read_b64_tr_b16 v[106:107], v14 offset:26624
  v_mfma_f32_32x32x16_bf16 v[144:159], v[100:103], v[64:67], v[144:159]
  ds_read_b128 v[80:83], v5 offset:0
  ds_read_b64_tr_b16 v[108:109], v15 offset:24576
  v_mfma_f32_32x32x16_bf16 v[160:175], v[96:99], v[68:71], v[160:175]
  ds_read_b64_tr_b16 v[110:111], v15 offset:26624
  ds_read_b128 v[84:87], v5 offset:4096
  v_mfma_f32_32x32x16_bf16 v[176:191], v[100:103], v[68:71], v[176:191]
  ds_read_b128 v[88:91], v5 offset:8192
  ds_read_b128 v[92:95], v5 offset:12288
  v_smfmac_f32_16x16x64_bf16 a[220:223], a[236:239], v[96:103], v115
  v_mfma_f32_32x32x16_bf16 v[192:207], v[96:99], v[72:75], v[192:207]
  v_mfma_f32_32x32x16_bf16 v[208:223], v[100:103], v[72:75], v[208:223]
  v_mfma_f32_32x32x16_bf16 v[224:239], v[96:99], v[76:79], v[224:239]
  v_mfma_f32_32x32x16_bf16 v[240:255], v[100:103], v[76:79], v[240:255]
  s_waitcnt lgkmcnt(0)
  v_mfma_f32_32x32x16_bf16 v[128:143], v[104:107], v[80:83], v[128:143]
  s_waitcnt vmcnt(7)
  v_cmp_gt_u32 vcc, s53, v60
  s_nop 0
  s_cmp_eq_u64 vcc, 0
  s_cbranch_scc0 Lslow_1
Lback_2:
  s_barrier
  ds_read_b64_tr_b16 v[96:97], v16 offset:0
  ds_read_b64_tr_b16 v[98:99], v16 offset:2048
  ds_read_b128 v[64:67], v6 offset:0
  v_mfma_f32_32x32x16_bf16 v[144:159], v[108:111], v[80:83], v[144:159]
  ds_read_b64_tr_b16 v[100:101], v17 offset:0
  ds_read_b64_tr_b16 v[102:103], v17 offset:2048
  ds_read_b128 v[68:71], v6 offset:4096
  s_add_u32 m0, s23, 98304
  s_nop 0
  buffer_load_dwordx4 v27, s[32:35], s65 offen  lds
  s_add_u32 m0, s24, 98304
  v_mfma_f32_32x32x16_bf16 v[160:175], v[104:107], v[84:87], v[160:175]
  buffer_load_dwordx4 v28, s[32:35], s65 offen  lds
  ds_read_b128 v[72:75], v6 offset:8192
  ds_read_b128 v[76:79], v6 offset:12288
  v_mfma_f32_32x32x16_bf16 v[176:191], v[108:111], v[84:87], v[176:191]
  s_add_u32 m0, s87, 98304
  v_smfmac_f32_16x16x64_bf16 a[220:223], a[236:239], v[104:111], v115
  v_mfma_f32_32x32x16_bf16 v[192:207], v[104:107], v[88:91], v[192:207]
  buffer_load_dwordx4 v22, s[28:31], s64 offen  lds
  v_mfma_f32_32x32x16_bf16 v[208:223], v[108:111], v[88:91], v[208:223]
  s_add_u32 m0, s25, 98304
  v_mfma_f32_32x32x16_bf16 v[224:239], v[104:107], v[92:95], v[224:239]
  buffer_load_dwordx4 v29, s[32:35], s65 offen  lds
  v_mfma_f32_32x32x16_bf16 v[240:255], v[108:111], v[92:95], v[240:255]
  s_waitcnt lgkmcnt(0)
  v_mfma_f32_32x32x16_bf16 v[128:143], v[96:99], v[64:67], v[128:143]
  ds_read_b64_tr_b16 v[104:105], v16 offset:8192
  ds_read_b64_tr_b16 v[106:107], v16 offset:10240
  s_add_u32 m0, s66, 98304
  s_nop 0
  buffer_load_dwordx4 v36, s[32:35], s65 offen  lds
  v_mfma_f32_32x32x16_bf16 v[144:159], v[100:103], v[64:67], v[144:159]
  ds_read_b128 v[80:83], v7 offset:0
  ds_read_b64_tr_b16 v[108:109], v17 offset:8192
  s_add_u32 m0, s89, 98304
  v_mfma_f32_32x32x16_bf16 v[160:175], v[96:99], v[68:71], v[160:175]
  buffer_load_dwordx4 v23, s[28:31], s64 offen  lds
  ds_read_b64_tr_b16 v[110:111], v17 offset:10240
  ds_read_b128 v[84:87], v7 offset:4096
  v_mfma_f32_32x32x16_bf16 v[176:191], v[100:103], v[68:71], v[176:191]
  ds_read_b128 v[88:91], v7 offset:8192
  ds_read_b128 v[92:95], v7 offset:12288
  s_add_u32 m0, s67, 98304
  v_smfmac_f32_16x16x64_bf16 a[220:223], a[236:239], v[96:103], v115
  v_mfma_f32_32x32x16_bf16 v[192:207], v[96:99], v[72:75], v[192:207]
  buffer_load_dwordx4 v37, s[32:35], s65 offen  lds
  v_mfma_f32_32x32x16_bf16 v[208:223], v[100:103], v[72:75], v[208:223]
  v_mfma_f32_32x32x16_bf16 v[224:239], v[96:99], v[76:79], v[224:239]
  s_xor_b32 s98, 9, s100
  s_mul_i32 s65, s98, 245760
  s_add_u32 m0, s91, 0
  s_add_u32 s65, s65, s94
  buffer_load_dwordx4 v24, s[32:35], s65 offen  lds
  v_mfma_f32_32x32x16_bf16 v[240:255], v[100:103], v[76:79], v[240:255]
  s_waitcnt lgkmcnt(0)
  v_mfma_f32_32x32x16_bf16 v[128:143], v[104:107], v[80:83], v[128:143]
  ds_read_b64_tr_b16 v[96:97], v16 offset:16384
  ds_read_b64_tr_b16 v[98:99], v16 offset:18432
  s_lshl_b32 s64, s98, 7
  s_add_u32 m0, s81, 0
  s_add_u32 s64, s64, s93
  buffer_load_dwordx4 v20, s[28:31], s64 offen  lds
  v_mfma_f32_32x32x16_bf16 v[144:159], v[108:111], v[80:83], v[144:159]
  ds_read_b128 v[64:67], v8 offset:0
  ds_read_b64_tr_b16 v[100:101], v17 offset:16384
  s_add_u32 m0, s101, 0
  v_mfma_f32_32x32x16_bf16 v[160:175], v[104:107], v[84:87], v[160:175]
  buffer_load_dwordx4 v25, s[32:35], s65 offen  lds
  ds_read_b64_tr_b16 v[102:103], v17 offset:18432
  ds_read_b128 v[68:71], v8 offset:4096
  v_mfma_f32_32x32x16_bf16 v[176:191], v[108:111], v[84:87], v[176:191]
  ds_read_b128 v[72:75], v8 offset:8192
  ds_read_b128 v[76:79], v8 offset:12288
  s_add_u32 m0, s22, 0
  v_smfmac_f32_16x16x64_bf16 a[220:223], a[236:239], v[104:111], v115
  v_mfma_f32_32x32x16_bf16 v[192:207], v[104:107], v[88:91], v[192:207]
  buffer_load_dwordx4 v26, s[32:35], s65 offen  lds
  v_mfma_f32_32x32x16_bf16 v[208:223], v[108:111], v[88:91], v[208:223]
  s_add_u32 m0, s83, 0
  v_mfma_f32_32x32x16_bf16 v[224:239], v[104:107], v[92:95], v[224:239]
  buffer_load_dwordx4 v21, s[28:31], s64 offen  lds
  v_mfma_f32_32x32x16_bf16 v[240:255], v[108:111], v[92:95], v[240:255]
  s_waitcnt lgkmcnt(0)
  v_mfma_f32_32x32x16_bf16 v[128:143], v[96:99], v[64:67], v[128:143]
  ds_read_b64_tr_b16 v[104:105], v16 offset:24576
  ds_read_b64_tr_b16 v[106:107], v16 offset:26624
  s_add_u32 m0, s23, 0
  s_nop 0
  buffer_load_dwordx4 v27, s[32:35], s65 offen  lds
  v_mfma_f32_32x32x16_bf16 v[144:159], v[100:103], v[64:67], v[144:159]
  ds_read_b128 v[80:83], v9 offset:0
  ds_read_b64_tr_b16 v[108:109], v17 offset:24576
  s_add_u32 m0, s24, 0
  v_mfma_f32_32x32x16_bf16 v[160:175], v[96:99], v[68:71], v[160:175]
  buffer_load_dwordx4 v28, s[32:35], s65 offen  lds
  ds_read_b64_tr_b16 v[110:111], v17 offset:26624
  ds_read_b128 v[84:87], v9 offset:4096
  v_mfma_f32_32x32x16_bf16 v[176:191], v[100:103], v[68:71], v[176:191]
  ds_read_b128 v[88:91], v9 offset:8192
  ds_read_b128 v[92:95], v9 offset:12288
  s_add_u32 m0, s87, 0
  v_smfmac_f32_16x16x64_bf16 a[220:223], a[236:239], v[96:103], v115
  v_mfma_f32_32x32x16_bf16 v[192:207], v[96:99], v[72:75], v[192:207]
  buffer_load_dwordx4 v22, s[28:31], s64 offen  lds
  v_mfma_f32_32x32x16_bf16 v[208:223], v[100:103], v[72:75], v[208:223]
  s_add_u32 m0, s25, 0
  v_mfma_f32_32x32x16_bf16 v[224:239], v[96:99], v[76:79], v[224:239]
  buffer_load_dwordx4 v29, s[32:35], s65 offen  lds
  v_mfma_f32_32x32x16_bf16 v[240:255], v[100:103], v[76:79], v[240:255]
  s_waitcnt lgkmcnt(0)
  v_mfma_f32_32x32x16_bf16 v[128:143], v[104:107], v[80:83], v[128:143]
  s_waitcnt vmcnt(9)
  s_barrier
  ds_read_b64_tr_b16 v[96:97], v18 offset:0
  ds_read_b64_tr_b16 v[98:99], v18 offset:2048
  ds_read_b128 v[64:67], v10 offset:0
  v_mfma_f32_32x32x16_bf16 v[144:159], v[108:111], v[80:83], v[144:159]
  ds_read_b64_tr_b16 v[100:101], v19 offset:0
  ds_read_b64_tr_b16 v[102:103], v19 offset:2048
  ds_read_b128 v[68:71], v10 offset:4096
  s_add_u32 m0, s66, 0
  s_nop 0
  buffer_load_dwordx4 v36, s[32:35], s65 offen  lds
  s_add_u32 m0, s89, 0
  v_mfma_f32_32x32x16_bf16 v[160:175], v[104:107], v[84:87], v[160:175]
  buffer_load_dwordx4 v23, s[28:31], s64 offen  lds
  ds_read_b128 v[72:75], v10 offset:8192
  ds_read_b128 v[76:79], v10 offset:12288
  v_mfma_f32_32x32x16_bf16 v[176:191], v[108:111], v[84:87], v[176:191]
  s_add_u32 m0, s67, 0
  v_smfmac_f32_16x16x64_bf16 a[220:223], a[236:239], v[104:111], v115
  v_mfma_f32_32x32x16_bf16 v[192:207], v[104:107], v[88:91], v[192:207]
  buffer_load_dwordx4 v37, s[32:35], s65 offen  lds
  v_mfma_f32_32x32x16_bf16 v[208:223], v[108:111], v[88:91], v[208:223]
  v_mfma_f32_32x32x16_bf16 v[224:239], v[104:107], v[92:95], v[224:239]
  buffer_load_dwordx2 v[60:61], v62, s[36:39], s54 offen sc1
  v_mfma_f32_32x32x16_bf16 v[240:255], v[108:111], v[92:95], v[240:255]
  s_waitcnt lgkmcnt(0)
  v_mfma_f32_32x32x16_bf16 v[128:143], v[96:99], v[64:67], v[128:143]
  ds_read_b64_tr_b16 v[104:105], v18 offset:8192
  ds_read_b64_tr_b16 v[106:107], v18 offset:10240
  s_add_u32 m0, s76, 49152
  s_mul_i32 s17, s4, 40
  buffer_load_dwordx4 v48, s[40:43], s17 offen  lds
  v_mfma_f32_32x32x16_bf16 v[144:159], v[100:103], v[64:67], v[144:159]
  ds_read_b128 v[80:83], v11 offset:0
  ds_read_b64_tr_b16 v[108:109], v19 offset:8192
  v_mfma_f32_32x32x16_bf16 v[160:175], v[96:99], v[68:71], v[160:175]
  ds_read_b64_tr_b16 v[110:111], v19 offset:10240
  ds_read_b128 v[84:87], v11 offset:4096
  buffer_load_dwordx4 v49, s[40:43], s17 offen offset:1024  lds
  v_mfma_f32_32x32x16_bf16 v[176:191], v[100:103], v[68:71], v[176:191]
  ds_read_b128 v[88:91], v11 offset:8192
  ds_read_b128 v[92:95], v11 offset:12288
  v_smfmac_f32_16x16x64_bf16 a[220:223], a[236:239], v[96:103], v115
  v_mfma_f32_32x32x16_bf16 v[192:207], v[96:99], v[72:75], v[192:207]
  s_add_u32 m0, s76, 57344
  s_mul_i32 s17, s4, 40
  s_add_u32 s17, s17, 40960
  buffer_load_dwordx4 v48, s[40:43], s17 offen  lds
  v_mfma_f32_32x32x16_bf16 v[208:223], v[100:103], v[72:75], v[208:223]
  v_mfma_f32_32x32x16_bf16 v[224:239], v[96:99], v[76:79], v[224:239]
  buffer_load_dwordx4 v49, s[40:43], s17 offen offset:1024  lds
  v_mfma_f32_32x32x16_bf16 v[240:255], v[100:103], v[76:79], v[240:255]
  s_waitcnt lgkmcnt(0)
  v_mfma_f32_32x32x16_bf16 v[128:143], v[104:107], v[80:83], v[128:143]
  ds_read_b64_tr_b16 v[96:97], v18 offset:16384
  ds_read_b64_tr_b16 v[98:99], v18 offset:18432
  s_add_u32 m0, s76, 65536
  s_mul_i32 s17, s4, 40
  s_add_u32 s17, s17, 81920
  buffer_load_dwordx4 v48, s[40:43], s17 offen  lds
  v_mfma_f32_32x32x16_bf16 v[144:159], v[108:111], v[80:83], v[144:159]
  ds_read_b128 v[64:67], v12 offset:0
  ds_read_b64_tr_b16 v[100:101], v19 offset:16384
  v_mfma_f32_32x32x16_bf16 v[160:175], v[104:107], v[84:87], v[160:175]
  ds_read_b64_tr_b16 v[102:103], v19 offset:18432
  ds_read_b128 v[68:71], v12 offset:4096
  buffer_load_dwordx4 v49, s[40:43], s17 offen offset:1024  lds
  v_mfma_f32_32x32x16_bf16 v[176:191], v[108:111], v[84:87], v[176:191]
  ds_read_b128 v[72:75], v12 offset:8192
  ds_read_b128 v[76:79], v12 offset:12288
  v_smfmac_f32_16x16x64_bf16 a[220:223], a[236:239], v[104:111], v115
  v_mfma_f32_32x32x16_bf16 v[192:207], v[104:107], v[88:91], v[192:207]
  s_add_u32 m0, s76, 73728
  s_mul_i32 s17, s5, 40
  buffer_load_dwordx4 v48, s[40:43], s17 offen  lds
  v_mfma_f32_32x32x16_bf16 v[208:223], v[108:111], v[88:91], v[208:223]
  v_mfma_f32_32x32x16_bf16 v[224:239], v[104:107], v[92:95], v[224:239]
  buffer_load_dwordx4 v49, s[40:43], s17 offen offset:1024  lds
  v_mfma_f32_32x32x16_bf16 v[240:255], v[108:111], v[92:95], v[240:255]
  s_waitcnt lgkmcnt(0)
  v_mfma_f32_32x32x16_bf16 v[128:143], v[96:99], v[64:67], v[128:143]
  ds_read_b64_tr_b16 v[104:105], v18 offset:24576
  ds_read_b64_tr_b16 v[106:107], v18 offset:26624
  s_add_u32 m0, s76, 81920
  s_mul_i32 s17, s5, 40
  s_add_u32 s17, s17, 40960
  buffer_load_dwordx4 v48, s[40:43], s17 offen  lds
  v_mfma_f32_32x32x16_bf16 v[144:159], v[100:103], v[64:67], v[144:159]
  ds_read_b128 v[80:83], v13 offset:0
  ds_read_b64_tr_b16 v[108:109], v19 offset:24576
  v_mfma_f32_32x32x16_bf16 v[160:175], v[96:99], v[68:71], v[160:175]
  ds_read_b64_tr_b16 v[110:111], v19 offset:26624
  ds_read_b128 v[84:87], v13 offset:4096
  buffer_load_dwordx4 v49, s[40:43], s17 offen offset:1024  lds
  v_mfma_f32_32x32x16_bf16 v[176:191], v[100:103], v[68:71], v[176:191]
  ds_read_b128 v[88:91], v13 offset:8192
  ds_read_b128 v[92:95], v13 offset:12288
  v_smfmac_f32_16x16x64_bf16 a[220:223], a[236:239], v[96:103], v115
  v_mfma_f32_32x32x16_bf16 v[192:207], v[96:99], v[72:75], v[192:207]
  s_add_u32 m0, s76, 90112
  s_mul_i32 s17, s5, 40
  s_add_u32 s17, s17, 81920
  buffer_load_dwordx4 v48, s[40:43], s17 offen  lds
  v_mfma_f32_32x32x16_bf16 v[208:223], v[100:103], v[72:75], v[208:223]
  v_mfma_f32_32x32x16_bf16 v[224:239], v[96:99], v[76:79], v[224:239]
  buffer_load_dwordx4 v49, s[40:43], s17 offen offset:1024  lds
  v_mfma_f32_32x32x16_bf16 v[240:255], v[100:103], v[76:79], v[240:255]
  s_waitcnt lgkmcnt(0)
  v_mfma_f32_32x32x16_bf16 v[128:143], v[104:107], v[80:83], v[128:143]
  s_waitcnt vmcnt(12)
  v_and_b32 v60, v60, v61
  v_cmp_gt_u32 vcc, s53, v60
  s_nop 0
  s_cmp_eq_u64 vcc, 0
  s_cbranch_scc0 Lslow_3
Lback_4:
  s_barrier
  ds_read_b64_tr_b16 v[96:97], v14 offset:0
  ds_read_b64_tr_b16 v[98:99], v14 offset:2048
  ds_read_b128 v[64:67], v2 offset:0
  v_mfma_f32_32x32x16_bf16 v[144:159], v[108:111], v[80:83], v[144:159]
  ds_read_b64_tr_b16 v[100:101], v15 offset:0
  ds_read_b64_tr_b16 v[102:103], v15 offset:2048
  ds_read_b128 v[68:71], v2 offset:4096
  buffer_load_dwordx2 v[32:33], v63, s[36:39], 0 offen offset:0 sc1
  v_mfma_f32_32x32x16_bf16 v[160:175], v[104:107], v[84:87], v[160:175]
  ds_read_b128 v[72:75], v2 offset:8192
  ds_read_b128 v[76:79], v2 offset:12288
  buffer_load_dwordx2 v[34:35], v63, s[36:39], 0 offen offset:256 sc1
  v_mfma_f32_32x32x16_bf16 v[176:191], v[108:111], v[84:87], v[176:191]
  buffer_load_dwordx2 v[36:37], v63, s[36:39], 0 offen offset:512 sc1
  v_smfmac_f32_16x16x64_bf16 a[220:223], a[236:239], v[104:111], v115
  v_mfma_f32_32x32x16_bf16 v[192:207], v[104:107], v[88:91], v[192:207]
  v_mfma_f32_32x32x16_bf16 v[208:223], v[108:111], v[88:91], v[208:223]
  buffer_load_dwordx2 v[38:39], v63, s[36:39], 0 offen offset:768 sc1
  v_mfma_f32_32x32x16_bf16 v[224:239], v[104:107], v[92:95], v[224:239]
  s_add_u32 m0, s76, 98304
  s_mul_i32 s17, s6, 40
  buffer_load_dwordx4 v48, s[40:43], s17 offen  lds
  v_mfma_f32_32x32x16_bf16 v[240:255], v[108:111], v[92:95], v[240:255]
  s_waitcnt lgkmcnt(0)
  v_mfma_f32_32x32x16_bf16 v[128:143], v[96:99], v[64:67], v[128:143]
  ds_read_b64_tr_b16 v[104:105], v14 offset:8192
  ds_read_b64_tr_b16 v[106:107], v14 offset:10240
  buffer_load_dwordx4 v49, s[40:43], s17 offen offset:1024  lds
  v_mfma_f32_32x32x16_bf16 v[144:159], v[100:103], v[64:67], v[144:159]
  ds_read_b128 v[80:83], v3 offset:0
  ds_read_b64_tr_b16 v[108:109], v15 offset:8192
  s_add_u32 m0, s76, 106496
  s_mul_i32 s17, s6, 40
  s_add_u32 s17, s17, 40960
  buffer_load_dwordx4 v48, s[40:43], s17 offen  lds
  v_mfma_f32_32x32x16_bf16 v[160:175], v[96:99], v[68:71], v[160:175]
  ds_read_b64_tr_b16 v[110:111], v15 offset:10240
  ds_read_b128 v[84:87], v3 offset:4096
  v_mfma_f32_32x32x16_bf16 v[176:191], v[100:103], v[68:71], v[176:191]
  ds_read_b128 v[88:91], v3 offset:8192
  ds_read_b128 v[92:95], v3 offset:12288
  buffer_load_dwordx4 v49, s[40:43], s17 offen offset:1024  lds
  v_smfmac_f32_16x16x64_bf16 a[220:223], a[236:239], v[96:103], v115
  v_mfma_f32_32x32x16_bf16 v[192:207], v[96:99], v[72:75], v[192:207]
  s_add_u32 m0, s76, 114688
  s_mul_i32 s17, s6, 40
  s_add_u32 s17, s17, 81920
  buffer_load_dwordx4 v48, s[40:43], s17 offen  lds
  v_mfma_f32_32x32x16_bf16 v[208:223], v[100:103], v[72:75], v[208:223]
  v_mfma_f32_32x32x16_bf16 v[224:239], v[96:99], v[76:79], v[224:239]
  buffer_load_dwordx4 v49, s[40:43], s17 offen offset:1024  lds
  v_mfma_f32_32x32x16_bf16 v[240:255], v[100:103], v[76:79], v[240:255]
  s_waitcnt lgkmcnt(0)
  v_mfma_f32_32x32x16_bf16 v[128:143], v[104:107], v[80:83], v[128:143]
  s_waitcnt vmcnt(10)
  s_barrier
  ds_read_b64_tr_b16 v[96:97], v14 offset:16384
  ds_read_b64_tr_b16 v[98:99], v14 offset:18432
  s_add_u32 m0, s76, 122880
  s_mul_i32 s17, s7, 40
  buffer_load_dwordx4 v48, s[40:43], s17 offen  lds
  v_mfma_f32_32x32x16_bf16 v[144:159], v[108:111], v[80:83], v[144:159]
  ds_read_b128 v[64:67], v4 offset:0
  ds_read_b64_tr_b16 v[100:101], v15 offset:16384
  buffer_load_dwordx4 v49, s[40:43], s17 offen offset:1024  lds
  ds_read_b64_tr_b16 a[0:1], v52 offset:49152
  ds_read_b64_tr_b16 a[2:3], v52 offset:51200
  ds_read_b64_tr_b16 a[4:5], v53 offset:49152
  v_mfma_f32_32x32x16_bf16 v[160:175], v[104:107], v[84:87], v[160:175]
  ds_read_b64_tr_b16 v[102:103], v15 offset:18432
  ds_read_b128 v[68:71], v4 offset:4096
  ds_read_b64_tr_b16 a[6:7], v53 offset:51200
  ds_read_b64_tr_b16 a[8:9], v54 offset:49152
  ds_read_b64_tr_b16 a[10:11], v54 offset:51200
  ds_read_b64_tr_b16 a[12:13], v55 offset:49152
  v_mfma_f32_32x32x16_bf16 v[176:191], v[108:111], v[84:87], v[176:191]
  ds_read_b128 v[72:75], v4 offset:8192
  ds_read_b128 v[76:79], v4 offset:12288
  s_add_u32 m0, s76, 131072
  s_mul_i32 s17, s7, 40
  s_add_u32 s17, s17, 40960
  buffer_load_dwordx4 v48, s[40:43], s17 offen  lds
  v_smfmac_f32_16x16x64_bf16 a[220:223], a[236:239], v[104:111], v115
  v_mfma_f32_32x32x16_bf16 v[192:207], v[104:107], v[88:91], v[192:207]
  buffer_load_dwordx4 v49, s[40:43], s17 offen offset:1024  lds
  ds_read_b64_tr_b16 a[14:15], v55 offset:51200
  ds_read_b64_tr_b16 a[16:17], v52 offset:57344
  ds_read_b64_tr_b16 a[18:19], v52 offset:59392
  ds_read_b64_tr_b16 a[20:21], v53 offset:57344
  ds_read_b64_tr_b16 a[22:23], v53 offset:59392
  v_mfma_f32_32x32x16_bf16 v[208:223], v[108:111], v[88:91], v[208:223]
  ds_read_b64_tr_b16 a[24:25], v54 offset:57344
  ds_read_b64_tr_b16 a[26:27], v54 offset:59392
  ds_read_b64_tr_b16 a[28:29], v55 offset:57344
  ds_read_b64_tr_b16 a[30:31], v55 offset:59392
  v_add_u32 v52, 0x10000, v52
  v_add_u32 v53, 0x10000, v53
  v_mfma_f32_32x32x16_bf16 v[224:239], v[104:107], v[92:95], v[224:239]
  s_add_u32 m0, s76, 139264
  s_mul_i32 s17, s7, 40
  s_add_u32 s17, s17, 81920
  buffer_load_dwordx4 v48, s[40:43], s17 offen  lds
  v_add_u32 v54, 0x10000, v54
  v_add_u32 v55, 0x10000, v55
  v_mfma_f32_32x32x16_bf16 v[240:255], v[108:111], v[92:95], v[240:255]
  ds_read_b64_tr_b16 a[32:33], v52 offset:0
  ds_read_b64_tr_b16 a[34:35], v52 offset:2048
  ds_read_b64_tr_b16 a[36:37], v53 offset:0
  ds_read_b64_tr_b16 a[38:39], v53 offset:2048
  ds_read_b64_tr_b16 a[40:41], v54 offset:0
  ds_read_b64_tr_b16 a[42:43], v54 offset:2048
  s_waitcnt lgkmcnt(0)
  v_mfma_f32_32x32x16_bf16 v[128:143], v[96:99], v[64:67], v[128:143]
  ds_read_b64_tr_b16 v[104:105], v14 offset:24576
  ds_read_b64_tr_b16 v[106:107], v14 offset:26624
  buffer_load_dwordx4 v49, s[40:43], s17 offen offset:1024  lds
  ds_read_b64_tr_b16 a[44:45], v55 offset:0
  ds_read_b64_tr_b16 a[46:47], v55 offset:2048
  ds_read_b64_tr_b16 a[48:49], v52 offset:8192
  v_mfma_f32_32x32x16_bf16 v[144:159], v[100:103], v[64:67], v[144:159]
  ds_read_b128 v[80:83], v5 offset:0
  ds_read_b64_tr_b16 v[108:109], v15 offset:24576
  ds_read_b64_tr_b16 a[50:51], v52 offset:10240
  ds_read_b64_tr_b16 a[52:53], v53 offset:8192
  ds_read_b64_tr_b16 a[54:55], v53 offset:10240
  ds_read_b64_tr_b16 a[56:57], v54 offset:8192
  v_mfma_f32_32x32x16_bf16 v[160:175], v[96:99], v[68:71], v[160:175]
  ds_read_b64_tr_b16 v[110:111], v15 offset:26624
  ds_read_b128 v[84:87], v5 offset:4096
  ds_read_b64_tr_b16 a[58:59], v54 offset:10240
  ds_read_b64_tr_b16 a[60:61], v55 offset:8192
  ds_read_b64_tr_b16 a[62:63], v55 offset:10240
  ds_read_b64_tr_b16 a[64:65], v52 offset:16384
  v_mfma_f32_32x32x16_bf16 v[176:191], v[100:103], v[68:71], v[176:191]
  ds_read_b128 v[88:91], v5 offset:8192
  ds_read_b128 v[92:95], v5 offset:12288
  ds_read_b64_tr_b16 a[66:67], v52 offset:18432
  ds_read_b64_tr_b16 a[68:69], v53 offset:16384
  ds_read_b64_tr_b16 a[70:71], v53 offset:18432
  ds_read_b64_tr_b16 a[72:73], v54 offset:16384
  v_smfmac_f32_16x16x64_bf16 a[220:223], a[236:239], v[96:103], v115
  v_mfma_f32_32x32x16_bf16 v[192:207], v[96:99], v[72:75], v[192:207]
  buffer_load_dword v127, v47, s[36:39], 0 offen
  ds_read_b64_tr_b16 a[74:75], v54 offset:18432
  ds_read_b64_tr_b16 a[76:77], v55 offset:16384
  ds_read_b64_tr_b16 a[78:79], v55 offset:18432
  ds_read_b64_tr_b16 a[80:81], v52 offset:24576
  ds_read_b64_tr_b16 a[82:83], v52 offset:26624
  v_mfma_f32_32x32x16_bf16 v[208:223], v[100:103], v[72:75], v[208:223]
  ds_read_b64_tr_b16 a[84:85], v53 offset:24576
  ds_read_b64_tr_b16 a[86:87], v53 offset:26624
  ds_read_b64_tr_b16 a[88:89], v54 offset:24576
  ds_read_b64_tr_b16 a[90:91], v54 offset:26624
  ds_read_b64_tr_b16 a[92:93], v55 offset:24576
  ds_read_b64_tr_b16 a[94:95], v55 offset:26624
  v_mfma_f32_32x32x16_bf16 v[224:239], v[96:99], v[76:79], v[224:239]
  v_mfma_f32_32x32x16_bf16 v[240:255], v[100:103], v[76:79], v[240:255]
  s_waitcnt lgkmcnt(0)
  v_mfma_f32_32x32x16_bf16 v[128:143], v[104:107], v[80:83], v[128:143]
  s_barrier
  v_smfmac_f32_16x16x64_bf16 a[220:223], a[236:239], v[104:111], v115
  v_mfma_f32_32x32x16_bf16 v[144:159], v[108:111], v[80:83], v[144:159]
  v_mfma_f32_32x32x16_bf16 v[160:175], v[104:107], v[84:87], v[160:175]
  s_nop 5
  v_accvgpr_read_b32 v40, a220
  v_accvgpr_read_b32 v41, a221
  v_accvgpr_read_b32 v42, a222
  v_accvgpr_read_b32 v43, a223
  v_mfma_f32_32x32x16_bf16 v[176:191], v[108:111], v[84:87], v[176:191]
  v_add_f32 v40, v40, v41
  v_add_f32 v42, v42, v43
  v_mfma_f32_32x32x16_bf16 v[192:207], v[104:107], v[88:91], v[192:207]
  ds_write2_b32 v113, v40, v42 offset0:0 offset1:16
  v_mfma_f32_32x32x16_bf16 v[208:223], v[108:111], v[88:91], v[208:223]
  ds_read_b128 v[2:5], v114 offset:0
  ds_read_b128 v[6:9], v114 offset:32
  ds_read_b128 v[10:13], v114 offset:64
  v_mfma_f32_32x32x16_bf16 v[224:239], v[104:107], v[92:95], v[224:239]
  v_mfma_f32_32x32x16_bf16 v[240:255], v[108:111], v[92:95], v[240:255]
  s_waitcnt lgkmcnt(0)
LQpost:
  s_nop 0
  ds_read_b128 v[104:107], v114 offset:160
  ds_read_b128 v[108:111], v114 offset:192
  ds_read_b128 v[96:99], v114 offset:96
  ds_read_b128 v[100:103], v114 offset:128
  ds_read_b128 v[112:115], v114 offset:224
  v_mov_b32 v30, 0x3f80
  s_waitcnt vmcnt(13)
  s_nop 0
  v_pk_fma_f32 v[14:15], v[2:3], v[32:33], s[82:83] op_sel:[0,1,0] op_sel_hi:[1,1,0] neg_lo:[0,0,1] neg_hi:[0,0,1]
  v_pk_fma_f32 v[16:17], v[4:5], v[32:33], s[82:83] op_sel:[0,1,0] op_sel_hi:[1,1,0] neg_lo:[0,0,1] neg_hi:[0,0,1]
  v_pk_fma_f32 v[18:19], v[6:7], v[32:33], s[82:83] op_sel:[0,1,0] op_sel_hi:[1,1,0] neg_lo:[0,0,1] neg_hi:[0,0,1]
  v_pk_fma_f32 v[20:21], v[8:9], v[32:33], s[82:83] op_sel:[0,1,0] op_sel_hi:[1,1,0] neg_lo:[0,0,1] neg_hi:[0,0,1]
  v_pk_fma_f32 v[22:23], v[10:11], v[32:33], s[82:83] op_sel:[0,1,0] op_sel_hi:[1,1,0] neg_lo:[0,0,1] neg_hi:[0,0,1]
  v_pk_fma_f32 v[24:25], v[12:13], v[32:33], s[82:83] op_sel:[0,1,0] op_sel_hi:[1,1,0] neg_lo:[0,0,1] neg_hi:[0,0,1]
  v_pk_fma_f32 v[128:129], v[128:129], v[32:33], v[14:15] op_sel:[0,0,0] op_sel_hi:[1,0,1] neg_lo:[0,0,1] neg_hi:[0,0,1]
  v_pk_fma_f32 v[130:131], v[130:131], v[32:33], v[16:17] op_sel:[0,0,0] op_sel_hi:[1,0,1] neg_lo:[0,0,1] neg_hi:[0,0,1]
  v_pk_fma_f32 v[132:133], v[132:133], v[32:33], v[18:19] op_sel:[0,0,0] op_sel_hi:[1,0,1] neg_lo:[0,0,1] neg_hi:[0,0,1]
  v_pk_fma_f32 v[134:135], v[134:135], v[32:33], v[20:21] op_sel:[0,0,0] op_sel_hi:[1,0,1] neg_lo:[0,0,1] neg_hi:[0,0,1]
  v_pk_fma_f32 v[136:137], v[136:137], v[32:33], v[22:23] op_sel:[0,0,0] op_sel_hi:[1,0,1] neg_lo:[0,0,1] neg_hi:[0,0,1]
  v_pk_fma_f32 v[138:139], v[138:139], v[32:33], v[24:25] op_sel:[0,0,0] op_sel_hi:[1,0,1] neg_lo:[0,0,1] neg_hi:[0,0,1]
  v_pk_mul_f32 v[14:15], v[128:129], s[80:81] op_sel_hi:[1,0]
  v_pk_mul_f32 v[16:17], v[130:131], s[80:81] op_sel_hi:[1,0]
  v_pk_mul_f32 v[18:19], v[132:133], s[80:81] op_sel_hi:[1,0]
  v_pk_mul_f32 v[20:21], v[134:135], s[80:81] op_sel_hi:[1,0]
  v_pk_mul_f32 v[22:23], v[136:137], s[80:81] op_sel_hi:[1,0]
  v_pk_mul_f32 v[24:25], v[138:139], s[80:81] op_sel_hi:[1,0]
  v_exp_f32 v14, v14 clamp
  v_exp_f32 v15, v15 clamp
  v_exp_f32 v16, v16 clamp
  v_exp_f32 v17, v17 clamp
  v_exp_f32 v18, v18 clamp
  v_exp_f32 v19, v19 clamp
  v_exp_f32 v20, v20 clamp
  v_exp_f32 v21, v21 clamp
  v_exp_f32 v22, v22 clamp
  v_exp_f32 v23, v23 clamp
  v_exp_f32 v24, v24 clamp
  v_exp_f32 v25, v25 clamp
  v_max_f32 v128, s82, v128
  v_max_f32 v129, s82, v129
  v_max_f32 v130, s82, v130
  v_max_f32 v131, s82, v131
  v_max_f32 v132, s82, v132
  v_max_f32 v133, s82, v133
  v_max_f32 v134, s82, v134
  v_max_f32 v135, s82, v135
  v_max_f32 v136, s82, v136
  v_max_f32 v137, s82, v137
  v_max_f32 v138, s82, v138
  v_max_f32 v139, s82, v139
  v_pk_add_f32 v[128:129], v[128:129], v[14:15]
  v_pk_add_f32 v[130:131], v[130:131], v[16:17]
  v_pk_add_f32 v[132:133], v[132:133], v[18:19]
  v_pk_add_f32 v[134:135], v[134:135], v[20:21]
  v_pk_add_f32 v[136:137], v[136:137], v[22:23]
  v_pk_add_f32 v[138:139], v[138:139], v[24:25]
  v_cvt_pk_bf16_f32 v94, v128, v129
  v_cvt_pk_bf16_f32 v95, v130, v131
  v_cvt_pk_bf16_f32 v60, v132, v133
  v_cvt_pk_bf16_f32 v61, v134, v135
  v_cvt_pk_bf16_f32 v68, v136, v137
  v_cvt_pk_bf16_f32 v69, v138, v139
  s_waitcnt lgkmcnt(0)
  s_mov_b32 s75, 0
  buffer_load_dwordx4 a[228:231], v123, s[28:31], s75 offen
  s_mov_b32 s75, 20480
  buffer_load_dwordx4 a[236:239], v123, s[28:31], s75 offen
  s_add_u32 m0, s76, 16384
  s_mul_i32 s17, s8, 40
  s_nop 0
  buffer_load_dwordx4 v48, s[40:43], s17 offen  lds
  buffer_load_dwordx4 v49, s[40:43], s17 offen offset:1024  lds
  ds_write_b64 v116, v[94:95]
  ds_write_b64 v117, v[60:61]
  ds_write_b64 v118, v[68:69]
  v_pk_mul_f32 v[14:15], v[104:105], v[32:33] op_sel:[0,1] op_sel_hi:[1,1]
  v_pk_mul_f32 v[16:17], v[106:107], v[32:33] op_sel:[0,1] op_sel_hi:[1,1]
  v_pk_mul_f32 v[18:19], v[108:109], v[32:33] op_sel:[0,1] op_sel_hi:[1,1]
  v_pk_mul_f32 v[20:21], v[110:111], v[32:33] op_sel:[0,1] op_sel_hi:[1,1]
  v_pk_mul_f32 v[22:23], v[112:113], v[32:33] op_sel:[0,1] op_sel_hi:[1,1]
  v_pk_mul_f32 v[24:25], v[114:115], v[32:33] op_sel:[0,1] op_sel_hi:[1,1]
  v_pk_fma_f32 v[148:149], v[148:149], v[32:33], v[14:15] op_sel:[0,0,0] op_sel_hi:[1,0,1] neg_lo:[0,0,1] neg_hi:[0,0,1]
  v_pk_fma_f32 v[150:151], v[150:151], v[32:33], v[16:17] op_sel:[0,0,0] op_sel_hi:[1,0,1] neg_lo:[0,0,1] neg_hi:[0,0,1]
  v_pk_fma_f32 v[152:153], v[152:153], v[32:33], v[18:19] op_sel:[0,0,0] op_sel_hi:[1,0,1] neg_lo:[0,0,1] neg_hi:[0,0,1]
  v_pk_fma_f32 v[154:155], v[154:155], v[32:33], v[20:21] op_sel:[0,0,0] op_sel_hi:[1,0,1] neg_lo:[0,0,1] neg_hi:[0,0,1]
  v_pk_fma_f32 v[156:157], v[156:157], v[32:33], v[22:23] op_sel:[0,0,0] op_sel_hi:[1,0,1] neg_lo:[0,0,1] neg_hi:[0,0,1]
  v_pk_fma_f32 v[158:159], v[158:159], v[32:33], v[24:25] op_sel:[0,0,0] op_sel_hi:[1,0,1] neg_lo:[0,0,1] neg_hi:[0,0,1]
  v_cvt_pk_bf16_f32 v148, v148, v149
  v_cvt_pk_bf16_f32 v149, v150, v151
  v_cvt_pk_bf16_f32 v152, v152, v153
  v_cvt_pk_bf16_f32 v153, v154, v155
  v_cvt_pk_bf16_f32 v156, v156, v157
  v_cvt_pk_bf16_f32 v157, v158, v159
  v_cndmask_b32 v156, v156, v30, s[84:85]
  s_add_u32 m0, s76, 24576
  s_mul_i32 s17, s8, 40
  s_add_u32 s17, s17, 40960
  buffer_load_dwordx4 v48, s[40:43], s17 offen  lds
  buffer_load_dwordx4 v49, s[40:43], s17 offen offset:1024  lds
  s_add_u32 m0, s76, 32768
  s_mul_i32 s17, s8, 40
  s_add_u32 s17, s17, 81920
  buffer_load_dwordx4 v48, s[40:43], s17 offen  lds
  buffer_load_dwordx4 v49, s[40:43], s17 offen offset:1024  lds
  ds_write_b64 v116, v[148:149] offset:2048
  ds_write_b64 v117, v[152:153] offset:2048
  ds_write_b64 v118, v[156:157] offset:2048
  ds_read_b64_tr_b16 v[90:91], v119 offset:0
  ds_read_b64_tr_b16 v[40:41], v119 offset:2048
  ds_read_b64_tr_b16 v[92:93], v120 offset:0
  ds_read_b64_tr_b16 v[42:43], v120 offset:2048
  ds_read_b64_tr_b16 v[26:27], v119 offset:1024
  ds_read_b64_tr_b16 v[44:45], v119 offset:3072
  ds_read_b64_tr_b16 v[28:29], v120 offset:1024
  ds_read_b64_tr_b16 v[46:47], v120 offset:3072
  v_pk_fma_f32 v[14:15], v[2:3], v[34:35], s[82:83] op_sel:[0,1,0] op_sel_hi:[1,1,0] neg_lo:[0,0,1] neg_hi:[0,0,1]
  v_pk_fma_f32 v[16:17], v[4:5], v[34:35], s[82:83] op_sel:[0,1,0] op_sel_hi:[1,1,0] neg_lo:[0,0,1] neg_hi:[0,0,1]
  v_pk_fma_f32 v[18:19], v[6:7], v[34:35], s[82:83] op_sel:[0,1,0] op_sel_hi:[1,1,0] neg_lo:[0,0,1] neg_hi:[0,0,1]
  v_pk_fma_f32 v[20:21], v[8:9], v[34:35], s[82:83] op_sel:[0,1,0] op_sel_hi:[1,1,0] neg_lo:[0,0,1] neg_hi:[0,0,1]
  v_pk_fma_f32 v[22:23], v[10:11], v[34:35], s[82:83] op_sel:[0,1,0] op_sel_hi:[1,1,0] neg_lo:[0,0,1] neg_hi:[0,0,1]
  v_pk_fma_f32 v[24:25], v[12:13], v[34:35], s[82:83] op_sel:[0,1,0] op_sel_hi:[1,1,0] neg_lo:[0,0,1] neg_hi:[0,0,1]
  v_pk_fma_f32 v[160:161], v[160:161], v[34:35], v[14:15] op_sel:[0,0,0] op_sel_hi:[1,0,1] neg_lo:[0,0,1] neg_hi:[0,0,1]
  v_pk_fma_f32 v[162:163], v[162:163], v[34:35], v[16:17] op_sel:[0,0,0] op_sel_hi:[1,0,1] neg_lo:[0,0,1] neg_hi:[0,0,1]
  v_pk_fma_f32 v[164:165], v[164:165], v[34:35], v[18:19] op_sel:[0,0,0] op_sel_hi:[1,0,1] neg_lo:[0,0,1] neg_hi:[0,0,1]
  v_pk_fma_f32 v[166:167], v[166:167], v[34:35], v[20:21] op_sel:[0,0,0] op_sel_hi:[1,0,1] neg_lo:[0,0,1] neg_hi:[0,0,1]
  v_pk_fma_f32 v[168:169], v[168:169], v[34:35], v[22:23] op_sel:[0,0,0] op_sel_hi:[1,0,1] neg_lo:[0,0,1] neg_hi:[0,0,1]
  v_pk_fma_f32 v[170:171], v[170:171], v[34:35], v[24:25] op_sel:[0,0,0] op_sel_hi:[1,0,1] neg_lo:[0,0,1] neg_hi:[0,0,1]
  v_pk_mul_f32 v[14:15], v[160:161], s[80:81] op_sel_hi:[1,0]
  v_pk_mul_f32 v[16:17], v[162:163], s[80:81] op_sel_hi:[1,0]
  v_pk_mul_f32 v[18:19], v[164:165], s[80:81] op_sel_hi:[1,0]
  v_pk_mul_f32 v[20:21], v[166:167], s[80:81] op_sel_hi:[1,0]
  v_pk_mul_f32 v[22:23], v[168:169], s[80:81] op_sel_hi:[1,0]
  v_pk_mul_f32 v[24:25], v[170:171], s[80:81] op_sel_hi:[1,0]
  v_exp_f32 v14, v14 clamp
  v_exp_f32 v15, v15 clamp
  v_exp_f32 v16, v16 clamp
  v_exp_f32 v17, v17 clamp
  v_exp_f32 v18, v18 clamp
  v_exp_f32 v19, v19 clamp
  v_exp_f32 v20, v20 clamp
  v_exp_f32 v21, v21 clamp
  v_exp_f32 v22, v22 clamp
  v_exp_f32 v23, v23 clamp
  v_exp_f32 v24, v24 clamp
  v_exp_f32 v25, v25 clamp
  s_waitcnt lgkmcnt(0)
  v_mfma_f32_32x32x16_bf16 a[240:255], v[90:93], v[40:43], 0
  v_mfma_f32_32x32x16_bf16 a[240:255], v[26:29], v[44:47], a[240:255]
  v_max_f32 v160, s82, v160
  v_max_f32 v161, s82, v161
  v_max_f32 v162, s82, v162
  v_max_f32 v163, s82, v163
  v_max_f32 v164, s82, v164
  v_max_f32 v165, s82, v165
  v_max_f32 v166, s82, v166
  v_max_f32 v167, s82, v167
  v_max_f32 v168, s82, v168
  v_max_f32 v169, s82, v169
  v_max_f32 v170, s82, v170
  v_max_f32_e64 v171, s82, v171
  v_pk_add_f32 v[160:161], v[160:161], v[14:15]
  v_pk_add_f32 v[162:163], v[162:163], v[16:17]
  v_pk_add_f32 v[164:165], v[164:165], v[18:19]
  v_pk_add_f32 v[166:167], v[166:167], v[20:21]
  v_pk_add_f32 v[168:169], v[168:169], v[22:23]
  v_pk_add_f32 v[170:171], v[170:171], v[24:25]
  v_cvt_pk_bf16_f32 v94, v160, v161
  v_cvt_pk_bf16_f32 v95, v162, v163
  v_cvt_pk_bf16_f32 v60, v164, v165
  v_cvt_pk_bf16_f32 v61, v166, v167
  v_cvt_pk_bf16_f32 v74, v168, v169
  v_cvt_pk_bf16_f32 v75, v170, v171
  s_add_u32 m0, s76, 40960
  s_mul_i32 s17, s9, 40
  buffer_load_dwordx4 v48, s[40:43], s17 offen  lds
  buffer_load_dwordx4 v49, s[40:43], s17 offen offset:1024  lds
  s_add_u32 m0, s76, 49152
  s_mul_i32 s17, s9, 40
  s_add_u32 s17, s17, 40960
  buffer_load_dwordx4 v48, s[40:43], s17 offen  lds
  buffer_load_dwordx4 v49, s[40:43], s17 offen offset:1024  lds
  ds_write_b64 v116, v[94:95]
  ds_write_b64 v117, v[60:61]
  ds_write_b64 v118, v[74:75]
  v_pk_mul_f32 v[14:15], v[104:105], v[34:35] op_sel:[0,1] op_sel_hi:[1,1]
  v_pk_mul_f32 v[16:17], v[106:107], v[34:35] op_sel:[0,1] op_sel_hi:[1,1]
  v_pk_mul_f32 v[18:19], v[108:109], v[34:35] op_sel:[0,1] op_sel_hi:[1,1]
  v_pk_mul_f32 v[20:21], v[110:111], v[34:35] op_sel:[0,1] op_sel_hi:[1,1]
  v_pk_mul_f32 v[22:23], v[112:113], v[34:35] op_sel:[0,1] op_sel_hi:[1,1]
  v_pk_mul_f32 v[24:25], v[114:115], v[34:35] op_sel:[0,1] op_sel_hi:[1,1]
  v_pk_fma_f32 v[180:181], v[180:181], v[34:35], v[14:15] op_sel:[0,0,0] op_sel_hi:[1,0,1] neg_lo:[0,0,1] neg_hi:[0,0,1]
  v_pk_fma_f32 v[182:183], v[182:183], v[34:35], v[16:17] op_sel:[0,0,0] op_sel_hi:[1,0,1] neg_lo:[0,0,1] neg_hi:[0,0,1]
  v_pk_fma_f32 v[184:185], v[184:185], v[34:35], v[18:19] op_sel:[0,0,0] op_sel_hi:[1,0,1] neg_lo:[0,0,1] neg_hi:[0,0,1]
  v_pk_fma_f32 v[186:187], v[186:187], v[34:35], v[20:21] op_sel:[0,0,0] op_sel_hi:[1,0,1] neg_lo:[0,0,1] neg_hi:[0,0,1]
  v_pk_fma_f32 v[188:189], v[188:189], v[34:35], v[22:23] op_sel:[0,0,0] op_sel_hi:[1,0,1] neg_lo:[0,0,1] neg_hi:[0,0,1]
  v_pk_fma_f32 v[190:191], v[190:191], v[34:35], v[24:25] op_sel:[0,0,0] op_sel_hi:[1,0,1] neg_lo:[0,0,1] neg_hi:[0,0,1]
  v_cvt_pk_bf16_f32 v180, v180, v181
  v_cvt_pk_bf16_f32 v181, v182, v183
  v_cvt_pk_bf16_f32 v184, v184, v185
  v_cvt_pk_bf16_f32 v185, v186, v187
  v_cvt_pk_bf16_f32 v188, v188, v189
  v_cvt_pk_bf16_f32 v189, v190, v191
  v_cndmask_b32 v188, v188, v30, s[84:85]
  s_add_u32 m0, s76, 57344
  s_mul_i32 s17, s9, 40
  s_nop 0
  s_add_u32 s17, s17, 81920
  buffer_load_dwordx4 v48, s[40:43], s17 offen  lds
  buffer_load_dwordx4 v49, s[40:43], s17 offen offset:1024  lds
  ds_write_b64 v116, v[180:181] offset:2048
  ds_write_b64 v117, v[184:185] offset:2048
  ds_write_b64 v118, v[188:189] offset:2048
  ds_read_b64_tr_b16 v[90:91], v119 offset:0
  ds_read_b64_tr_b16 v[40:41], v119 offset:2048
  ds_read_b64_tr_b16 v[92:93], v120 offset:0
  ds_read_b64_tr_b16 v[42:43], v120 offset:2048
  ds_read_b64_tr_b16 v[26:27], v119 offset:1024
  ds_read_b64_tr_b16 v[44:45], v119 offset:3072
  ds_read_b64_tr_b16 v[28:29], v120 offset:1024
  ds_read_b64_tr_b16 v[46:47], v120 offset:3072
  v_pk_fma_f32 v[14:15], v[2:3], v[36:37], s[82:83] op_sel:[0,1,0] op_sel_hi:[1,1,0] neg_lo:[0,0,1] neg_hi:[0,0,1]
  v_pk_fma_f32 v[16:17], v[4:5], v[36:37], s[82:83] op_sel:[0,1,0] op_sel_hi:[1,1,0] neg_lo:[0,0,1] neg_hi:[0,0,1]
  v_pk_fma_f32 v[18:19], v[6:7], v[36:37], s[82:83] op_sel:[0,1,0] op_sel_hi:[1,1,0] neg_lo:[0,0,1] neg_hi:[0,0,1]
  v_pk_fma_f32 v[20:21], v[8:9], v[36:37], s[82:83] op_sel:[0,1,0] op_sel_hi:[1,1,0] neg_lo:[0,0,1] neg_hi:[0,0,1]
  v_pk_fma_f32 v[22:23], v[10:11], v[36:37], s[82:83] op_sel:[0,1,0] op_sel_hi:[1,1,0] neg_lo:[0,0,1] neg_hi:[0,0,1]
  v_pk_fma_f32 v[24:25], v[12:13], v[36:37], s[82:83] op_sel:[0,1,0] op_sel_hi:[1,1,0] neg_lo:[0,0,1] neg_hi:[0,0,1]
  v_pk_fma_f32 v[192:193], v[192:193], v[36:37], v[14:15] op_sel:[0,0,0] op_sel_hi:[1,0,1] neg_lo:[0,0,1] neg_hi:[0,0,1]
  v_pk_fma_f32 v[194:195], v[194:195], v[36:37], v[16:17] op_sel:[0,0,0] op_sel_hi:[1,0,1] neg_lo:[0,0,1] neg_hi:[0,0,1]
  v_pk_fma_f32 v[196:197], v[196:197], v[36:37], v[18:19] op_sel:[0,0,0] op_sel_hi:[1,0,1] neg_lo:[0,0,1] neg_hi:[0,0,1]
  v_pk_fma_f32 v[198:199], v[198:199], v[36:37], v[20:21] op_sel:[0,0,0] op_sel_hi:[1,0,1] neg_lo:[0,0,1] neg_hi:[0,0,1]
  v_pk_fma_f32 v[200:201], v[200:201], v[36:37], v[22:23] op_sel:[0,0,0] op_sel_hi:[1,0,1] neg_lo:[0,0,1] neg_hi:[0,0,1]
  v_pk_fma_f32 v[202:203], v[202:203], v[36:37], v[24:25] op_sel:[0,0,0] op_sel_hi:[1,0,1] neg_lo:[0,0,1] neg_hi:[0,0,1]
  v_pk_mul_f32 v[14:15], v[192:193], s[80:81] op_sel_hi:[1,0]
  v_pk_mul_f32 v[16:17], v[194:195], s[80:81] op_sel_hi:[1,0]
  v_pk_mul_f32 v[18:19], v[196:197], s[80:81] op_sel_hi:[1,0]
  v_pk_mul_f32 v[20:21], v[198:199], s[80:81] op_sel_hi:[1,0]
  v_pk_mul_f32 v[22:23], v[200:201], s[80:81] op_sel_hi:[1,0]
  v_pk_mul_f32 v[24:25], v[202:203], s[80:81] op_sel_hi:[1,0]
  v_exp_f32 v14, v14 clamp
  v_exp_f32 v15, v15 clamp
  v_exp_f32 v16, v16 clamp
  v_exp_f32 v17, v17 clamp
  v_exp_f32 v18, v18 clamp
  v_exp_f32 v19, v19 clamp
  v_exp_f32 v20, v20 clamp
  v_exp_f32 v21, v21 clamp
  v_exp_f32 v22, v22 clamp
  v_exp_f32 v23, v23 clamp
  v_exp_f32 v24, v24 clamp
  v_exp_f32 v25, v25 clamp
  s_waitcnt lgkmcnt(0)
  v_mfma_f32_32x32x16_bf16 a[240:255], v[90:93], v[40:43], a[240:255]
  v_mfma_f32_32x32x16_bf16 a[240:255], v[26:29], v[44:47], a[240:255]
  v_max_f32 v192, s82, v192
  v_max_f32 v193, s82, v193
  v_max_f32 v194, s82, v194
  v_max_f32 v195, s82, v195
  v_max_f32 v196, s82, v196
  v_max_f32 v197, s82, v197
  v_max_f32 v198, s82, v198
  v_max_f32 v199, s82, v199
  v_max_f32 v200, s82, v200
  v_max_f32 v201, s82, v201
  v_max_f32 v202, s82, v202
  v_max_f32_e64 v203, s82, v203
  v_pk_add_f32 v[192:193], v[192:193], v[14:15]
  v_pk_add_f32 v[194:195], v[194:195], v[16:17]
  v_pk_add_f32 v[196:197], v[196:197], v[18:19]
  v_pk_add_f32 v[198:199], v[198:199], v[20:21]
  v_pk_add_f32 v[200:201], v[200:201], v[22:23]
  v_pk_add_f32 v[202:203], v[202:203], v[24:25]
  v_cvt_pk_bf16_f32 v94, v192, v193
  v_cvt_pk_bf16_f32 v95, v194, v195
  v_cvt_pk_bf16_f32 v60, v196, v197
  v_cvt_pk_bf16_f32 v61, v198, v199
  v_cvt_pk_bf16_f32 v80, v200, v201
  v_cvt_pk_bf16_f32 v81, v202, v203
  s_add_u32 m0, s76, 65536
  s_mul_i32 s17, s20, 40
  s_nop 0
  buffer_load_dwordx4 v48, s[40:43], s17 offen  lds
  buffer_load_dwordx4 v49, s[40:43], s17 offen offset:1024  lds
  ds_write_b64 v116, v[94:95]
  ds_write_b64 v117, v[60:61]
  ds_write_b64 v118, v[80:81]
  v_pk_mul_f32 v[14:15], v[104:105], v[36:37] op_sel:[0,1] op_sel_hi:[1,1]
  v_pk_mul_f32 v[16:17], v[106:107], v[36:37] op_sel:[0,1] op_sel_hi:[1,1]
  v_pk_mul_f32 v[18:19], v[108:109], v[36:37] op_sel:[0,1] op_sel_hi:[1,1]
  v_pk_mul_f32 v[20:21], v[110:111], v[36:37] op_sel:[0,1] op_sel_hi:[1,1]
  v_pk_mul_f32 v[22:23], v[112:113], v[36:37] op_sel:[0,1] op_sel_hi:[1,1]
  v_pk_mul_f32 v[24:25], v[114:115], v[36:37] op_sel:[0,1] op_sel_hi:[1,1]
  v_pk_fma_f32 v[212:213], v[212:213], v[36:37], v[14:15] op_sel:[0,0,0] op_sel_hi:[1,0,1] neg_lo:[0,0,1] neg_hi:[0,0,1]
  v_pk_fma_f32 v[214:215], v[214:215], v[36:37], v[16:17] op_sel:[0,0,0] op_sel_hi:[1,0,1] neg_lo:[0,0,1] neg_hi:[0,0,1]
  v_pk_fma_f32 v[216:217], v[216:217], v[36:37], v[18:19] op_sel:[0,0,0] op_sel_hi:[1,0,1] neg_lo:[0,0,1] neg_hi:[0,0,1]
  v_pk_fma_f32 v[218:219], v[218:219], v[36:37], v[20:21] op_sel:[0,0,0] op_sel_hi:[1,0,1] neg_lo:[0,0,1] neg_hi:[0,0,1]
  v_pk_fma_f32 v[220:221], v[220:221], v[36:37], v[22:23] op_sel:[0,0,0] op_sel_hi:[1,0,1] neg_lo:[0,0,1] neg_hi:[0,0,1]
  v_pk_fma_f32 v[222:223], v[222:223], v[36:37], v[24:25] op_sel:[0,0,0] op_sel_hi:[1,0,1] neg_lo:[0,0,1] neg_hi:[0,0,1]
  v_cvt_pk_bf16_f32 v212, v212, v213
  v_cvt_pk_bf16_f32 v213, v214, v215
  v_cvt_pk_bf16_f32 v216, v216, v217
  v_cvt_pk_bf16_f32 v217, v218, v219
  v_cvt_pk_bf16_f32 v220, v220, v221
  v_cvt_pk_bf16_f32 v221, v222, v223
  v_cndmask_b32 v220, v220, v30, s[84:85]
  s_add_u32 m0, s76, 73728
  s_mul_i32 s17, s20, 40
  s_nop 0
  s_add_u32 s17, s17, 40960
  buffer_load_dwordx4 v48, s[40:43], s17 offen  lds
  buffer_load_dwordx4 v49, s[40:43], s17 offen offset:1024  lds
  ds_write_b64 v116, v[212:213] offset:2048
  ds_write_b64 v117, v[216:217] offset:2048
  ds_write_b64 v118, v[220:221] offset:2048
  ds_read_b64_tr_b16 v[90:91], v119 offset:0
  ds_read_b64_tr_b16 v[40:41], v119 offset:2048
  ds_read_b64_tr_b16 v[92:93], v120 offset:0
  ds_read_b64_tr_b16 v[42:43], v120 offset:2048
  ds_read_b64_tr_b16 v[26:27], v119 offset:1024
  ds_read_b64_tr_b16 v[44:45], v119 offset:3072
  ds_read_b64_tr_b16 v[28:29], v120 offset:1024
  ds_read_b64_tr_b16 v[46:47], v120 offset:3072
  v_pk_fma_f32 v[14:15], v[2:3], v[38:39], s[82:83] op_sel:[0,1,0] op_sel_hi:[1,1,0] neg_lo:[0,0,1] neg_hi:[0,0,1]
  v_pk_fma_f32 v[16:17], v[4:5], v[38:39], s[82:83] op_sel:[0,1,0] op_sel_hi:[1,1,0] neg_lo:[0,0,1] neg_hi:[0,0,1]
  v_pk_fma_f32 v[18:19], v[6:7], v[38:39], s[82:83] op_sel:[0,1,0] op_sel_hi:[1,1,0] neg_lo:[0,0,1] neg_hi:[0,0,1]
  v_pk_fma_f32 v[20:21], v[8:9], v[38:39], s[82:83] op_sel:[0,1,0] op_sel_hi:[1,1,0] neg_lo:[0,0,1] neg_hi:[0,0,1]
  v_pk_fma_f32 v[22:23], v[10:11], v[38:39], s[82:83] op_sel:[0,1,0] op_sel_hi:[1,1,0] neg_lo:[0,0,1] neg_hi:[0,0,1]
  v_pk_fma_f32 v[24:25], v[12:13], v[38:39], s[82:83] op_sel:[0,1,0] op_sel_hi:[1,1,0] neg_lo:[0,0,1] neg_hi:[0,0,1]
  v_pk_fma_f32 v[224:225], v[224:225], v[38:39], v[14:15] op_sel:[0,0,0] op_sel_hi:[1,0,1] neg_lo:[0,0,1] neg_hi:[0,0,1]
  v_pk_fma_f32 v[226:227], v[226:227], v[38:39], v[16:17] op_sel:[0,0,0] op_sel_hi:[1,0,1] neg_lo:[0,0,1] neg_hi:[0,0,1]
  v_pk_fma_f32 v[228:229], v[228:229], v[38:39], v[18:19] op_sel:[0,0,0] op_sel_hi:[1,0,1] neg_lo:[0,0,1] neg_hi:[0,0,1]
  v_pk_fma_f32 v[230:231], v[230:231], v[38:39], v[20:21] op_sel:[0,0,0] op_sel_hi:[1,0,1] neg_lo:[0,0,1] neg_hi:[0,0,1]
  v_pk_fma_f32 v[232:233], v[232:233], v[38:39], v[22:23] op_sel:[0,0,0] op_sel_hi:[1,0,1] neg_lo:[0,0,1] neg_hi:[0,0,1]
  v_pk_fma_f32 v[234:235], v[234:235], v[38:39], v[24:25] op_sel:[0,0,0] op_sel_hi:[1,0,1] neg_lo:[0,0,1] neg_hi:[0,0,1]
  v_pk_mul_f32 v[14:15], v[224:225], s[80:81] op_sel_hi:[1,0]
  v_pk_mul_f32 v[16:17], v[226:227], s[80:81] op_sel_hi:[1,0]
  v_pk_mul_f32 v[18:19], v[228:229], s[80:81] op_sel_hi:[1,0]
  v_pk_mul_f32 v[20:21], v[230:231], s[80:81] op_sel_hi:[1,0]
  v_pk_mul_f32 v[22:23], v[232:233], s[80:81] op_sel_hi:[1,0]
  v_pk_mul_f32 v[24:25], v[234:235], s[80:81] op_sel_hi:[1,0]
  v_exp_f32 v14, v14 clamp
  v_exp_f32 v15, v15 clamp
  v_exp_f32 v16, v16 clamp
  v_exp_f32 v17, v17 clamp
  v_exp_f32 v18, v18 clamp
  v_exp_f32 v19, v19 clamp
  v_exp_f32 v20, v20 clamp
  v_exp_f32 v21, v21 clamp
  v_exp_f32 v22, v22 clamp
  v_exp_f32 v23, v23 clamp
  v_exp_f32 v24, v24 clamp
  v_exp_f32 v25, v25 clamp
  s_waitcnt lgkmcnt(0)
  v_mfma_f32_32x32x16_bf16 a[240:255], v[90:93], v[40:43], a[240:255]
  v_mfma_f32_32x32x16_bf16 a[240:255], v[26:29], v[44:47], a[240:255]
  v_max_f32 v224, s82, v224
  v_max_f32 v225, s82, v225
  v_max_f32 v226, s82, v226
  v_max_f32 v227, s82, v227
  v_max_f32 v228, s82, v228
  v_max_f32 v229, s82, v229
  v_max_f32 v230, s82, v230
  v_max_f32 v231, s82, v231
  v_max_f32 v232, s82, v232
  v_max_f32 v233, s82, v233
  v_max_f32 v234, s82, v234
  v_max_f32_e64 v235, s82, v235
  v_pk_add_f32 v[224:225], v[224:225], v[14:15]
  v_pk_add_f32 v[226:227], v[226:227], v[16:17]
  v_pk_add_f32 v[228:229], v[228:229], v[18:19]
  v_pk_add_f32 v[230:231], v[230:231], v[20:21]
  v_pk_add_f32 v[232:233], v[232:233], v[22:23]
  v_pk_add_f32 v[234:235], v[234:235], v[24:25]
  v_cvt_pk_bf16_f32 v94, v224, v225
  v_cvt_pk_bf16_f32 v95, v226, v227
  v_cvt_pk_bf16_f32 v60, v228, v229
  v_cvt_pk_bf16_f32 v61, v230, v231
  v_cvt_pk_bf16_f32 v86, v232, v233
  v_cvt_pk_bf16_f32 v87, v234, v235
  s_add_u32 m0, s76, 81920
  s_mul_i32 s17, s20, 40
  s_nop 0
  s_add_u32 s17, s17, 81920
  buffer_load_dwordx4 v48, s[40:43], s17 offen  lds
  buffer_load_dwordx4 v49, s[40:43], s17 offen offset:1024  lds
  ds_write_b64 v116, v[94:95]
  ds_write_b64 v117, v[60:61]
  ds_write_b64 v118, v[86:87]
  v_pk_mul_f32 v[14:15], v[104:105], v[38:39] op_sel:[0,1] op_sel_hi:[1,1]
  v_pk_mul_f32 v[16:17], v[106:107], v[38:39] op_sel:[0,1] op_sel_hi:[1,1]
  v_pk_mul_f32 v[18:19], v[108:109], v[38:39] op_sel:[0,1] op_sel_hi:[1,1]
  v_pk_mul_f32 v[20:21], v[110:111], v[38:39] op_sel:[0,1] op_sel_hi:[1,1]
  v_pk_mul_f32 v[22:23], v[112:113], v[38:39] op_sel:[0,1] op_sel_hi:[1,1]
  v_pk_mul_f32 v[24:25], v[114:115], v[38:39] op_sel:[0,1] op_sel_hi:[1,1]
  v_pk_fma_f32 v[244:245], v[244:245], v[38:39], v[14:15] op_sel:[0,0,0] op_sel_hi:[1,0,1] neg_lo:[0,0,1] neg_hi:[0,0,1]
  v_pk_fma_f32 v[246:247], v[246:247], v[38:39], v[16:17] op_sel:[0,0,0] op_sel_hi:[1,0,1] neg_lo:[0,0,1] neg_hi:[0,0,1]
  v_pk_fma_f32 v[248:249], v[248:249], v[38:39], v[18:19] op_sel:[0,0,0] op_sel_hi:[1,0,1] neg_lo:[0,0,1] neg_hi:[0,0,1]
  v_pk_fma_f32 v[250:251], v[250:251], v[38:39], v[20:21] op_sel:[0,0,0] op_sel_hi:[1,0,1] neg_lo:[0,0,1] neg_hi:[0,0,1]
  v_pk_fma_f32 v[252:253], v[252:253], v[38:39], v[22:23] op_sel:[0,0,0] op_sel_hi:[1,0,1] neg_lo:[0,0,1] neg_hi:[0,0,1]
  v_pk_fma_f32 v[254:255], v[254:255], v[38:39], v[24:25] op_sel:[0,0,0] op_sel_hi:[1,0,1] neg_lo:[0,0,1] neg_hi:[0,0,1]
  v_cvt_pk_bf16_f32 v244, v244, v245
  v_cvt_pk_bf16_f32 v245, v246, v247
  v_cvt_pk_bf16_f32 v248, v248, v249
  v_cvt_pk_bf16_f32 v249, v250, v251
  v_cvt_pk_bf16_f32 v252, v252, v253
  v_cvt_pk_bf16_f32 v253, v254, v255
  v_cndmask_b32 v252, v252, v30, s[84:85]
  s_add_u32 m0, s76, 90112
  s_mul_i32 s17, s21, 40
  s_nop 0
  buffer_load_dwordx4 v48, s[40:43], s17 offen  lds
  buffer_load_dwordx4 v49, s[40:43], s17 offen offset:1024  lds
  ds_write_b64 v116, v[244:245] offset:2048
  ds_write_b64 v117, v[248:249] offset:2048
  ds_write_b64 v118, v[252:253] offset:2048
  ds_read_b64_tr_b16 v[90:91], v119 offset:0
  ds_read_b64_tr_b16 v[40:41], v119 offset:2048
  ds_read_b64_tr_b16 v[92:93], v120 offset:0
  ds_read_b64_tr_b16 v[42:43], v120 offset:2048
  ds_read_b64_tr_b16 v[26:27], v119 offset:1024
  ds_read_b64_tr_b16 v[44:45], v119 offset:3072
  ds_read_b64_tr_b16 v[28:29], v120 offset:1024
  ds_read_b64_tr_b16 v[46:47], v120 offset:3072
  v_pk_fma_f32 v[14:15], v[96:97], v[32:33], s[82:83] op_sel:[0,1,0] op_sel_hi:[1,1,0] neg_lo:[0,0,1] neg_hi:[0,0,1]
  v_pk_fma_f32 v[16:17], v[98:99], v[32:33], s[82:83] op_sel:[0,1,0] op_sel_hi:[1,1,0] neg_lo:[0,0,1] neg_hi:[0,0,1]
  v_pk_fma_f32 v[18:19], v[100:101], v[32:33], s[82:83] op_sel:[0,1,0] op_sel_hi:[1,1,0] neg_lo:[0,0,1] neg_hi:[0,0,1]
  v_pk_fma_f32 v[20:21], v[102:103], v[32:33], s[82:83] op_sel:[0,1,0] op_sel_hi:[1,1,0] neg_lo:[0,0,1] neg_hi:[0,0,1]
  v_pk_fma_f32 v[140:141], v[140:141], v[32:33], v[14:15] op_sel:[0,0,0] op_sel_hi:[1,0,1] neg_lo:[0,0,1] neg_hi:[0,0,1]
  v_pk_fma_f32 v[142:143], v[142:143], v[32:33], v[16:17] op_sel:[0,0,0] op_sel_hi:[1,0,1] neg_lo:[0,0,1] neg_hi:[0,0,1]
  v_pk_fma_f32 v[144:145], v[144:145], v[32:33], v[18:19] op_sel:[0,0,0] op_sel_hi:[1,0,1] neg_lo:[0,0,1] neg_hi:[0,0,1]
  v_pk_fma_f32 v[146:147], v[146:147], v[32:33], v[20:21] op_sel:[0,0,0] op_sel_hi:[1,0,1] neg_lo:[0,0,1] neg_hi:[0,0,1]
  v_pk_mul_f32 v[14:15], v[140:141], s[80:81] op_sel_hi:[1,0]
  v_pk_mul_f32 v[16:17], v[142:143], s[80:81] op_sel_hi:[1,0]
  v_pk_mul_f32 v[18:19], v[144:145], s[80:81] op_sel_hi:[1,0]
  v_pk_mul_f32 v[20:21], v[146:147], s[80:81] op_sel_hi:[1,0]
  v_exp_f32 v14, v14 clamp
  v_exp_f32 v15, v15 clamp
  v_exp_f32 v16, v16 clamp
  v_exp_f32 v17, v17 clamp
  v_exp_f32 v18, v18 clamp
  v_exp_f32 v19, v19 clamp
  v_exp_f32 v20, v20 clamp
  v_exp_f32 v21, v21 clamp
  s_waitcnt lgkmcnt(0)
  v_mfma_f32_32x32x16_bf16 a[240:255], v[90:93], v[40:43], a[240:255]
  v_mfma_f32_32x32x16_bf16 a[240:255], v[26:29], v[44:47], a[240:255]
  v_max_f32 v140, s82, v140
  v_max_f32 v141, s82, v141
  v_max_f32 v142, s82, v142
  v_max_f32 v143, s82, v143
  v_max_f32 v144, s82, v144
  v_max_f32 v145, s82, v145
  v_max_f32 v146, s82, v146
  v_max_f32 v147, s82, v147
  v_mov_b32 v88, 0
  v_mov_b32_e64 v89, 0
  v_accvgpr_read_b32 v46, a208
  v_accvgpr_read_b32 v116, a209
  v_accvgpr_read_b32 v117, a210
  v_accvgpr_read_b32 v118, a211
  v_accvgpr_read_b32 v119, a212
  v_accvgpr_read_b32 v120, a213
  v_accvgpr_read_b32 v63, a215
  v_accvgpr_read_b32 v2, a200
  v_accvgpr_read_b32 v124, a201
  v_accvgpr_read_b32 v5, a202
  v_accvgpr_read_b32 v9, a204
  v_accvgpr_read_b32 v10, a205
  v_accvgpr_read_b32 v28, a206
  v_accvgpr_read_b32 v29, a207
  v_accvgpr_read_b32 v128, a240
  v_accvgpr_read_b32 v129, a241
  v_accvgpr_read_b32 v130, a242
  v_accvgpr_read_b32 v131, a243
  v_accvgpr_read_b32 v132, a244
  v_accvgpr_read_b32 v133, a245
  v_accvgpr_read_b32 v134, a246
  v_accvgpr_read_b32 v135, a247
  v_accvgpr_read_b32 v136, a248
  v_accvgpr_read_b32 v137, a249
  v_accvgpr_read_b32 v138, a250
  v_accvgpr_read_b32 v139, a251
  v_cvt_pk_bf16_f32 v128, v128, v129
  v_cvt_pk_bf16_f32 v129, v130, v131
  v_cvt_pk_bf16_f32 v130, v132, v133
  v_cvt_pk_bf16_f32 v131, v134, v135
  v_cvt_pk_bf16_f32 v132, v136, v137
  v_cvt_pk_bf16_f32 v133, v138, v139
  v_min_u32 v128, -2, v128
  v_min_u32 v129, -2, v129
  v_min_u32 v130, -2, v130
  v_min_u32 v131, -2, v131
  v_min_u32 v132, -2, v132
  v_min_u32 v133, -2, v133
  buffer_store_dwordx4 v[128:131], v121, s[36:39], 0 offen sc1
  buffer_store_dwordx2 v[132:133], v122, s[36:39], 0 offen offset:768 sc1
  v_accvgpr_read_b32 v121, a214
  s_waitcnt vmcnt(25)
  s_barrier
  ds_read_b64_tr_b16 a[96:97], v52 offset:32768
  ds_read_b64_tr_b16 a[98:99], v52 offset:34816
  ds_read_b64_tr_b16 a[100:101], v53 offset:32768
  ds_read_b64_tr_b16 a[102:103], v53 offset:34816
  ds_read_b64_tr_b16 a[104:105], v54 offset:32768
  ds_read_b64_tr_b16 a[106:107], v54 offset:34816
  ds_read_b64_tr_b16 a[108:109], v55 offset:32768
  ds_read_b64_tr_b16 a[110:111], v55 offset:34816
  ds_read_b64_tr_b16 a[112:113], v52 offset:40960
  ds_read_b64_tr_b16 a[114:115], v52 offset:43008
  ds_read_b64_tr_b16 a[116:117], v53 offset:40960
  ds_read_b64_tr_b16 a[118:119], v53 offset:43008
  ds_read_b64_tr_b16 a[120:121], v54 offset:40960
  ds_read_b64_tr_b16 a[122:123], v54 offset:43008
  ds_read_b64_tr_b16 a[124:125], v55 offset:40960
  ds_read_b64_tr_b16 a[126:127], v55 offset:43008
  ds_read_b64_tr_b16 a[128:129], v52 offset:49152
  ds_read_b64_tr_b16 a[130:131], v52 offset:51200
  ds_read_b64_tr_b16 a[132:133], v53 offset:49152
  ds_read_b64_tr_b16 a[134:135], v53 offset:51200
  ds_read_b64_tr_b16 a[136:137], v54 offset:49152
  ds_read_b64_tr_b16 a[138:139], v54 offset:51200
  ds_read_b64_tr_b16 a[140:141], v55 offset:49152
  ds_read_b64_tr_b16 a[142:143], v55 offset:51200
  ds_read_b64_tr_b16 a[144:145], v52 offset:57344
  ds_read_b64_tr_b16 a[146:147], v52 offset:59392
  ds_read_b64_tr_b16 a[148:149], v53 offset:57344
  ds_read_b64_tr_b16 a[150:151], v53 offset:59392
  ds_read_b64_tr_b16 a[152:153], v54 offset:57344
  ds_read_b64_tr_b16 a[154:155], v54 offset:59392
  ds_read_b64_tr_b16 a[156:157], v55 offset:57344
  ds_read_b64_tr_b16 a[158:159], v55 offset:59392
  v_add_u32 v52, 0x8000, v52
  v_add_u32 v53, 0x8000, v53
  v_add_u32 v54, 0x8000, v54
  v_add_u32 v55, 0x8000, v55
  ds_read_b64_tr_b16 a[160:161], v52 offset:32768
  ds_read_b64_tr_b16 a[162:163], v52 offset:34816
  ds_read_b64_tr_b16 a[164:165], v53 offset:32768
  ds_read_b64_tr_b16 a[166:167], v53 offset:34816
  ds_read_b64_tr_b16 a[168:169], v54 offset:32768
  ds_read_b64_tr_b16 a[170:171], v54 offset:34816
  ds_read_b64_tr_b16 a[172:173], v55 offset:32768
  ds_read_b64_tr_b16 a[174:175], v55 offset:34816
  ds_read_b64_tr_b16 a[176:177], v52 offset:40960
  ds_read_b64_tr_b16 a[178:179], v52 offset:43008
  ds_read_b64_tr_b16 a[180:181], v53 offset:40960
  ds_read_b64_tr_b16 a[182:183], v53 offset:43008
  ds_read_b64_tr_b16 a[184:185], v54 offset:40960
  ds_read_b64_tr_b16 a[186:187], v54 offset:43008
  ds_read_b64_tr_b16 a[188:189], v55 offset:40960
  ds_read_b64_tr_b16 a[190:191], v55 offset:43008
  s_waitcnt lgkmcnt(0)
  s_barrier
  v_accvgpr_read_b32 v123, a203
  s_mov_b32 s71, 0x3f80
  s_mov_b32 s92, 0
  s_add_u32 m0, s76, 0
  s_mul_i32 s17, s21, 40
  s_add_u32 s17, s17, 40960
  buffer_load_dwordx4 v48, s[40:43], s17 offen  lds
  buffer_load_dwordx4 v49, s[40:43], s17 offen offset:1024  lds
  s_add_u32 m0, s76, 8192
  s_mul_i32 s17, s21, 40
  s_add_u32 s17, s17, 81920
  buffer_load_dwordx4 v48, s[40:43], s17 offen  lds
  buffer_load_dwordx4 v49, s[40:43], s17 offen offset:1024  lds
  v_pk_add_f32 v[140:141], v[140:141], v[14:15]
  v_pk_add_f32 v[142:143], v[142:143], v[16:17]
  v_pk_add_f32 v[144:145], v[144:145], v[18:19]
  v_pk_add_f32 v[146:147], v[146:147], v[20:21]
  v_cvt_pk_bf16_f32 v64, v140, v141
  v_cvt_pk_bf16_f32 v65, v142, v143
  v_cvt_pk_bf16_f32 v66, v144, v145
  v_cvt_pk_bf16_f32 v67, v146, v147
  v_pk_fma_f32 v[22:23], v[96:97], v[34:35], s[82:83] op_sel:[0,1,0] op_sel_hi:[1,1,0] neg_lo:[0,0,1] neg_hi:[0,0,1]
  v_pk_fma_f32 v[24:25], v[98:99], v[34:35], s[82:83] op_sel:[0,1,0] op_sel_hi:[1,1,0] neg_lo:[0,0,1] neg_hi:[0,0,1]
  v_pk_fma_f32 v[14:15], v[100:101], v[34:35], s[82:83] op_sel:[0,1,0] op_sel_hi:[1,1,0] neg_lo:[0,0,1] neg_hi:[0,0,1]
  v_pk_fma_f32 v[16:17], v[102:103], v[34:35], s[82:83] op_sel:[0,1,0] op_sel_hi:[1,1,0] neg_lo:[0,0,1] neg_hi:[0,0,1]
  v_pk_fma_f32 v[172:173], v[172:173], v[34:35], v[22:23] op_sel:[0,0,0] op_sel_hi:[1,0,1] neg_lo:[0,0,1] neg_hi:[0,0,1]
  v_pk_fma_f32 v[174:175], v[174:175], v[34:35], v[24:25] op_sel:[0,0,0] op_sel_hi:[1,0,1] neg_lo:[0,0,1] neg_hi:[0,0,1]
  v_pk_fma_f32 v[176:177], v[176:177], v[34:35], v[14:15] op_sel:[0,0,0] op_sel_hi:[1,0,1] neg_lo:[0,0,1] neg_hi:[0,0,1]
  v_pk_fma_f32 v[178:179], v[178:179], v[34:35], v[16:17] op_sel:[0,0,0] op_sel_hi:[1,0,1] neg_lo:[0,0,1] neg_hi:[0,0,1]
  v_pk_mul_f32 v[22:23], v[172:173], s[80:81] op_sel_hi:[1,0]
  v_pk_mul_f32 v[24:25], v[174:175], s[80:81] op_sel_hi:[1,0]
  v_pk_mul_f32 v[14:15], v[176:177], s[80:81] op_sel_hi:[1,0]
  v_pk_mul_f32 v[16:17], v[178:179], s[80:81] op_sel_hi:[1,0]
  v_exp_f32 v22, v22 clamp
  v_exp_f32 v23, v23 clamp
  v_exp_f32 v24, v24 clamp
  v_exp_f32 v25, v25 clamp
  v_exp_f32 v14, v14 clamp
  v_exp_f32 v15, v15 clamp
  v_exp_f32 v16, v16 clamp
  v_exp_f32 v17, v17 clamp
  v_max_f32 v172, s82, v172
  s_add_u32 m0, s76, 98304
  s_mul_i32 s17, s10, 40
  buffer_load_dwordx4 v50, s[44:47], s17 offen  lds
  buffer_load_dwordx4 v51, s[44:47], s17 offen offset:1024  lds
  s_add_u32 m0, s76, 106496
  s_add_u32 s17, s17, 40960
  buffer_load_dwordx4 v50, s[44:47], s17 offen  lds
  buffer_load_dwordx4 v51, s[44:47], s17 offen offset:1024  lds
  v_max_f32 v173, s82, v173
  v_max_f32 v174, s82, v174
  v_max_f32 v175, s82, v175
  v_max_f32 v176, s82, v176
  v_max_f32 v177, s82, v177
  v_max_f32 v178, s82, v178
  v_max_f32_e64 v179, s82, v179
  v_pk_add_f32 v[172:173], v[172:173], v[22:23]
  v_pk_add_f32 v[174:175], v[174:175], v[24:25]
  v_pk_add_f32 v[176:177], v[176:177], v[14:15]
  v_pk_add_f32 v[178:179], v[178:179], v[16:17]
  v_cvt_pk_bf16_f32 v70, v172, v173
  v_cvt_pk_bf16_f32 v71, v174, v175
  v_cvt_pk_bf16_f32 v72, v176, v177
  v_cvt_pk_bf16_f32 v73, v178, v179
  v_pk_fma_f32 v[18:19], v[96:97], v[36:37], s[82:83] op_sel:[0,1,0] op_sel_hi:[1,1,0] neg_lo:[0,0,1] neg_hi:[0,0,1]
  v_pk_fma_f32 v[20:21], v[98:99], v[36:37], s[82:83] op_sel:[0,1,0] op_sel_hi:[1,1,0] neg_lo:[0,0,1] neg_hi:[0,0,1]
  v_pk_fma_f32 v[22:23], v[100:101], v[36:37], s[82:83] op_sel:[0,1,0] op_sel_hi:[1,1,0] neg_lo:[0,0,1] neg_hi:[0,0,1]
  v_pk_fma_f32 v[24:25], v[102:103], v[36:37], s[82:83] op_sel:[0,1,0] op_sel_hi:[1,1,0] neg_lo:[0,0,1] neg_hi:[0,0,1]
  v_pk_fma_f32 v[204:205], v[204:205], v[36:37], v[18:19] op_sel:[0,0,0] op_sel_hi:[1,0,1] neg_lo:[0,0,1] neg_hi:[0,0,1]
  v_pk_fma_f32 v[206:207], v[206:207], v[36:37], v[20:21] op_sel:[0,0,0] op_sel_hi:[1,0,1] neg_lo:[0,0,1] neg_hi:[0,0,1]
  v_pk_fma_f32 v[208:209], v[208:209], v[36:37], v[22:23] op_sel:[0,0,0] op_sel_hi:[1,0,1] neg_lo:[0,0,1] neg_hi:[0,0,1]
  v_pk_fma_f32 v[210:211], v[210:211], v[36:37], v[24:25] op_sel:[0,0,0] op_sel_hi:[1,0,1] neg_lo:[0,0,1] neg_hi:[0,0,1]
  v_pk_mul_f32 v[18:19], v[204:205], s[80:81] op_sel_hi:[1,0]
  v_pk_mul_f32 v[20:21], v[206:207], s[80:81] op_sel_hi:[1,0]
  v_pk_mul_f32 v[22:23], v[208:209], s[80:81] op_sel_hi:[1,0]
  v_pk_mul_f32 v[24:25], v[210:211], s[80:81] op_sel_hi:[1,0]
  v_exp_f32 v18, v18 clamp
  v_exp_f32 v19, v19 clamp
  s_add_u32 m0, s76, 114688
  s_mul_i32 s17, s11, 40
  s_nop 0
  buffer_load_dwordx4 v50, s[44:47], s17 offen  lds
  buffer_load_dwordx4 v51, s[44:47], s17 offen offset:1024  lds
  s_add_u32 m0, s76, 122880
  s_add_u32 s17, s17, 40960
  buffer_load_dwordx4 v50, s[44:47], s17 offen  lds
  buffer_load_dwordx4 v51, s[44:47], s17 offen offset:1024  lds
  v_exp_f32 v20, v20 clamp
  v_exp_f32 v21, v21 clamp
  v_exp_f32 v22, v22 clamp
  v_exp_f32 v23, v23 clamp
  v_exp_f32 v24, v24 clamp
  v_exp_f32 v25, v25 clamp
  v_max_f32 v204, s82, v204
  v_max_f32 v205, s82, v205
  v_max_f32 v206, s82, v206
  v_max_f32 v207, s82, v207
  v_max_f32 v208, s82, v208
  v_max_f32 v209, s82, v209
  v_max_f32 v210, s82, v210
  v_max_f32 v211, s82, v211
  v_pk_add_f32 v[204:205], v[204:205], v[18:19]
  v_pk_add_f32 v[206:207], v[206:207], v[20:21]
  v_pk_add_f32 v[208:209], v[208:209], v[22:23]
  v_pk_add_f32 v[210:211], v[210:211], v[24:25]
  v_cvt_pk_bf16_f32 v76, v204, v205
  v_cvt_pk_bf16_f32 v77, v206, v207
  v_cvt_pk_bf16_f32 v78, v208, v209
  v_cvt_pk_bf16_f32 v79, v210, v211
  v_pk_fma_f32 v[14:15], v[96:97], v[38:39], s[82:83] op_sel:[0,1,0] op_sel_hi:[1,1,0] neg_lo:[0,0,1] neg_hi:[0,0,1]
  v_pk_fma_f32 v[16:17], v[98:99], v[38:39], s[82:83] op_sel:[0,1,0] op_sel_hi:[1,1,0] neg_lo:[0,0,1] neg_hi:[0,0,1]
  v_pk_fma_f32 v[18:19], v[100:101], v[38:39], s[82:83] op_sel:[0,1,0] op_sel_hi:[1,1,0] neg_lo:[0,0,1] neg_hi:[0,0,1]
  v_pk_fma_f32 v[20:21], v[102:103], v[38:39], s[82:83] op_sel:[0,1,0] op_sel_hi:[1,1,0] neg_lo:[0,0,1] neg_hi:[0,0,1]
  v_pk_fma_f32 v[236:237], v[236:237], v[38:39], v[14:15] op_sel:[0,0,0] op_sel_hi:[1,0,1] neg_lo:[0,0,1] neg_hi:[0,0,1]
  v_pk_fma_f32 v[238:239], v[238:239], v[38:39], v[16:17] op_sel:[0,0,0] op_sel_hi:[1,0,1] neg_lo:[0,0,1] neg_hi:[0,0,1]
  v_pk_fma_f32 v[240:241], v[240:241], v[38:39], v[18:19] op_sel:[0,0,0] op_sel_hi:[1,0,1] neg_lo:[0,0,1] neg_hi:[0,0,1]
  s_add_u32 m0, s76, 131072
  s_mul_i32 s17, s12, 40
  s_nop 0
  buffer_load_dwordx4 v50, s[44:47], s17 offen  lds
  buffer_load_dwordx4 v51, s[44:47], s17 offen offset:1024  lds
  s_add_u32 m0, s76, 139264
  s_add_u32 s17, s17, 40960
  buffer_load_dwordx4 v50, s[44:47], s17 offen  lds
  buffer_load_dwordx4 v51, s[44:47], s17 offen offset:1024  lds
  v_pk_fma_f32 v[242:243], v[242:243], v[38:39], v[20:21] op_sel:[0,0,0] op_sel_hi:[1,0,1] neg_lo:[0,0,1] neg_hi:[0,0,1]
  v_pk_mul_f32 v[14:15], v[236:237], s[80:81] op_sel_hi:[1,0]
  v_pk_mul_f32 v[16:17], v[238:239], s[80:81] op_sel_hi:[1,0]
  v_pk_mul_f32 v[18:19], v[240:241], s[80:81] op_sel_hi:[1,0]
  v_pk_mul_f32 v[20:21], v[242:243], s[80:81] op_sel_hi:[1,0]
  v_exp_f32 v14, v14 clamp
  v_exp_f32 v15, v15 clamp
  v_exp_f32 v16, v16 clamp
  v_exp_f32 v17, v17 clamp
  v_exp_f32 v18, v18 clamp
  v_exp_f32 v19, v19 clamp
  v_exp_f32 v20, v20 clamp
  v_exp_f32 v21, v21 clamp
  v_max_f32 v236, s82, v236
  v_max_f32 v237, s82, v237
  v_max_f32 v238, s82, v238
  v_max_f32 v239, s82, v239
  v_max_f32 v240, s82, v240
  v_max_f32 v241, s82, v241
  v_max_f32 v242, s82, v242
  v_max_f32 v243, s82, v243
  v_pk_add_f32 v[236:237], v[236:237], v[14:15]
  v_pk_add_f32 v[238:239], v[238:239], v[16:17]
  v_pk_add_f32 v[240:241], v[240:241], v[18:19]
  v_pk_add_f32 v[242:243], v[242:243], v[20:21]
  v_cvt_pk_bf16_f32 v82, v236, v237
  v_cvt_pk_bf16_f32 v83, v238, v239
  v_cvt_pk_bf16_f32 v84, v240, v241
  v_cvt_pk_bf16_f32 v85, v242, v243
  v_accvgpr_read_b32 v24, a216
  v_accvgpr_read_b32 v25, a217
  v_accvgpr_read_b32 v26, a218
  v_accvgpr_read_b32 v27, a219
  s_waitcnt vmcnt(38)
  s_nop 0
  v_accvgpr_read_b32 v12, a228
  v_accvgpr_read_b32 v13, a229
  v_accvgpr_read_b32 v14, a230
  v_accvgpr_read_b32 v15, a231
  v_accvgpr_read_b32 v16, a236
  v_accvgpr_read_b32 v17, a237
  v_accvgpr_read_b32 v18, a238
  v_accvgpr_read_b32 v19, a239
  v_add_u32 v3, 69632, v2
  v_add_u32 v6, 20480, v5
  v_mov_b32 v40, 0
  v_mov_b32 v41, 0
  v_mov_b32 v42, 0
  v_mov_b32 v43, 0
  ds_write_b128 v46, v[40:43] offset:32
  v_mov_b32 v192, 0
  v_mov_b32 v193, 0
  v_mov_b32 v194, 0
  v_mov_b32 v195, 0
  v_mov_b32 v196, 0
  v_mov_b32 v197, 0
  v_mov_b32 v198, 0
  v_mov_b32 v199, 0
  v_mov_b32 v200, 0
  s_lshr_b32 s70, s68, 1
  s_lshl_b32 s70, s70, 11
  s_lshl_b32 s73, s59, 13
  s_add_u32 s72, s70, s73
  buffer_load_dwordx4 v[128:131], v123, s[36:39], s72 offen offset:0 sc1
  buffer_load_dwordx4 v[132:135], v123, s[36:39], s72 offen offset:1024 sc1
  s_add_u32 s70, s70, 2048
  s_and_b32 s70, s70, 0x1fff
  s_add_u32 s72, s70, s73
  buffer_load_dwordx4 v[136:139], v123, s[36:39], s72 offen offset:0 sc1
  buffer_load_dwordx4 v[148:151], v123, s[36:39], s72 offen offset:1024 sc1
  s_add_u32 s70, s70, 2048
  s_and_b32 s70, s70, 0x1fff
  s_add_u32 s72, s70, s73
  buffer_load_dwordx4 v[152:155], v123, s[36:39], s72 offen offset:0 sc1
  buffer_load_dwordx4 v[156:159], v123, s[36:39], s72 offen offset:1024 sc1
  s_add_u32 s70, s70, 2048
  s_and_b32 s70, s70, 0x1fff
  s_add_u32 s72, s70, s73
  buffer_load_dwordx4 v[160:163], v123, s[36:39], s72 offen offset:0 sc1
  buffer_load_dwordx4 v[164:167], v123, s[36:39], s72 offen offset:1024 sc1
  s_add_u32 s70, s70, 2048
  s_and_b32 s70, s70, 0x1fff
  s_xor_b32 s73, s73, 0x2000
  s_add_u32 s72, s70, s73
  buffer_load_dwordx4 v[168:171], v123, s[36:39], s72 offen offset:0 sc1
  buffer_load_dwordx4 v[180:183], v123, s[36:39], s72 offen offset:1024 sc1
  s_add_u32 s70, s70, 2048
  s_and_b32 s70, s70, 0x1fff
  s_add_u32 s72, s70, s73
  buffer_load_dwordx4 v[184:187], v123, s[36:39], s72 offen offset:0 sc1
  buffer_load_dwordx4 v[188:191], v123, s[36:39], s72 offen offset:1024 sc1
  s_add_u32 s70, s70, 2048
  s_and_b32 s70, s70, 0x1fff
  s_add_u32 s72, s70, s73
  buffer_load_dwordx4 v[212:215], v123, s[36:39], s72 offen offset:0 sc1
  buffer_load_dwordx4 v[216:219], v123, s[36:39], s72 offen offset:1024 sc1
  s_add_u32 s70, s70, 2048
  s_and_b32 s70, s70, 0x1fff
  s_add_u32 s72, s70, s73
  buffer_load_dwordx4 v[220:223], v123, s[36:39], s72 offen offset:0 sc1
  buffer_load_dwordx4 v[224:227], v123, s[36:39], s72 offen offset:1024 sc1
  buffer_load_dword v60, v124, s[36:39], s54 offen sc1
  s_waitcnt vmcnt(16)
  v_max3_u32 v200, v200, v128, v130
  v_dot2c_f32_bf16 v192, s71, v128
  v_dot2c_f32_bf16 v193, s90, v128
  v_dot2c_f32_bf16 v194, s71, v129
  v_dot2c_f32_bf16 v195, s90, v129
  v_dot2c_f32_bf16 v196, s71, v130
  v_dot2c_f32_bf16 v197, s90, v130
  v_dot2c_f32_bf16 v198, s71, v131
  v_dot2c_f32_bf16 v199, s90, v131
  s_waitcnt vmcnt(15)
  v_max3_u32 v200, v200, v132, v134
  v_dot2c_f32_bf16 v192, s71, v132
  v_dot2c_f32_bf16 v193, s90, v132
  v_dot2c_f32_bf16 v194, s71, v133
  v_dot2c_f32_bf16 v195, s90, v133
  v_dot2c_f32_bf16 v196, s71, v134
  v_dot2c_f32_bf16 v197, s90, v134
  v_dot2c_f32_bf16 v198, s71, v135
  v_dot2c_f32_bf16 v199, s90, v135
  s_waitcnt vmcnt(14)
  v_max3_u32 v200, v200, v136, v138
  v_dot2c_f32_bf16 v192, s71, v136
  v_dot2c_f32_bf16 v193, s90, v136
  v_dot2c_f32_bf16 v194, s71, v137
  v_dot2c_f32_bf16 v195, s90, v137
  v_dot2c_f32_bf16 v196, s71, v138
  v_dot2c_f32_bf16 v197, s90, v138
  v_dot2c_f32_bf16 v198, s71, v139
  v_dot2c_f32_bf16 v199, s90, v139
  s_waitcnt vmcnt(13)
  v_max3_u32 v200, v200, v148, v150
  v_dot2c_f32_bf16 v192, s71, v148
  v_dot2c_f32_bf16 v193, s90, v148
  v_dot2c_f32_bf16 v194, s71, v149
  v_dot2c_f32_bf16 v195, s90, v149
  v_dot2c_f32_bf16 v196, s71, v150
  v_dot2c_f32_bf16 v197, s90, v150
  v_dot2c_f32_bf16 v198, s71, v151
  v_dot2c_f32_bf16 v199, s90, v151
  s_waitcnt vmcnt(12)
  v_max3_u32 v200, v200, v152, v154
  v_dot2c_f32_bf16 v192, s71, v152
  v_dot2c_f32_bf16 v193, s90, v152
  v_dot2c_f32_bf16 v194, s71, v153
  v_dot2c_f32_bf16 v195, s90, v153
  v_dot2c_f32_bf16 v196, s71, v154
  v_dot2c_f32_bf16 v197, s90, v154
  v_dot2c_f32_bf16 v198, s71, v155
  v_dot2c_f32_bf16 v199, s90, v155
  s_waitcnt vmcnt(11)
  v_max3_u32 v200, v200, v156, v158
  v_dot2c_f32_bf16 v192, s71, v156
  v_dot2c_f32_bf16 v193, s90, v156
  v_dot2c_f32_bf16 v194, s71, v157
  v_dot2c_f32_bf16 v195, s90, v157
  v_dot2c_f32_bf16 v196, s71, v158
  v_dot2c_f32_bf16 v197, s90, v158
  v_dot2c_f32_bf16 v198, s71, v159
  v_dot2c_f32_bf16 v199, s90, v159
  s_waitcnt vmcnt(10)
  v_max3_u32 v200, v200, v160, v162
  v_dot2c_f32_bf16 v192, s71, v160
  v_dot2c_f32_bf16 v193, s90, v160
  v_dot2c_f32_bf16 v194, s71, v161
  v_dot2c_f32_bf16 v195, s90, v161
  v_dot2c_f32_bf16 v196, s71, v162
  v_dot2c_f32_bf16 v197, s90, v162
  v_dot2c_f32_bf16 v198, s71, v163
  v_dot2c_f32_bf16 v199, s90, v163
  s_waitcnt vmcnt(9)
  v_max3_u32 v200, v200, v164, v166
  v_dot2c_f32_bf16 v192, s71, v164
  v_dot2c_f32_bf16 v193, s90, v164
  v_dot2c_f32_bf16 v194, s71, v165
  v_dot2c_f32_bf16 v195, s90, v165
  v_dot2c_f32_bf16 v196, s71, v166
  v_dot2c_f32_bf16 v197, s90, v166
  v_dot2c_f32_bf16 v198, s71, v167
  v_dot2c_f32_bf16 v199, s90, v167
  s_waitcnt vmcnt(8)
  v_max3_u32 v200, v200, v168, v170
  v_dot2c_f32_bf16 v192, s71, v168
  v_dot2c_f32_bf16 v193, s90, v168
  v_dot2c_f32_bf16 v194, s71, v169
  v_dot2c_f32_bf16 v195, s90, v169
  v_dot2c_f32_bf16 v196, s71, v170
  v_dot2c_f32_bf16 v197, s90, v170
  v_dot2c_f32_bf16 v198, s71, v171
  v_dot2c_f32_bf16 v199, s90, v171
  s_waitcnt vmcnt(7)
  v_max3_u32 v200, v200, v180, v182
  v_dot2c_f32_bf16 v192, s71, v180
  v_dot2c_f32_bf16 v193, s90, v180
  v_dot2c_f32_bf16 v194, s71, v181
  v_dot2c_f32_bf16 v195, s90, v181
  v_dot2c_f32_bf16 v196, s71, v182
  v_dot2c_f32_bf16 v197, s90, v182
  v_dot2c_f32_bf16 v198, s71, v183
  v_dot2c_f32_bf16 v199, s90, v183
  s_waitcnt vmcnt(6)
  v_max3_u32 v200, v200, v184, v186
  v_dot2c_f32_bf16 v192, s71, v184
  v_dot2c_f32_bf16 v193, s90, v184
  v_dot2c_f32_bf16 v194, s71, v185
  v_dot2c_f32_bf16 v195, s90, v185
  v_dot2c_f32_bf16 v196, s71, v186
  v_dot2c_f32_bf16 v197, s90, v186
  v_dot2c_f32_bf16 v198, s71, v187
  v_dot2c_f32_bf16 v199, s90, v187
  s_waitcnt vmcnt(5)
  v_max3_u32 v200, v200, v188, v190
  v_dot2c_f32_bf16 v192, s71, v188
  v_dot2c_f32_bf16 v193, s90, v188
  v_dot2c_f32_bf16 v194, s71, v189
  v_dot2c_f32_bf16 v195, s90, v189
  v_dot2c_f32_bf16 v196, s71, v190
  v_dot2c_f32_bf16 v197, s90, v190
  v_dot2c_f32_bf16 v198, s71, v191
  v_dot2c_f32_bf16 v199, s90, v191
  s_waitcnt vmcnt(4)
  v_max3_u32 v200, v200, v212, v214
  v_dot2c_f32_bf16 v192, s71, v212
  v_dot2c_f32_bf16 v193, s90, v212
  v_dot2c_f32_bf16 v194, s71, v213
  v_dot2c_f32_bf16 v195, s90, v213
  v_dot2c_f32_bf16 v196, s71, v214
  v_dot2c_f32_bf16 v197, s90, v214
  v_dot2c_f32_bf16 v198, s71, v215
  v_dot2c_f32_bf16 v199, s90, v215
  s_waitcnt vmcnt(3)
  v_max3_u32 v200, v200, v216, v218
  v_dot2c_f32_bf16 v192, s71, v216
  v_dot2c_f32_bf16 v193, s90, v216
  v_dot2c_f32_bf16 v194, s71, v217
  v_dot2c_f32_bf16 v195, s90, v217
  v_dot2c_f32_bf16 v196, s71, v218
  v_dot2c_f32_bf16 v197, s90, v218
  v_dot2c_f32_bf16 v198, s71, v219
  v_dot2c_f32_bf16 v199, s90, v219
  s_waitcnt vmcnt(2)
  v_max3_u32 v200, v200, v220, v222
  v_dot2c_f32_bf16 v192, s71, v220
  v_dot2c_f32_bf16 v193, s90, v220
  v_dot2c_f32_bf16 v194, s71, v221
  v_dot2c_f32_bf16 v195, s90, v221
  v_dot2c_f32_bf16 v196, s71, v222
  v_dot2c_f32_bf16 v197, s90, v222
  v_dot2c_f32_bf16 v198, s71, v223
  v_dot2c_f32_bf16 v199, s90, v223
  s_waitcnt vmcnt(1)
  v_max3_u32 v200, v200, v224, v226
  v_dot2c_f32_bf16 v192, s71, v224
  v_dot2c_f32_bf16 v193, s90, v224
  v_dot2c_f32_bf16 v194, s71, v225
  v_dot2c_f32_bf16 v195, s90, v225
  v_dot2c_f32_bf16 v196, s71, v226
  v_dot2c_f32_bf16 v197, s90, v226
  v_dot2c_f32_bf16 v198, s71, v227
  v_dot2c_f32_bf16 v199, s90, v227
  v_cmp_eq_u32 vcc, -1, v200
  s_nop 0
  s_cmp_eq_u64 vcc, 0
  s_cbranch_scc0 Lretry_6
Lagain_5:
  s_nop 1
  s_nop 0
  v_cvt_pk_bf16_f32 v40, v192, v193
  v_cvt_pk_bf16_f32 v41, v194, v195
  v_cvt_pk_bf16_f32 v42, v196, v197
  v_cvt_pk_bf16_f32 v43, v198, v199
  ds_write_b64 v116, v[40:41]
  ds_write_b64 v117, v[42:43]
  ds_read_b128 v[40:43], v118
  ds_read_b128 v[44:47], v119 offset:48
LQp2:
  s_waitcnt vmcnt(0)
  v_cmp_gt_u32 vcc, s53, v60
  s_nop 0
  s_cmp_eq_u64 vcc, 0
  s_cbranch_scc0 Lslow_7
Lback_8:
  s_barrier
  buffer_load_dwordx4 a[192:195], v2, s[36:39], s4 offen offset:0 sc1
  buffer_load_dwordx4 a[196:199], v3, s[36:39], s4 offen offset:0 sc1
  buffer_load_dwordx4 a[200:203], v2, s[36:39], s4 offen offset:1024 sc1
  buffer_load_dwordx4 a[204:207], v3, s[36:39], s4 offen offset:1024 sc1
  buffer_load_dwordx4 a[208:211], v2, s[36:39], s4 offen offset:2048 sc1
  buffer_load_dwordx4 a[212:215], v3, s[36:39], s4 offen offset:2048 sc1
  buffer_load_dwordx4 a[216:219], v2, s[36:39], s5 offen offset:0 sc1
  buffer_load_dwordx4 a[220:223], v3, s[36:39], s5 offen offset:0 sc1
  s_waitcnt lgkmcnt(0)
  v_mfma_f32_32x32x16_bf16 v[128:143], v[40:43], v[64:67], 0
  v_mfma_f32_32x32x16_bf16 v[128:143], v[44:47], v[68:71], v[128:143]
  v_mfma_f32_32x32x16_bf16 v[144:159], v[40:43], v[70:73], 0
  v_mfma_f32_32x32x16_bf16 v[144:159], v[44:47], v[74:77], v[144:159]
  v_mfma_f32_32x32x16_bf16 v[160:175], v[40:43], v[76:79], 0
  s_nop 7
  v_mfma_f32_32x32x16_bf16 v[160:175], v[44:47], v[80:83], v[160:175]
  v_add_f32 v140, s82, v140
  v_rcp_f32 v140, v140
  s_mov_b32 s70, 0
  v_mul_f32 v128, v128, v140
  v_mul_f32 v129, v129, v140
  v_mul_f32 v130, v130, v140
  v_mul_f32 v131, v131, v140
  v_mul_f32 v132, v132, v140
  v_mfma_f32_32x32x16_bf16 v[176:191], v[40:43], v[82:85], 0
  v_mul_f32 v133, v133, v140
  v_mul_f32 v134, v134, v140
  v_mul_f32 v135, v135, v140
  v_mul_f32 v136, v136, v140
  v_mul_f32 v137, v137, v140
  v_mul_f32 v138, v138, v140
  v_mul_f32 v139, v139, v140
  v_mfma_f32_32x32x16_bf16 v[176:191], v[44:47], v[86:89], v[176:191]
  v_cvt_pk_bf16_f32 v192, v128, v129
  v_cvt_pk_bf16_f32 v193, v130, v131
  v_cvt_pk_bf16_f32 v194, v132, v133
  v_cvt_pk_bf16_f32 v195, v134, v135
  v_cvt_pk_bf16_f32 v196, v136, v137
  v_cvt_pk_bf16_f32 v197, v138, v139
  buffer_store_dwordx4 v[192:195], v120, s[36:39], s70 offen sc1
  buffer_store_dwordx2 v[196:197], v121, s[36:39], s70 offen sc1
  v_add_f32 v156, s82, v156
  v_rcp_f32_e64 v156, v156
  s_mov_b32 s70, 139264
  v_pk_mul_f32 v[144:145], v[144:145], v[156:157] op_sel_hi:[1,0]
  v_pk_mul_f32 v[146:147], v[146:147], v[156:157] op_sel_hi:[1,0]
  v_pk_mul_f32 v[148:149], v[148:149], v[156:157] op_sel_hi:[1,0]
  v_pk_mul_f32 v[150:151], v[150:151], v[156:157] op_sel_hi:[1,0]
  v_pk_mul_f32 v[152:153], v[152:153], v[156:157] op_sel_hi:[1,0]
  v_pk_mul_f32 v[154:155], v[154:155], v[156:157] op_sel_hi:[1,0]
  v_cvt_pk_bf16_f32 v200, v144, v145
  v_cvt_pk_bf16_f32 v201, v146, v147
  v_cvt_pk_bf16_f32 v202, v148, v149
  v_cvt_pk_bf16_f32 v203, v150, v151
  v_cvt_pk_bf16_f32 v204, v152, v153
  v_cvt_pk_bf16_f32 v205, v154, v155
  buffer_store_dwordx4 v[200:203], v120, s[36:39], s70 offen sc1
  buffer_store_dwordx2 v[204:205], v121, s[36:39], s70 offen sc1
  v_add_f32 v172, s82, v172
  v_rcp_f32 v172, v172
  s_mov_b32 s70, 278528
  v_pk_mul_f32 v[160:161], v[160:161], v[172:173] op_sel_hi:[1,0]
  v_pk_mul_f32 v[162:163], v[162:163], v[172:173] op_sel_hi:[1,0]
  v_pk_mul_f32 v[164:165], v[164:165], v[172:173] op_sel_hi:[1,0]
  v_pk_mul_f32 v[166:167], v[166:167], v[172:173] op_sel_hi:[1,0]
  v_pk_mul_f32 v[168:169], v[168:169], v[172:173] op_sel_hi:[1,0]
  v_pk_mul_f32 v[170:171], v[170:171], v[172:173] op_sel_hi:[1,0]
  v_cvt_pk_bf16_f32 v208, v160, v161
  v_cvt_pk_bf16_f32 v209, v162, v163
  v_cvt_pk_bf16_f32 v210, v164, v165
  v_cvt_pk_bf16_f32 v211, v166, v167
  v_cvt_pk_bf16_f32 v212, v168, v169
  v_cvt_pk_bf16_f32 v213, v170, v171
  buffer_store_dwordx4 v[208:211], v120, s[36:39], s70 offen sc1
  buffer_store_dwordx2 v[212:213], v121, s[36:39], s70 offen sc1
  v_add_f32 v188, s82, v188
  v_rcp_f32 v188, v188
  s_mov_b32 s70, 417792
  v_pk_mul_f32 v[176:177], v[176:177], v[188:189] op_sel_hi:[1,0]
  v_pk_mul_f32 v[178:179], v[178:179], v[188:189] op_sel_hi:[1,0]
  v_pk_mul_f32 v[180:181], v[180:181], v[188:189] op_sel_hi:[1,0]
  v_pk_mul_f32 v[182:183], v[182:183], v[188:189] op_sel_hi:[1,0]
  v_pk_mul_f32 v[184:185], v[184:185], v[188:189] op_sel_hi:[1,0]
  v_pk_mul_f32 v[186:187], v[186:187], v[188:189] op_sel_hi:[1,0]
  v_cvt_pk_bf16_f32 v216, v176, v177
  v_cvt_pk_bf16_f32 v217, v178, v179
  v_cvt_pk_bf16_f32 v218, v180, v181
  v_cvt_pk_bf16_f32 v219, v182, v183
  v_cvt_pk_bf16_f32 v220, v184, v185
  v_cvt_pk_bf16_f32 v221, v186, v187
  buffer_store_dwordx4 v[216:219], v120, s[36:39], s70 offen sc1
  buffer_store_dwordx2 v[220:221], v121, s[36:39], s70 offen sc1
  buffer_load_dwordx4 v[96:99], v2, s[36:39], s5 offen offset:1024 sc1
  buffer_load_dwordx4 v[100:103], v3, s[36:39], s5 offen offset:1024 sc1
  buffer_load_dwordx4 v[104:107], v2, s[36:39], s5 offen offset:2048 sc1
  buffer_load_dwordx4 v[108:111], v3, s[36:39], s5 offen offset:2048 sc1
  buffer_load_dwordx4 v[112:115], v2, s[36:39], s6 offen offset:0 sc1
  buffer_load_dwordx4 v[116:119], v3, s[36:39], s6 offen offset:0 sc1
  buffer_load_dwordx4 v[64:67], v2, s[36:39], s6 offen offset:1024 sc1
  buffer_load_dwordx4 v[68:71], v3, s[36:39], s6 offen offset:1024 sc1
  s_waitcnt vmcnt(22)
  v_mfma_f32_16x16x32_bf16 v[160:163], a[0:3], a[192:195], 0
  v_mfma_f32_16x16x32_bf16 v[164:167], a[4:7], a[192:195], 0
  buffer_load_dwordx4 v[72:75], v2, s[36:39], s6 offen offset:2048 sc1
  v_mfma_f32_16x16x32_bf16 v[168:171], a[8:11], a[192:195], 0
  v_mfma_f32_16x16x32_bf16 v[172:175], a[12:15], a[192:195], 0
  buffer_load_dwordx4 v[76:79], v3, s[36:39], s6 offen offset:2048 sc1
  v_mfma_f32_16x16x32_bf16 v[176:179], a[0:3], a[196:199], 0
  v_mfma_f32_16x16x32_bf16 v[180:183], a[4:7], a[196:199], 0
  buffer_load_dwordx4 v[80:83], v2, s[36:39], s7 offen offset:0 sc1
  v_mfma_f32_16x16x32_bf16 v[184:187], a[8:11], a[196:199], 0
  v_mfma_f32_16x16x32_bf16 v[188:191], a[12:15], a[196:199], 0
  buffer_load_dwordx4 v[84:87], v3, s[36:39], s7 offen offset:0 sc1
  s_waitcnt vmcnt(24)
  v_mfma_f32_16x16x32_bf16 v[160:163], a[16:19], a[200:203], v[160:163]
  v_mfma_f32_16x16x32_bf16 v[164:167], a[20:23], a[200:203], v[164:167]
  buffer_load_dwordx4 v[88:91], v2, s[36:39], s7 offen offset:1024 sc1
  v_mfma_f32_16x16x32_bf16 v[168:171], a[24:27], a[200:203], v[168:171]
  v_mfma_f32_16x16x32_bf16 v[172:175], a[28:31], a[200:203], v[172:175]
  buffer_load_dwordx4 v[92:95], v3, s[36:39], s7 offen offset:1024 sc1
  v_mfma_f32_16x16x32_bf16 v[176:179], a[16:19], a[204:207], v[176:179]
  v_mfma_f32_16x16x32_bf16 v[180:183], a[20:23], a[204:207], v[180:183]
  v_mfma_f32_16x16x32_bf16 v[184:187], a[24:27], a[204:207], v[184:187]
  v_mfma_f32_16x16x32_bf16 v[188:191], a[28:31], a[204:207], v[188:191]
  s_waitcnt vmcnt(24)
  v_mfma_f32_16x16x32_bf16 v[160:163], a[32:35], a[208:211], v[160:163]
  v_mfma_f32_16x16x32_bf16 v[164:167], a[36:39], a[208:211], v[164:167]
  v_mfma_f32_16x16x32_bf16 v[168:171], a[40:43], a[208:211], v[168:171]
  v_mfma_f32_16x16x32_bf16 v[172:175], a[44:47], a[208:211], v[172:175]
  v_mfma_f32_16x16x32_bf16 v[176:179], a[32:35], a[212:215], v[176:179]
  v_mfma_f32_16x16x32_bf16 v[180:183], a[36:39], a[212:215], v[180:183]
  v_mfma_f32_16x16x32_bf16 v[184:187], a[40:43], a[212:215], v[184:187]
  v_mfma_f32_16x16x32_bf16 v[188:191], a[44:47], a[212:215], v[188:191]
  s_waitcnt vmcnt(22)
  v_mfma_f32_16x16x32_bf16 v[160:163], a[48:51], a[216:219], v[160:163]
  v_mfma_f32_16x16x32_bf16 v[164:167], a[52:55], a[216:219], v[164:167]
  v_mfma_f32_16x16x32_bf16 v[168:171], a[56:59], a[216:219], v[168:171]
  v_mfma_f32_16x16x32_bf16 v[172:175], a[60:63], a[216:219], v[172:175]
  v_mfma_f32_16x16x32_bf16 v[176:179], a[48:51], a[220:223], v[176:179]
  v_mfma_f32_16x16x32_bf16 v[180:183], a[52:55], a[220:223], v[180:183]
  v_mfma_f32_16x16x32_bf16 v[184:187], a[56:59], a[220:223], v[184:187]
  v_mfma_f32_16x16x32_bf16 v[188:191], a[60:63], a[220:223], v[188:191]
  s_waitcnt vmcnt(12)
  s_barrier
  buffer_store_dword v125, v63, s[36:39], 0 offen sc1
  v_mfma_f32_16x16x32_bf16 v[160:163], a[64:67], v[96:99], v[160:163]
  v_mfma_f32_16x16x32_bf16 v[164:167], a[68:71], v[96:99], v[164:167]
  v_mfma_f32_16x16x32_bf16 v[168:171], a[72:75], v[96:99], v[168:171]
  v_mfma_f32_16x16x32_bf16 v[172:175], a[76:79], v[96:99], v[172:175]
  buffer_load_dwordx4 v[96:99], v2, s[36:39], s7 offen offset:2048 sc1
  v_mfma_f32_16x16x32_bf16 v[176:179], a[64:67], v[100:103], v[176:179]
  v_mfma_f32_16x16x32_bf16 v[180:183], a[68:71], v[100:103], v[180:183]
  v_mfma_f32_16x16x32_bf16 v[184:187], a[72:75], v[100:103], v[184:187]
  v_mfma_f32_16x16x32_bf16 v[188:191], a[76:79], v[100:103], v[188:191]
  buffer_load_dwordx4 v[100:103], v3, s[36:39], s7 offen offset:2048 sc1
  s_waitcnt vmcnt(13)
  v_mfma_f32_16x16x32_bf16 v[160:163], a[80:83], v[104:107], v[160:163]
  v_mfma_f32_16x16x32_bf16 v[164:167], a[84:87], v[104:107], v[164:167]
  v_mfma_f32_16x16x32_bf16 v[168:171], a[88:91], v[104:107], v[168:171]
  v_mfma_f32_16x16x32_bf16 v[172:175], a[92:95], v[104:107], v[172:175]
  buffer_load_dwordx4 v[104:107], v2, s[36:39], s8 offen offset:0 sc1
  v_mfma_f32_16x16x32_bf16 v[176:179], a[80:83], v[108:111], v[176:179]
  v_mfma_f32_16x16x32_bf16 v[180:183], a[84:87], v[108:111], v[180:183]
  v_mfma_f32_16x16x32_bf16 v[184:187], a[88:91], v[108:111], v[184:187]
  v_mfma_f32_16x16x32_bf16 v[188:191], a[92:95], v[108:111], v[188:191]
  buffer_load_dwordx4 v[108:111], v3, s[36:39], s8 offen offset:0 sc1
  s_waitcnt vmcnt(13)
  v_mfma_f32_16x16x32_bf16 v[160:163], a[96:99], v[112:115], v[160:163]
  v_mfma_f32_16x16x32_bf16 v[164:167], a[100:103], v[112:115], v[164:167]
  v_mfma_f32_16x16x32_bf16 v[168:171], a[104:107], v[112:115], v[168:171]
  v_mfma_f32_16x16x32_bf16 v[172:175], a[108:111], v[112:115], v[172:175]
  buffer_load_dwordx4 v[112:115], v2, s[36:39], s8 offen offset:1024 sc1
  v_mfma_f32_16x16x32_bf16 v[176:179], a[96:99], v[116:119], v[176:179]
  v_mfma_f32_16x16x32_bf16 v[180:183], a[100:103], v[116:119], v[180:183]
  v_mfma_f32_16x16x32_bf16 v[184:187], a[104:107], v[116:119], v[184:187]
  v_mfma_f32_16x16x32_bf16 v[188:191], a[108:111], v[116:119], v[188:191]
  buffer_load_dwordx4 v[116:119], v3, s[36:39], s8 offen offset:1024 sc1
  s_waitcnt vmcnt(13)
  v_mfma_f32_16x16x32_bf16 v[160:163], a[112:115], v[64:67], v[160:163]
  v_mfma_f32_16x16x32_bf16 v[164:167], a[116:119], v[64:67], v[164:167]
  v_mfma_f32_16x16x32_bf16 v[168:171], a[120:123], v[64:67], v[168:171]
  v_mfma_f32_16x16x32_bf16 v[172:175], a[124:127], v[64:67], v[172:175]
  buffer_load_dwordx4 v[64:67], v2, s[36:39], s8 offen offset:2048 sc1
  v_mfma_f32_16x16x32_bf16 v[176:179], a[112:115], v[68:71], v[176:179]
  v_mfma_f32_16x16x32_bf16 v[180:183], a[116:119], v[68:71], v[180:183]
  v_mfma_f32_16x16x32_bf16 v[184:187], a[120:123], v[68:71], v[184:187]
  v_mfma_f32_16x16x32_bf16 v[188:191], a[124:127], v[68:71], v[188:191]
  buffer_load_dwordx4 v[68:71], v3, s[36:39], s8 offen offset:2048 sc1
  s_waitcnt vmcnt(13)
  v_mfma_f32_16x16x32_bf16 v[160:163], a[128:131], v[72:75], v[160:163]
  v_mfma_f32_16x16x32_bf16 v[164:167], a[132:135], v[72:75], v[164:167]
  v_mfma_f32_16x16x32_bf16 v[168:171], a[136:139], v[72:75], v[168:171]
  v_mfma_f32_16x16x32_bf16 v[172:175], a[140:143], v[72:75], v[172:175]
  buffer_load_dwordx4 v[72:75], v2, s[36:39], s9 offen offset:0 sc1
  v_mfma_f32_16x16x32_bf16 v[176:179], a[128:131], v[76:79], v[176:179]
  v_mfma_f32_16x16x32_bf16 v[180:183], a[132:135], v[76:79], v[180:183]
  v_mfma_f32_16x16x32_bf16 v[184:187], a[136:139], v[76:79], v[184:187]
  v_mfma_f32_16x16x32_bf16 v[188:191], a[140:143], v[76:79], v[188:191]
  buffer_load_dwordx4 v[76:79], v3, s[36:39], s9 offen offset:0 sc1
  s_waitcnt vmcnt(13)
  v_mfma_f32_16x16x32_bf16 v[160:163], a[144:147], v[80:83], v[160:163]
  v_mfma_f32_16x16x32_bf16 v[164:167], a[148:151], v[80:83], v[164:167]
  v_mfma_f32_16x16x32_bf16 v[168:171], a[152:155], v[80:83], v[168:171]
  v_mfma_f32_16x16x32_bf16 v[172:175], a[156:159], v[80:83], v[172:175]
  buffer_load_dwordx4 v[80:83], v2, s[36:39], s9 offen offset:1024 sc1
  v_mfma_f32_16x16x32_bf16 v[176:179], a[144:147], v[84:87], v[176:179]
  v_mfma_f32_16x16x32_bf16 v[180:183], a[148:151], v[84:87], v[180:183]
  v_mfma_f32_16x16x32_bf16 v[184:187], a[152:155], v[84:87], v[184:187]
  v_mfma_f32_16x16x32_bf16 v[188:191], a[156:159], v[84:87], v[188:191]
  buffer_load_dwordx4 v[84:87], v3, s[36:39], s9 offen offset:1024 sc1
  s_waitcnt vmcnt(63) lgkmcnt(0)
  s_barrier
  s_waitcnt vmcnt(13)
  v_mfma_f32_16x16x32_bf16 v[160:163], a[160:163], v[88:91], v[160:163]
  v_add_u32 v52, 0xfffe8000, v52
  v_add_u32 v53, 0xfffe8000, v53
  v_add_u32 v54, 0xfffe8000, v54
  v_add_u32 v55, 0xfffe8000, v55
  ds_read_b64_tr_b16 a[192:193], v52 offset:16384
  ds_read_b64_tr_b16 a[194:195], v52 offset:18432
  v_mfma_f32_16x16x32_bf16 v[164:167], a[164:167], v[88:91], v[164:167]
  ds_read_b64_tr_b16 a[196:197], v53 offset:16384
  v_mfma_f32_16x16x32_bf16 v[168:171], a[168:171], v[88:91], v[168:171]
  ds_read_b64_tr_b16 a[198:199], v53 offset:18432
  v_mfma_f32_16x16x32_bf16 v[172:175], a[172:175], v[88:91], v[172:175]
  buffer_load_dwordx4 v[88:91], v2, s[36:39], s9 offen offset:2048 sc1
  v_mfma_f32_16x16x32_bf16 v[176:179], a[160:163], v[92:95], v[176:179]
  ds_read_b64_tr_b16 a[200:201], v54 offset:16384
  ds_read_b64_tr_b16 a[202:203], v54 offset:18432
  v_mfma_f32_16x16x32_bf16 v[180:183], a[164:167], v[92:95], v[180:183]
  ds_read_b64_tr_b16 a[204:205], v55 offset:16384
  v_mfma_f32_16x16x32_bf16 v[184:187], a[168:171], v[92:95], v[184:187]
  ds_read_b64_tr_b16 a[206:207], v55 offset:18432
  v_mfma_f32_16x16x32_bf16 v[188:191], a[172:175], v[92:95], v[188:191]
  buffer_load_dwordx4 v[92:95], v3, s[36:39], s9 offen offset:2048 sc1
  s_waitcnt vmcnt(12)
  v_mfma_f32_16x16x32_bf16 v[160:163], a[176:179], v[96:99], v[160:163]
  ds_read_b64_tr_b16 a[208:209], v52 offset:24576
  ds_read_b64_tr_b16 a[210:211], v52 offset:26624
  v_mfma_f32_16x16x32_bf16 v[164:167], a[180:183], v[96:99], v[164:167]
  ds_read_b64_tr_b16 a[212:213], v53 offset:24576
  v_mfma_f32_16x16x32_bf16 v[168:171], a[184:187], v[96:99], v[168:171]
  ds_read_b64_tr_b16 a[214:215], v53 offset:26624
  v_mfma_f32_16x16x32_bf16 v[172:175], a[188:191], v[96:99], v[172:175]
  buffer_load_dwordx4 v[96:99], v2, s[36:39], s20 offen offset:0 sc1
  v_mfma_f32_16x16x32_bf16 v[176:179], a[176:179], v[100:103], v[176:179]
  ds_read_b64_tr_b16 a[216:217], v54 offset:24576
  ds_read_b64_tr_b16 a[218:219], v54 offset:26624
  v_mfma_f32_16x16x32_bf16 v[180:183], a[180:183], v[100:103], v[180:183]
  ds_read_b64_tr_b16 a[220:221], v55 offset:24576
  v_mfma_f32_16x16x32_bf16 v[184:187], a[184:187], v[100:103], v[184:187]
  ds_read_b64_tr_b16 a[222:223], v55 offset:26624
  v_mfma_f32_16x16x32_bf16 v[188:191], a[188:191], v[100:103], v[188:191]
  buffer_load_dwordx4 v[100:103], v3, s[36:39], s20 offen offset:0 sc1
  s_waitcnt vmcnt(12) lgkmcnt(8)
  v_mfma_f32_16x16x32_bf16 v[160:163], a[192:195], v[104:107], v[160:163]
  ds_read_b64_tr_b16 a[224:225], v52 offset:32768
  ds_read_b64_tr_b16 a[226:227], v52 offset:34816
  v_mfma_f32_16x16x32_bf16 v[164:167], a[196:199], v[104:107], v[164:167]
  ds_read_b64_tr_b16 a[228:229], v53 offset:32768
  v_mfma_f32_16x16x32_bf16 v[168:171], a[200:203], v[104:107], v[168:171]
  ds_read_b64_tr_b16 a[230:231], v53 offset:34816
  v_mfma_f32_16x16x32_bf16 v[172:175], a[204:207], v[104:107], v[172:175]
  buffer_load_dwordx4 v[104:107], v2, s[36:39], s20 offen offset:1024 sc1
  v_mfma_f32_16x16x32_bf16 v[176:179], a[192:195], v[108:111], v[176:179]
  ds_read_b64_tr_b16 a[232:233], v54 offset:32768
  ds_read_b64_tr_b16 a[234:235], v54 offset:34816
  v_mfma_f32_16x16x32_bf16 v[180:183], a[196:199], v[108:111], v[180:183]
  ds_read_b64_tr_b16 a[236:237], v55 offset:32768
  v_mfma_f32_16x16x32_bf16 v[184:187], a[200:203], v[108:111], v[184:187]
  ds_read_b64_tr_b16 a[238:239], v55 offset:34816
  v_mfma_f32_16x16x32_bf16 v[188:191], a[204:207], v[108:111], v[188:191]
  buffer_load_dwordx4 v[108:111], v3, s[36:39], s20 offen offset:1024 sc1
  s_waitcnt vmcnt(12) lgkmcnt(8)
  v_mfma_f32_16x16x32_bf16 v[160:163], a[208:211], v[112:115], v[160:163]
  ds_read_b64_tr_b16 a[240:241], v52 offset:40960
  ds_read_b64_tr_b16 a[242:243], v52 offset:43008
  v_mfma_f32_16x16x32_bf16 v[164:167], a[212:215], v[112:115], v[164:167]
  ds_read_b64_tr_b16 a[244:245], v53 offset:40960
  v_mfma_f32_16x16x32_bf16 v[168:171], a[216:219], v[112:115], v[168:171]
  ds_read_b64_tr_b16 a[246:247], v53 offset:43008
  v_mfma_f32_16x16x32_bf16 v[172:175], a[220:223], v[112:115], v[172:175]
  buffer_load_dwordx4 v[112:115], v2, s[36:39], s20 offen offset:2048 sc1
  v_mfma_f32_16x16x32_bf16 v[176:179], a[208:211], v[116:119], v[176:179]
  ds_read_b64_tr_b16 a[248:249], v54 offset:40960
  ds_read_b64_tr_b16 a[250:251], v54 offset:43008
  v_mfma_f32_16x16x32_bf16 v[180:183], a[212:215], v[116:119], v[180:183]
  ds_read_b64_tr_b16 a[252:253], v55 offset:40960
  v_mfma_f32_16x16x32_bf16 v[184:187], a[216:219], v[116:119], v[184:187]
  ds_read_b64_tr_b16 a[254:255], v55 offset:43008
  v_mfma_f32_16x16x32_bf16 v[188:191], a[220:223], v[116:119], v[188:191]
  buffer_load_dwordx4 v[116:119], v3, s[36:39], s20 offen offset:2048 sc1
  s_waitcnt vmcnt(12) lgkmcnt(8)
  v_mfma_f32_16x16x32_bf16 v[160:163], a[224:227], v[64:67], v[160:163]
  ds_read_b64_tr_b16 a[192:193], v52 offset:49152
  ds_read_b64_tr_b16 a[194:195], v52 offset:51200
  v_mfma_f32_16x16x32_bf16 v[164:167], a[228:231], v[64:67], v[164:167]
  ds_read_b64_tr_b16 a[196:197], v53 offset:49152
  v_mfma_f32_16x16x32_bf16 v[168:171], a[232:235], v[64:67], v[168:171]
  ds_read_b64_tr_b16 a[198:199], v53 offset:51200
  v_mfma_f32_16x16x32_bf16 v[172:175], a[236:239], v[64:67], v[172:175]
  buffer_load_dwordx4 v[64:67], v2, s[36:39], s21 offen offset:0 sc1
  v_mfma_f32_16x16x32_bf16 v[176:179], a[224:227], v[68:71], v[176:179]
  ds_read_b64_tr_b16 a[200:201], v54 offset:49152
  ds_read_b64_tr_b16 a[202:203], v54 offset:51200
  v_mfma_f32_16x16x32_bf16 v[180:183], a[228:231], v[68:71], v[180:183]
  ds_read_b64_tr_b16 a[204:205], v55 offset:49152
  v_mfma_f32_16x16x32_bf16 v[184:187], a[232:235], v[68:71], v[184:187]
  ds_read_b64_tr_b16 a[206:207], v55 offset:51200
  v_mfma_f32_16x16x32_bf16 v[188:191], a[236:239], v[68:71], v[188:191]
  buffer_load_dwordx4 v[68:71], v3, s[36:39], s21 offen offset:0 sc1
  s_waitcnt lgkmcnt(0)
  s_barrier
  s_waitcnt vmcnt(12)
  v_mfma_f32_16x16x32_bf16 v[160:163], a[240:243], v[72:75], v[160:163]
  ds_read_b64_tr_b16 a[208:209], v52 offset:57344
  ds_read_b64_tr_b16 a[210:211], v52 offset:59392
  v_mfma_f32_16x16x32_bf16 v[164:167], a[244:247], v[72:75], v[164:167]
  ds_read_b64_tr_b16 a[212:213], v53 offset:57344
  v_mfma_f32_16x16x32_bf16 v[168:171], a[248:251], v[72:75], v[168:171]
  ds_read_b64_tr_b16 a[214:215], v53 offset:59392
  s_add_u32 m0, s76, 16384
  s_mul_i32 s17, s13, 40
  v_mfma_f32_16x16x32_bf16 v[172:175], a[252:255], v[72:75], v[172:175]
  buffer_load_dwordx4 v[72:75], v2, s[36:39], s21 offen offset:1024 sc1
  v_mfma_f32_16x16x32_bf16 v[176:179], a[240:243], v[76:79], v[176:179]
  ds_read_b64_tr_b16 a[216:217], v54 offset:57344
  ds_read_b64_tr_b16 a[218:219], v54 offset:59392
  v_mfma_f32_16x16x32_bf16 v[180:183], a[244:247], v[76:79], v[180:183]
  ds_read_b64_tr_b16 a[220:221], v55 offset:57344
  buffer_load_dwordx4 v50, s[44:47], s17 offen  lds
  buffer_load_dwordx4 v51, s[44:47], s17 offen offset:1024  lds
  v_mfma_f32_16x16x32_bf16 v[184:187], a[248:251], v[76:79], v[184:187]
  ds_read_b64_tr_b16 a[222:223], v55 offset:59392
  v_mfma_f32_16x16x32_bf16 v[188:191], a[252:255], v[76:79], v[188:191]
  buffer_load_dwordx4 v[76:79], v3, s[36:39], s21 offen offset:1024 sc1
  s_waitcnt vmcnt(14) lgkmcnt(8)
  v_mfma_f32_16x16x32_bf16 v[160:163], a[192:195], v[80:83], v[160:163]
  v_add_u32 v52, 0x10000, v52
  v_add_u32 v53, 0x10000, v53
  v_add_u32 v54, 0x10000, v54
  v_add_u32 v55, 0x10000, v55
  ds_read_b64_tr_b16 a[224:225], v52 offset:0
  ds_read_b64_tr_b16 a[226:227], v52 offset:2048
  v_mfma_f32_16x16x32_bf16 v[164:167], a[196:199], v[80:83], v[164:167]
  ds_read_b64_tr_b16 a[228:229], v53 offset:0
  v_mfma_f32_16x16x32_bf16 v[168:171], a[200:203], v[80:83], v[168:171]
  ds_read_b64_tr_b16 a[230:231], v53 offset:2048
  s_add_u32 m0, s76, 24576
  s_add_u32 s17, s17, 40960
  v_mfma_f32_16x16x32_bf16 v[172:175], a[204:207], v[80:83], v[172:175]
  buffer_load_dwordx4 v[80:83], v2, s[36:39], s21 offen offset:2048 sc1
  v_mfma_f32_16x16x32_bf16 v[176:179], a[192:195], v[84:87], v[176:179]
  ds_read_b64_tr_b16 a[232:233], v54 offset:0
  ds_read_b64_tr_b16 a[234:235], v54 offset:2048
  v_mfma_f32_16x16x32_bf16 v[180:183], a[196:199], v[84:87], v[180:183]
  ds_read_b64_tr_b16 a[236:237], v55 offset:0
  buffer_load_dwordx4 v50, s[44:47], s17 offen  lds
  buffer_load_dwordx4 v51, s[44:47], s17 offen offset:1024  lds
  v_mfma_f32_16x16x32_bf16 v[184:187], a[200:203], v[84:87], v[184:187]
  ds_read_b64_tr_b16 a[238:239], v55 offset:2048
  v_mfma_f32_16x16x32_bf16 v[188:191], a[204:207], v[84:87], v[188:191]
  buffer_load_dwordx4 v[84:87], v3, s[36:39], s21 offen offset:2048 sc1
  s_waitcnt vmcnt(16) lgkmcnt(8)
  v_mfma_f32_16x16x32_bf16 v[160:163], a[208:211], v[88:91], v[160:163]
  ds_read_b64_tr_b16 a[240:241], v52 offset:8192
  ds_read_b64_tr_b16 a[242:243], v52 offset:10240
  v_mfma_f32_16x16x32_bf16 v[164:167], a[212:215], v[88:91], v[164:167]
  ds_read_b64_tr_b16 a[244:245], v53 offset:8192
  v_mfma_f32_16x16x32_bf16 v[168:171], a[216:219], v[88:91], v[168:171]
  ds_read_b64_tr_b16 a[246:247], v53 offset:10240
  s_add_u32 m0, s76, 32768
  s_mul_i32 s17, s16, 40
  v_mfma_f32_16x16x32_bf16 v[172:175], a[220:223], v[88:91], v[172:175]
  v_mfma_f32_16x16x32_bf16 v[176:179], a[208:211], v[92:95], v[176:179]
  ds_read_b64_tr_b16 a[248:249], v54 offset:8192
  ds_read_b64_tr_b16 a[250:251], v54 offset:10240
  v_mfma_f32_16x16x32_bf16 v[180:183], a[212:215], v[92:95], v[180:183]
  ds_read_b64_tr_b16 a[252:253], v55 offset:8192
  buffer_load_dwordx4 v50, s[44:47], s17 offen  lds
  buffer_load_dwordx4 v51, s[44:47], s17 offen offset:1024  lds
  v_mfma_f32_16x16x32_bf16 v[184:187], a[216:219], v[92:95], v[184:187]
  ds_read_b64_tr_b16 a[254:255], v55 offset:10240
  v_mfma_f32_16x16x32_bf16 v[188:191], a[220:223], v[92:95], v[188:191]
  s_waitcnt vmcnt(16) lgkmcnt(8)
  v_mfma_f32_16x16x32_bf16 v[160:163], a[224:227], v[96:99], v[160:163]
  ds_read_b64_tr_b16 a[192:193], v52 offset:16384
  ds_read_b64_tr_b16 a[194:195], v52 offset:18432
  v_mfma_f32_16x16x32_bf16 v[164:167], a[228:231], v[96:99], v[164:167]
  ds_read_b64_tr_b16 a[196:197], v53 offset:16384
  v_mfma_f32_16x16x32_bf16 v[168:171], a[232:235], v[96:99], v[168:171]
  ds_read_b64_tr_b16 a[198:199], v53 offset:18432
  s_add_u32 m0, s76, 40960
  s_add_u32 s17, s17, 40960
  v_mfma_f32_16x16x32_bf16 v[172:175], a[236:239], v[96:99], v[172:175]
  v_mfma_f32_16x16x32_bf16 v[176:179], a[224:227], v[100:103], v[176:179]
  ds_read_b64_tr_b16 a[200:201], v54 offset:16384
  ds_read_b64_tr_b16 a[202:203], v54 offset:18432
  v_mfma_f32_16x16x32_bf16 v[180:183], a[228:231], v[100:103], v[180:183]
  ds_read_b64_tr_b16 a[204:205], v55 offset:16384
  buffer_load_dwordx4 v50, s[44:47], s17 offen  lds
  buffer_load_dwordx4 v51, s[44:47], s17 offen offset:1024  lds
  v_mfma_f32_16x16x32_bf16 v[184:187], a[232:235], v[100:103], v[184:187]
  ds_read_b64_tr_b16 a[206:207], v55 offset:18432
  v_mfma_f32_16x16x32_bf16 v[188:191], a[236:239], v[100:103], v[188:191]
  s_waitcnt vmcnt(16) lgkmcnt(8)
  v_mfma_f32_16x16x32_bf16 v[160:163], a[240:243], v[104:107], v[160:163]
  ds_read_b64_tr_b16 a[208:209], v52 offset:24576
  ds_read_b64_tr_b16 a[210:211], v52 offset:26624
  v_mfma_f32_16x16x32_bf16 v[164:167], a[244:247], v[104:107], v[164:167]
  ds_read_b64_tr_b16 a[212:213], v53 offset:24576
  v_mfma_f32_16x16x32_bf16 v[168:171], a[248:251], v[104:107], v[168:171]
  ds_read_b64_tr_b16 a[214:215], v53 offset:26624
  v_mfma_f32_16x16x32_bf16 v[172:175], a[252:255], v[104:107], v[172:175]
  v_mfma_f32_16x16x32_bf16 v[176:179], a[240:243], v[108:111], v[176:179]
  ds_read_b64_tr_b16 a[216:217], v54 offset:24576
  ds_read_b64_tr_b16 a[218:219], v54 offset:26624
  v_mfma_f32_16x16x32_bf16 v[180:183], a[244:247], v[108:111], v[180:183]
  ds_read_b64_tr_b16 a[220:221], v55 offset:24576
  v_mfma_f32_16x16x32_bf16 v[184:187], a[248:251], v[108:111], v[184:187]
  ds_read_b64_tr_b16 a[222:223], v55 offset:26624
  v_mfma_f32_16x16x32_bf16 v[188:191], a[252:255], v[108:111], v[188:191]
  s_waitcnt vmcnt(14) lgkmcnt(8)
  v_mfma_f32_16x16x32_bf16 v[160:163], a[192:195], v[112:115], v[160:163]
  v_add_u32 v52, 0xffff0000, v52
  v_add_u32 v53, 0xffff0000, v53
  v_add_u32 v54, 0xffff0000, v54
  v_add_u32 v55, 0xffff0000, v55
  ds_read_b64_tr_b16 a[224:225], v52 offset:0
  ds_read_b64_tr_b16 a[226:227], v52 offset:2048
  v_mfma_f32_16x16x32_bf16 v[164:167], a[196:199], v[112:115], v[164:167]
  ds_read_b64_tr_b16 a[228:229], v53 offset:0
  v_mfma_f32_16x16x32_bf16 v[168:171], a[200:203], v[112:115], v[168:171]
  ds_read_b64_tr_b16 a[230:231], v53 offset:2048
  buffer_load_dword v61, v124, s[36:39], s54 offen offset:2048 sc1
  v_mfma_f32_16x16x32_bf16 v[172:175], a[204:207], v[112:115], v[172:175]
  v_mfma_f32_16x16x32_bf16 v[176:179], a[192:195], v[116:119], v[176:179]
  ds_read_b64_tr_b16 a[232:233], v54 offset:0
  ds_read_b64_tr_b16 a[234:235], v54 offset:2048
  v_mfma_f32_16x16x32_bf16 v[180:183], a[196:199], v[116:119], v[180:183]
  ds_read_b64_tr_b16 a[236:237], v55 offset:0
  v_mfma_f32_16x16x32_bf16 v[184:187], a[200:203], v[116:119], v[184:187]
  ds_read_b64_tr_b16 a[238:239], v55 offset:2048
  v_mfma_f32_16x16x32_bf16 v[188:191], a[204:207], v[116:119], v[188:191]
  s_waitcnt vmcnt(13) lgkmcnt(8)
  v_mfma_f32_16x16x32_bf16 v[160:163], a[208:211], v[64:67], v[160:163]
  ds_read_b64_tr_b16 a[240:241], v52 offset:8192
  ds_read_b64_tr_b16 a[242:243], v52 offset:10240
  v_mfma_f32_16x16x32_bf16 v[164:167], a[212:215], v[64:67], v[164:167]
  ds_read_b64_tr_b16 a[244:245], v53 offset:8192
  v_mfma_f32_16x16x32_bf16 v[168:171], a[216:219], v[64:67], v[168:171]
  ds_read_b64_tr_b16 a[246:247], v53 offset:10240
  v_mfma_f32_16x16x32_bf16 v[172:175], a[220:223], v[64:67], v[172:175]
  v_mfma_f32_16x16x32_bf16 v[176:179], a[208:211], v[68:71], v[176:179]
  ds_read_b64_tr_b16 a[248:249], v54 offset:8192
  ds_read_b64_tr_b16 a[250:251], v54 offset:10240
  v_mfma_f32_16x16x32_bf16 v[180:183], a[212:215], v[68:71], v[180:183]
  ds_read_b64_tr_b16 a[252:253], v55 offset:8192
  v_mfma_f32_16x16x32_bf16 v[184:187], a[216:219], v[68:71], v[184:187]
  ds_read_b64_tr_b16 a[254:255], v55 offset:10240
  v_mfma_f32_16x16x32_bf16 v[188:191], a[220:223], v[68:71], v[188:191]
  s_waitcnt vmcnt(63) lgkmcnt(0)
  s_barrier
  s_waitcnt vmcnt(9)
  v_mfma_f32_16x16x32_bf16 v[160:163], a[224:227], v[72:75], v[160:163]
  v_add_u32 v56, 0x18000, v56
  v_add_u32 v57, 0x18000, v57
  v_add_u32 v58, 0x18000, v58
  v_add_u32 v59, 0x18000, v59
  ds_read_b64_tr_b16 a[192:193], v56 offset:0
  ds_read_b64_tr_b16 a[194:195], v56 offset:512
  v_mfma_f32_16x16x32_bf16 v[164:167], a[228:231], v[72:75], v[164:167]
  ds_read_b64_tr_b16 a[196:197], v57 offset:0
  v_mfma_f32_16x16x32_bf16 v[168:171], a[232:235], v[72:75], v[168:171]
  ds_read_b64_tr_b16 a[198:199], v57 offset:512
  v_mfma_f32_16x16x32_bf16 v[172:175], a[236:239], v[72:75], v[172:175]
  v_mfma_f32_16x16x32_bf16 v[176:179], a[224:227], v[76:79], v[176:179]
  ds_read_b64_tr_b16 a[200:201], v58 offset:0
  ds_read_b64_tr_b16 a[202:203], v58 offset:512
  v_mfma_f32_16x16x32_bf16 v[180:183], a[228:231], v[76:79], v[180:183]
  ds_read_b64_tr_b16 a[204:205], v59 offset:0
  v_mfma_f32_16x16x32_bf16 v[184:187], a[232:235], v[76:79], v[184:187]
  ds_read_b64_tr_b16 a[206:207], v59 offset:512
  v_mfma_f32_16x16x32_bf16 v[188:191], a[236:239], v[76:79], v[188:191]
  s_waitcnt vmcnt(5) lgkmcnt(8)
  v_mfma_f32_16x16x32_bf16 v[160:163], a[240:243], v[80:83], v[160:163]
  ds_read_b64_tr_b16 a[208:209], v56 offset:8192
  ds_read_b64_tr_b16 a[210:211], v56 offset:8704
  v_mfma_f32_16x16x32_bf16 v[164:167], a[244:247], v[80:83], v[164:167]
  ds_read_b64_tr_b16 a[212:213], v57 offset:8192
  v_mfma_f32_16x16x32_bf16 v[168:171], a[248:251], v[80:83], v[168:171]
  ds_read_b64_tr_b16 a[214:215], v57 offset:8704
  v_mfma_f32_16x16x32_bf16 v[172:175], a[252:255], v[80:83], v[172:175]
  v_mfma_f32_16x16x32_bf16 v[176:179], a[240:243], v[84:87], v[176:179]
  ds_read_b64_tr_b16 a[216:217], v58 offset:8192
  ds_read_b64_tr_b16 a[218:219], v58 offset:8704
  v_mfma_f32_16x16x32_bf16 v[180:183], a[244:247], v[84:87], v[180:183]
  ds_read_b64_tr_b16 a[220:221], v59 offset:8192
  v_mfma_f32_16x16x32_bf16 v[184:187], a[248:251], v[84:87], v[184:187]
  ds_read_b64_tr_b16 a[222:223], v59 offset:8704
  v_mfma_f32_16x16x32_bf16 v[188:191], a[252:255], v[84:87], v[188:191]
  v_add_u32 v2, s79, v2
  v_add_u32 v3, s79, v3
  s_waitcnt vmcnt(0)
  v_cmp_gt_u32 vcc, s53, v61
  s_nop 0
  s_cmp_eq_u64 vcc, 0
  s_cbranch_scc0 Lslow_9
Lback_10:
  s_waitcnt lgkmcnt(0)
  s_barrier
  buffer_load_dwordx4 a[0:3], v2, s[36:39], s10 offen offset:0 sc1
  buffer_load_dwordx4 a[4:7], v3, s[36:39], s10 offen offset:0 sc1
  buffer_load_dwordx4 a[8:11], v2, s[36:39], s10 offen offset:1024 sc1
  buffer_load_dwordx4 a[12:15], v3, s[36:39], s10 offen offset:1024 sc1
  buffer_load_dwordx4 a[16:19], v2, s[36:39], s11 offen offset:0 sc1
  buffer_load_dwordx4 a[20:23], v3, s[36:39], s11 offen offset:0 sc1
  ds_write_b128 v9, v[168:171] offset:0
  ds_write_b128 v9, v[172:175] offset:1024
  ds_write_b128 v9, v[184:187] offset:2048
  ds_write_b128 v9, v[188:191] offset:3072
  v_lshlrev_b32 v40, 16, v24
  v_and_b32 v41, 0xffff0000, v24
  v_lshlrev_b32 v42, 16, v25
  v_and_b32 v43, 0xffff0000, v25
  v_lshlrev_b32 v44, 16, v26
  v_and_b32 v45, 0xffff0000, v26
  v_lshlrev_b32 v46, 16, v27
  v_and_b32 v47, 0xffff0000, v27
  v_permlane16_swap_b32 v12, v14
  v_permlane16_swap_b32 v13, v15
  v_permlane16_swap_b32 v16, v18
  v_permlane16_swap_b32 v17, v19
  v_pk_add_f32 v[160:161], v[160:161], v[40:41]
  v_pk_add_f32 v[162:163], v[162:163], v[42:43]
  v_pk_add_f32 v[164:165], v[164:165], v[44:45]
  v_pk_add_f32 v[166:167], v[166:167], v[46:47]
  v_pk_add_f32 v[176:177], v[176:177], v[40:41]
  v_pk_add_f32 v[178:179], v[178:179], v[42:43]
  v_pk_add_f32 v[180:181], v[180:181], v[44:45]
  v_pk_add_f32 v[182:183], v[182:183], v[46:47]
  s_waitcnt lgkmcnt(0)
  s_barrier
  ds_read_b128 v[64:67], v10 offset:0
  ds_read_b128 v[68:71], v10 offset:1024
  ds_read_b128 v[72:75], v10 offset:2048
  ds_read_b128 v[76:79], v10 offset:3072
  buffer_load_dwordx4 a[24:27], v2, s[36:39], s11 offen offset:1024 sc1
  buffer_load_dwordx4 a[28:31], v3, s[36:39], s11 offen offset:1024 sc1
  buffer_load_dwordx4 a[32:35], v2, s[36:39], s12 offen offset:0 sc1
  buffer_load_dwordx4 a[36:39], v3, s[36:39], s12 offen offset:0 sc1
  buffer_load_dwordx4 a[40:43], v2, s[36:39], s12 offen offset:1024 sc1
  buffer_load_dwordx4 a[44:47], v3, s[36:39], s12 offen offset:1024 sc1
  v_lshlrev_b32 v88, 16, v12
  v_and_b32 v89, 0xffff0000, v12
  v_lshlrev_b32 v90, 16, v13
  v_and_b32 v91, 0xffff0000, v13
  v_lshlrev_b32 v92, 16, v14
  v_and_b32 v93, 0xffff0000, v14
  v_lshlrev_b32 v94, 16, v15
  v_and_b32 v95, 0xffff0000, v15
  v_lshlrev_b32 v96, 16, v16
  v_and_b32 v97, 0xffff0000, v16
  v_lshlrev_b32 v98, 16, v17
  v_and_b32 v99, 0xffff0000, v17
  v_lshlrev_b32 v100, 16, v18
  v_and_b32 v101, 0xffff0000, v18
  v_lshlrev_b32 v102, 16, v19
  v_and_b32 v103, 0xffff0000, v19
  s_waitcnt lgkmcnt(0)
  s_nop 0
  v_pk_add_f32 v[160:161], v[160:161], v[64:65]
  v_pk_add_f32 v[162:163], v[162:163], v[66:67]
  v_pk_add_f32 v[164:165], v[164:165], v[68:69]
  v_pk_add_f32 v[166:167], v[166:167], v[70:71]
  v_pk_add_f32 v[176:177], v[176:177], v[72:73]
  v_pk_add_f32 v[178:179], v[178:179], v[74:75]
  v_pk_add_f32 v[180:181], v[180:181], v[76:77]
  v_pk_add_f32 v[182:183], v[182:183], v[78:79]
  v_pk_mul_f32 v[168:169], v[160:161], s[80:81] op_sel_hi:[1,0] neg_lo:[1,0] neg_hi:[1,0]
  v_pk_mul_f32 v[170:171], v[162:163], s[80:81] op_sel_hi:[1,0] neg_lo:[1,0] neg_hi:[1,0]
  v_pk_mul_f32 v[172:173], v[164:165], s[80:81] op_sel_hi:[1,0] neg_lo:[1,0] neg_hi:[1,0]
  v_pk_mul_f32 v[174:175], v[166:167], s[80:81] op_sel_hi:[1,0] neg_lo:[1,0] neg_hi:[1,0]
  v_pk_mul_f32 v[184:185], v[176:177], s[80:81] op_sel_hi:[1,0] neg_lo:[1,0] neg_hi:[1,0]
  v_pk_mul_f32 v[186:187], v[178:179], s[80:81] op_sel_hi:[1,0] neg_lo:[1,0] neg_hi:[1,0]
  v_pk_mul_f32 v[188:189], v[180:181], s[80:81] op_sel_hi:[1,0] neg_lo:[1,0] neg_hi:[1,0]
  v_pk_mul_f32 v[190:191], v[182:183], s[80:81] op_sel_hi:[1,0] neg_lo:[1,0] neg_hi:[1,0]
  v_exp_f32 v168, v168
  v_exp_f32 v169, v169
  v_exp_f32 v170, v170
  v_exp_f32 v171, v171
  v_exp_f32 v172, v172
  v_exp_f32 v173, v173
  v_exp_f32 v174, v174
  v_exp_f32 v175, v175
  v_exp_f32 v184, v184
  v_exp_f32 v185, v185
  v_exp_f32 v186, v186
  v_exp_f32 v187, v187
  v_exp_f32 v188, v188
  v_exp_f32 v189, v189
  v_exp_f32 v190, v190
  v_exp_f32 v191, v191
  v_pk_add_f32 v[168:169], v[168:169], s[90:91] op_sel_hi:[1,0]
  v_pk_add_f32 v[170:171], v[170:171], s[90:91] op_sel_hi:[1,0]
  v_pk_add_f32 v[172:173], v[172:173], s[90:91] op_sel_hi:[1,0]
  v_pk_add_f32 v[174:175], v[174:175], s[90:91] op_sel_hi:[1,0]
  v_pk_add_f32 v[184:185], v[184:185], s[90:91] op_sel_hi:[1,0]
  v_pk_add_f32 v[186:187], v[186:187], s[90:91] op_sel_hi:[1,0]
  v_pk_add_f32 v[188:189], v[188:189], s[90:91] op_sel_hi:[1,0]
  v_pk_add_f32 v[190:191], v[190:191], s[90:91] op_sel_hi:[1,0]
  v_rcp_f32 v168, v168
  v_rcp_f32 v169, v169
  v_rcp_f32 v170, v170
  v_rcp_f32 v171, v171
  v_rcp_f32 v172, v172
  v_rcp_f32 v173, v173
  v_rcp_f32 v174, v174
  v_rcp_f32 v175, v175
  v_rcp_f32 v184, v184
  v_rcp_f32 v185, v185
  v_rcp_f32 v186, v186
  v_rcp_f32 v187, v187
  v_rcp_f32 v188, v188
  v_rcp_f32 v189, v189
  v_rcp_f32 v190, v190
  v_rcp_f32 v191, v191
  v_pk_mul_f32 v[160:161], v[160:161], v[168:169]
  v_pk_mul_f32 v[162:163], v[162:163], v[170:171]
  v_pk_mul_f32 v[164:165], v[164:165], v[172:173]
  v_pk_mul_f32 v[166:167], v[166:167], v[174:175]
  v_pk_mul_f32 v[176:177], v[176:177], v[184:185]
  v_pk_mul_f32 v[178:179], v[178:179], v[186:187]
  v_pk_mul_f32 v[180:181], v[180:181], v[188:189]
  v_pk_mul_f32 v[182:183], v[182:183], v[190:191]
  s_waitcnt vmcnt(10)
  v_mfma_f32_16x16x32_bf16 v[208:211], a[192:195], a[0:3], 0
  ds_read_b64_tr_b16 a[224:225], v56 offset:16384
  ds_read_b64_tr_b16 a[226:227], v56 offset:16896
  v_mfma_f32_16x16x32_bf16 v[212:215], a[196:199], a[0:3], 0
  ds_read_b64_tr_b16 a[228:229], v57 offset:16384
  buffer_load_dwordx4 a[48:51], v2, s[36:39], s13 offen offset:0 sc1
  v_mfma_f32_16x16x32_bf16 v[216:219], a[200:203], a[0:3], 0
  ds_read_b64_tr_b16 a[230:231], v57 offset:16896
  v_mfma_f32_16x16x32_bf16 v[220:223], a[204:207], a[0:3], 0
  buffer_load_dwordx4 a[52:55], v3, s[36:39], s13 offen offset:0 sc1
  v_mfma_f32_16x16x32_bf16 v[224:227], a[192:195], a[4:7], 0
  ds_read_b64_tr_b16 a[232:233], v58 offset:16384
  ds_read_b64_tr_b16 a[234:235], v58 offset:16896
  v_mfma_f32_16x16x32_bf16 v[228:231], a[196:199], a[4:7], 0
  ds_read_b64_tr_b16 a[236:237], v59 offset:16384
  buffer_load_dwordx4 a[56:59], v2, s[36:39], s13 offen offset:1024 sc1
  v_mfma_f32_16x16x32_bf16 v[232:235], a[200:203], a[4:7], 0
  ds_read_b64_tr_b16 a[238:239], v59 offset:16896
  v_mfma_f32_16x16x32_bf16 v[236:239], a[204:207], a[4:7], 0
  buffer_load_dwordx4 a[60:63], v3, s[36:39], s13 offen offset:1024 sc1
  s_waitcnt vmcnt(12) lgkmcnt(8)
  v_mfma_f32_16x16x32_bf16 v[208:211], a[208:211], a[8:11], v[208:211]
  ds_read_b64_tr_b16 a[240:241], v56 offset:24576
  ds_read_b64_tr_b16 a[242:243], v56 offset:25088
  v_mfma_f32_16x16x32_bf16 v[212:215], a[212:215], a[8:11], v[212:215]
  ds_read_b64_tr_b16 a[244:245], v57 offset:24576
  buffer_load_dwordx4 a[64:67], v2, s[36:39], s16 offen offset:0 sc1
  v_mfma_f32_16x16x32_bf16 v[216:219], a[216:219], a[8:11], v[216:219]
  ds_read_b64_tr_b16 a[246:247], v57 offset:25088
  v_mfma_f32_16x16x32_bf16 v[220:223], a[220:223], a[8:11], v[220:223]
  buffer_load_dwordx4 a[68:71], v3, s[36:39], s16 offen offset:0 sc1
  v_mfma_f32_16x16x32_bf16 v[224:227], a[208:211], a[12:15], v[224:227]
  ds_read_b64_tr_b16 a[248:249], v58 offset:24576
  ds_read_b64_tr_b16 a[250:251], v58 offset:25088
  v_mfma_f32_16x16x32_bf16 v[228:231], a[212:215], a[12:15], v[228:231]
  ds_read_b64_tr_b16 a[252:253], v59 offset:24576
  buffer_load_dwordx4 a[72:75], v2, s[36:39], s16 offen offset:1024 sc1
  v_mfma_f32_16x16x32_bf16 v[232:235], a[216:219], a[12:15], v[232:235]
  ds_read_b64_tr_b16 a[254:255], v59 offset:25088
  v_mfma_f32_16x16x32_bf16 v[236:239], a[220:223], a[12:15], v[236:239]
  buffer_load_dwordx4 a[76:79], v3, s[36:39], s16 offen offset:1024 sc1
  s_waitcnt vmcnt(14) lgkmcnt(8)
  v_mfma_f32_16x16x32_bf16 v[208:211], a[224:227], a[16:19], v[208:211]
  ds_read_b64_tr_b16 a[192:193], v56 offset:32768
  ds_read_b64_tr_b16 a[194:195], v56 offset:33280
  v_mfma_f32_16x16x32_bf16 v[212:215], a[228:231], a[16:19], v[212:215]
  ds_read_b64_tr_b16 a[196:197], v57 offset:32768
  v_mfma_f32_16x16x32_bf16 v[216:219], a[232:235], a[16:19], v[216:219]
  ds_read_b64_tr_b16 a[198:199], v57 offset:33280
  v_mfma_f32_16x16x32_bf16 v[220:223], a[236:239], a[16:19], v[220:223]
  v_mfma_f32_16x16x32_bf16 v[224:227], a[224:227], a[20:23], v[224:227]
  ds_read_b64_tr_b16 a[200:201], v58 offset:32768
  ds_read_b64_tr_b16 a[202:203], v58 offset:33280
  v_mfma_f32_16x16x32_bf16 v[228:231], a[228:231], a[20:23], v[228:231]
  ds_read_b64_tr_b16 a[204:205], v59 offset:32768
  v_mfma_f32_16x16x32_bf16 v[232:235], a[232:235], a[20:23], v[232:235]
  ds_read_b64_tr_b16 a[206:207], v59 offset:33280
  v_mfma_f32_16x16x32_bf16 v[236:239], a[236:239], a[20:23], v[236:239]
  s_waitcnt vmcnt(12) lgkmcnt(8)
  v_mfma_f32_16x16x32_bf16 v[208:211], a[240:243], a[24:27], v[208:211]
  ds_read_b64_tr_b16 a[208:209], v56 offset:40960
  ds_read_b64_tr_b16 a[210:211], v56 offset:41472
  v_mfma_f32_16x16x32_bf16 v[212:215], a[244:247], a[24:27], v[212:215]
  ds_read_b64_tr_b16 a[212:213], v57 offset:40960
  v_mfma_f32_16x16x32_bf16 v[216:219], a[248:251], a[24:27], v[216:219]
  ds_read_b64_tr_b16 a[214:215], v57 offset:41472
  v_mfma_f32_16x16x32_bf16 v[220:223], a[252:255], a[24:27], v[220:223]
  v_mfma_f32_16x16x32_bf16 v[224:227], a[240:243], a[28:31], v[224:227]
  ds_read_b64_tr_b16 a[216:217], v58 offset:40960
  ds_read_b64_tr_b16 a[218:219], v58 offset:41472
  v_mfma_f32_16x16x32_bf16 v[228:231], a[244:247], a[28:31], v[228:231]
  ds_read_b64_tr_b16 a[220:221], v59 offset:40960
  v_mfma_f32_16x16x32_bf16 v[232:235], a[248:251], a[28:31], v[232:235]
  ds_read_b64_tr_b16 a[222:223], v59 offset:41472
  v_mfma_f32_16x16x32_bf16 v[236:239], a[252:255], a[28:31], v[236:239]
  s_waitcnt vmcnt(21) lgkmcnt(0)
  s_barrier
  s_waitcnt vmcnt(10)
  v_mfma_f32_16x16x32_bf16 v[208:211], a[192:195], a[32:35], v[208:211]
  v_add_u32 v56, 0xfffe8000, v56
  v_add_u32 v57, 0xfffe8000, v57
  v_add_u32 v58, 0xfffe8000, v58
  v_add_u32 v59, 0xfffe8000, v59
  ds_read_b64_tr_b16 a[224:225], v56 offset:16384
  ds_read_b64_tr_b16 a[226:227], v56 offset:16896
  v_mfma_f32_16x16x32_bf16 v[212:215], a[196:199], a[32:35], v[212:215]
  ds_read_b64_tr_b16 a[228:229], v57 offset:16384
  v_mfma_f32_16x16x32_bf16 v[216:219], a[200:203], a[32:35], v[216:219]
  ds_read_b64_tr_b16 a[230:231], v57 offset:16896
  v_mfma_f32_16x16x32_bf16 v[220:223], a[204:207], a[32:35], v[220:223]
  v_mfma_f32_16x16x32_bf16 v[224:227], a[192:195], a[36:39], v[224:227]
  ds_read_b64_tr_b16 a[232:233], v58 offset:16384
  ds_read_b64_tr_b16 a[234:235], v58 offset:16896
  v_mfma_f32_16x16x32_bf16 v[228:231], a[196:199], a[36:39], v[228:231]
  ds_read_b64_tr_b16 a[236:237], v59 offset:16384
  v_mfma_f32_16x16x32_bf16 v[232:235], a[200:203], a[36:39], v[232:235]
  ds_read_b64_tr_b16 a[238:239], v59 offset:16896
  v_mfma_f32_16x16x32_bf16 v[236:239], a[204:207], a[36:39], v[236:239]
  s_waitcnt vmcnt(8) lgkmcnt(8)
  v_mfma_f32_16x16x32_bf16 v[208:211], a[208:211], a[40:43], v[208:211]
  ds_read_b64_tr_b16 a[240:241], v56 offset:24576
  ds_read_b64_tr_b16 a[242:243], v56 offset:25088
  v_mfma_f32_16x16x32_bf16 v[212:215], a[212:215], a[40:43], v[212:215]
  ds_read_b64_tr_b16 a[244:245], v57 offset:24576
  v_mfma_f32_16x16x32_bf16 v[216:219], a[216:219], a[40:43], v[216:219]
  ds_read_b64_tr_b16 a[246:247], v57 offset:25088
  v_mfma_f32_16x16x32_bf16 v[220:223], a[220:223], a[40:43], v[220:223]
  v_mfma_f32_16x16x32_bf16 v[224:227], a[208:211], a[44:47], v[224:227]
  ds_read_b64_tr_b16 a[248:249], v58 offset:24576
  ds_read_b64_tr_b16 a[250:251], v58 offset:25088
  v_mfma_f32_16x16x32_bf16 v[228:231], a[212:215], a[44:47], v[228:231]
  ds_read_b64_tr_b16 a[252:253], v59 offset:24576
  v_mfma_f32_16x16x32_bf16 v[232:235], a[216:219], a[44:47], v[232:235]
  ds_read_b64_tr_b16 a[254:255], v59 offset:25088
  v_mfma_f32_16x16x32_bf16 v[236:239], a[220:223], a[44:47], v[236:239]
  ds_read_b64_tr_b16 a[192:193], v56 offset:32768
  ds_read_b64_tr_b16 a[194:195], v56 offset:33280
  ds_read_b64_tr_b16 a[196:197], v57 offset:32768
  ds_read_b64_tr_b16 a[198:199], v57 offset:33280
  ds_read_b64_tr_b16 a[200:201], v58 offset:32768
  ds_read_b64_tr_b16 a[202:203], v58 offset:33280
  ds_read_b64_tr_b16 a[204:205], v59 offset:32768
  ds_read_b64_tr_b16 a[206:207], v59 offset:33280
  s_waitcnt lgkmcnt(8) vmcnt(0)
  v_mfma_f32_16x16x32_bf16 v[216:219], a[232:235], a[48:51], v[216:219]
  ds_read_b64_tr_b16 a[208:209], v56 offset:40960
  v_mfma_f32_16x16x32_bf16 v[220:223], a[236:239], a[48:51], v[220:223]
  ds_read_b64_tr_b16 a[210:211], v56 offset:41472
  v_mfma_f32_16x16x32_bf16 v[208:211], a[224:227], a[48:51], v[208:211]
  ds_read_b64_tr_b16 a[212:213], v57 offset:40960
  v_mfma_f32_16x16x32_bf16 v[212:215], a[228:231], a[48:51], v[212:215]
  ds_read_b64_tr_b16 a[214:215], v57 offset:41472
  v_mfma_f32_16x16x32_bf16 v[216:219], a[248:251], a[56:59], v[216:219]
  ds_read_b64_tr_b16 a[216:217], v58 offset:40960
  v_mfma_f32_16x16x32_bf16 v[220:223], a[252:255], a[56:59], v[220:223]
  ds_read_b64_tr_b16 a[218:219], v58 offset:41472
  v_mfma_f32_16x16x32_bf16 v[208:211], a[240:243], a[56:59], v[208:211]
  ds_read_b64_tr_b16 a[220:221], v59 offset:40960
  ds_read_b64_tr_b16 a[222:223], v59 offset:41472
  v_mfma_f32_16x16x32_bf16 v[212:215], a[244:247], a[56:59], v[212:215]
  s_waitcnt lgkmcnt(8)
  v_mfma_f32_16x16x32_bf16 v[216:219], a[200:203], a[64:67], v[216:219]
  v_mfma_f32_16x16x32_bf16 v[220:223], a[204:207], a[64:67], v[220:223]
  v_mfma_f32_16x16x32_bf16 v[208:211], a[192:195], a[64:67], v[208:211]
  v_mfma_f32_16x16x32_bf16 v[212:215], a[196:199], a[64:67], v[212:215]
  s_waitcnt lgkmcnt(0)
  v_mfma_f32_16x16x32_bf16 v[216:219], a[216:219], a[72:75], v[216:219]
  v_mfma_f32_16x16x32_bf16 v[220:223], a[220:223], a[72:75], v[220:223]
  v_mfma_f32_16x16x32_bf16 v[208:211], a[208:211], a[72:75], v[208:211]
  v_mfma_f32_16x16x32_bf16 v[212:215], a[212:215], a[72:75], v[212:215]
  v_mfma_f32_16x16x32_bf16 v[232:235], a[232:235], a[52:55], v[232:235]
  s_nop 1
  v_mfma_f32_16x16x32_bf16 v[236:239], a[236:239], a[52:55], v[236:239]
  s_nop 1
  v_mfma_f32_16x16x32_bf16 v[224:227], a[224:227], a[52:55], v[224:227]
  ds_write_b128 v28, v[216:219] offset:0
  v_mfma_f32_16x16x32_bf16 v[228:231], a[228:231], a[52:55], v[228:231]
  ds_write_b128 v28, v[220:223] offset:1024
  v_mfma_f32_16x16x32_bf16 v[232:235], a[248:251], a[60:63], v[232:235]
  v_fmac_f32 v88, v160, v208
  v_mfma_f32_16x16x32_bf16 v[236:239], a[252:255], a[60:63], v[236:239]
  v_fmac_f32 v89, v161, v209
  v_mfma_f32_16x16x32_bf16 v[224:227], a[240:243], a[60:63], v[224:227]
  v_fmac_f32 v90, v162, v210
  v_mfma_f32_16x16x32_bf16 v[228:231], a[244:247], a[60:63], v[228:231]
  v_fmac_f32 v91, v163, v211
  v_mfma_f32_16x16x32_bf16 v[232:235], a[200:203], a[68:71], v[232:235]
  v_fmac_f32 v92, v164, v212
  v_mfma_f32_16x16x32_bf16 v[236:239], a[204:207], a[68:71], v[236:239]
  v_fmac_f32 v93, v165, v213
  v_mfma_f32_16x16x32_bf16 v[224:227], a[192:195], a[68:71], v[224:227]
  v_fmac_f32 v94, v166, v214
  v_mfma_f32_16x16x32_bf16 v[228:231], a[196:199], a[68:71], v[228:231]
  v_fmac_f32 v95, v167, v215
  v_mfma_f32_16x16x32_bf16 v[232:235], a[216:219], a[76:79], v[232:235]
  s_waitcnt lgkmcnt(0)
  v_mfma_f32_16x16x32_bf16 v[236:239], a[220:223], a[76:79], v[236:239]
  s_barrier
  v_mfma_f32_16x16x32_bf16 v[224:227], a[208:211], a[76:79], v[224:227]
  ds_read_b128 v[64:67], v29 offset:0
  v_mfma_f32_16x16x32_bf16 v[228:231], a[212:215], a[76:79], v[228:231]
  ds_read_b128 v[68:71], v29 offset:1024
  s_waitcnt lgkmcnt(0)
  v_fmac_f32 v88, v160, v64
  v_fmac_f32 v89, v161, v65
  v_fmac_f32 v90, v162, v66
  v_fmac_f32 v91, v163, v67
  v_fmac_f32 v92, v164, v68
  v_fmac_f32 v93, v165, v69
  ds_write_b128 v28, v[232:235] offset:2048
  ds_write_b128 v28, v[236:239] offset:3072
  v_fmac_f32 v94, v166, v70
  v_fmac_f32 v95, v167, v71
  v_cvt_pk_bf16_f32 v12, v88, v89
  v_cvt_pk_bf16_f32 v13, v90, v91
  v_cvt_pk_bf16_f32 v14, v92, v93
  v_cvt_pk_bf16_f32 v15, v94, v95
  s_nop 0
  v_permlane16_swap_b32 v12, v14
  v_permlane16_swap_b32 v13, v15
  buffer_store_dwordx4 v[12:15], v5, s[48:51], 0 offen sc0 sc1
  v_pk_fma_f32 v[96:97], v[176:177], v[224:225], v[96:97]
  v_pk_fma_f32 v[98:99], v[178:179], v[226:227], v[98:99]
  v_pk_fma_f32 v[100:101], v[180:181], v[228:229], v[100:101]
  v_pk_fma_f32 v[102:103], v[182:183], v[230:231], v[102:103]
  s_waitcnt lgkmcnt(0)
  s_barrier
  ds_read_b128 v[72:75], v29 offset:2048
  ds_read_b128 v[76:79], v29 offset:3072
  s_waitcnt lgkmcnt(0)
  v_pk_fma_f32 v[96:97], v[176:177], v[72:73], v[96:97]
  v_pk_fma_f32 v[98:99], v[178:179], v[74:75], v[98:99]
  v_pk_fma_f32 v[100:101], v[180:181], v[76:77], v[100:101]
  v_pk_fma_f32 v[102:103], v[182:183], v[78:79], v[102:103]
  v_cvt_pk_bf16_f32 v16, v96, v97
  v_cvt_pk_bf16_f32 v17, v98, v99
  v_cvt_pk_bf16_f32 v18, v100, v101
  v_cvt_pk_bf16_f32 v19, v102, v103
  s_nop 0
  v_permlane16_swap_b32 v16, v18
  v_permlane16_swap_b32 v17, v19
  buffer_store_dwordx4 v[16:19], v6, s[48:51], 0 offen sc0 sc1
LQend:
  s_endpgm
Lslow_1:
  s_mov_b32 s92, 0
Lslow_1b:
  s_sleep 2
  buffer_load_dword v60, off, s[0:3], s54 sc1
  s_add_u32 s92, s92, 1
  s_waitcnt vmcnt(0)
  v_cmp_gt_u32 vcc, s53, v60
  s_nop 0
  s_cmp_eq_u64 vcc, 0
  s_cbranch_scc1 Lback_2
  s_cmp_lt_u32 s92, 0x8000
  s_cbranch_scc1 Lslow_1b
  s_branch Lback_2
Lslow_3:
  s_mov_b32 s92, 0
Lslow_3b:
  s_sleep 2
  buffer_load_dwordx2 v[60:61], v62, s[36:39], s54 offen sc1
  s_add_u32 s92, s92, 1
  s_waitcnt vmcnt(0)
  v_and_b32 v60, v60, v61
  v_cmp_gt_u32 vcc, s53, v60
  s_nop 0
  s_cmp_eq_u64 vcc, 0
  s_cbranch_scc1 Lback_4
  s_cmp_lt_u32 s92, 0x8000
  s_cbranch_scc1 Lslow_3b
  s_branch Lback_4
Lretry_6:
  s_lshr_b32 s70, s68, 1
  s_lshl_b32 s70, s70, 11
  s_lshl_b32 s73, s59, 13
  s_add_u32 s72, s70, s73
  buffer_load_dwordx4 v[128:131], v123, s[36:39], s72 offen offset:0 sc1
  buffer_load_dwordx4 v[132:135], v123, s[36:39], s72 offen offset:1024 sc1
  s_add_u32 s70, s70, 2048
  s_and_b32 s70, s70, 0x1fff
  s_add_u32 s72, s70, s73
  buffer_load_dwordx4 v[136:139], v123, s[36:39], s72 offen offset:0 sc1
  buffer_load_dwordx4 v[148:151], v123, s[36:39], s72 offen offset:1024 sc1
  s_add_u32 s70, s70, 2048
  s_and_b32 s70, s70, 0x1fff
  s_add_u32 s72, s70, s73
  buffer_load_dwordx4 v[152:155], v123, s[36:39], s72 offen offset:0 sc1
  buffer_load_dwordx4 v[156:159], v123, s[36:39], s72 offen offset:1024 sc1
  s_add_u32 s70, s70, 2048
  s_and_b32 s70, s70, 0x1fff
  s_add_u32 s72, s70, s73
  buffer_load_dwordx4 v[160:163], v123, s[36:39], s72 offen offset:0 sc1
  buffer_load_dwordx4 v[164:167], v123, s[36:39], s72 offen offset:1024 sc1
  s_add_u32 s70, s70, 2048
  s_and_b32 s70, s70, 0x1fff
  s_xor_b32 s73, s73, 0x2000
  s_add_u32 s72, s70, s73
  buffer_load_dwordx4 v[168:171], v123, s[36:39], s72 offen offset:0 sc1
  buffer_load_dwordx4 v[180:183], v123, s[36:39], s72 offen offset:1024 sc1
  s_add_u32 s70, s70, 2048
  s_and_b32 s70, s70, 0x1fff
  s_add_u32 s72, s70, s73
  buffer_load_dwordx4 v[184:187], v123, s[36:39], s72 offen offset:0 sc1
  buffer_load_dwordx4 v[188:191], v123, s[36:39], s72 offen offset:1024 sc1
  s_add_u32 s70, s70, 2048
  s_and_b32 s70, s70, 0x1fff
  s_add_u32 s72, s70, s73
  buffer_load_dwordx4 v[212:215], v123, s[36:39], s72 offen offset:0 sc1
  buffer_load_dwordx4 v[216:219], v123, s[36:39], s72 offen offset:1024 sc1
  s_add_u32 s70, s70, 2048
  s_and_b32 s70, s70, 0x1fff
  s_add_u32 s72, s70, s73
  buffer_load_dwordx4 v[220:223], v123, s[36:39], s72 offen offset:0 sc1
  buffer_load_dwordx4 v[224:227], v123, s[36:39], s72 offen offset:1024 sc1
  v_mov_b32 v192, 0
  v_mov_b32 v193, 0
  v_mov_b32 v194, 0
  v_mov_b32 v195, 0
  v_mov_b32 v196, 0
  v_mov_b32 v197, 0
  v_mov_b32 v198, 0
  v_mov_b32 v199, 0
  v_mov_b32 v200, 0
  s_add_u32 s92, s92, 1
  s_waitcnt vmcnt(0)
  v_max3_u32 v200, v200, v128, v130
  v_dot2c_f32_bf16 v192, s71, v128
  v_dot2c_f32_bf16 v193, s90, v128
  v_dot2c_f32_bf16 v194, s71, v129
  v_dot2c_f32_bf16 v195, s90, v129
  v_dot2c_f32_bf16 v196, s71, v130
  v_dot2c_f32_bf16 v197, s90, v130
  v_dot2c_f32_bf16 v198, s71, v131
  v_dot2c_f32_bf16 v199, s90, v131
  v_max3_u32 v200, v200, v132, v134
  v_dot2c_f32_bf16 v192, s71, v132
  v_dot2c_f32_bf16 v193, s90, v132
  v_dot2c_f32_bf16 v194, s71, v133
  v_dot2c_f32_bf16 v195, s90, v133
  v_dot2c_f32_bf16 v196, s71, v134
  v_dot2c_f32_bf16 v197, s90, v134
  v_dot2c_f32_bf16 v198, s71, v135
  v_dot2c_f32_bf16 v199, s90, v135
  v_max3_u32 v200, v200, v136, v138
  v_dot2c_f32_bf16 v192, s71, v136
  v_dot2c_f32_bf16 v193, s90, v136
  v_dot2c_f32_bf16 v194, s71, v137
  v_dot2c_f32_bf16 v195, s90, v137
  v_dot2c_f32_bf16 v196, s71, v138
  v_dot2c_f32_bf16 v197, s90, v138
  v_dot2c_f32_bf16 v198, s71, v139
  v_dot2c_f32_bf16 v199, s90, v139
  v_max3_u32 v200, v200, v148, v150
  v_dot2c_f32_bf16 v192, s71, v148
  v_dot2c_f32_bf16 v193, s90, v148
  v_dot2c_f32_bf16 v194, s71, v149
  v_dot2c_f32_bf16 v195, s90, v149
  v_dot2c_f32_bf16 v196, s71, v150
  v_dot2c_f32_bf16 v197, s90, v150
  v_dot2c_f32_bf16 v198, s71, v151
  v_dot2c_f32_bf16 v199, s90, v151
  v_max3_u32 v200, v200, v152, v154
  v_dot2c_f32_bf16 v192, s71, v152
  v_dot2c_f32_bf16 v193, s90, v152
  v_dot2c_f32_bf16 v194, s71, v153
  v_dot2c_f32_bf16 v195, s90, v153
  v_dot2c_f32_bf16 v196, s71, v154
  v_dot2c_f32_bf16 v197, s90, v154
  v_dot2c_f32_bf16 v198, s71, v155
  v_dot2c_f32_bf16 v199, s90, v155
  v_max3_u32 v200, v200, v156, v158
  v_dot2c_f32_bf16 v192, s71, v156
  v_dot2c_f32_bf16 v193, s90, v156
  v_dot2c_f32_bf16 v194, s71, v157
  v_dot2c_f32_bf16 v195, s90, v157
  v_dot2c_f32_bf16 v196, s71, v158
  v_dot2c_f32_bf16 v197, s90, v158
  v_dot2c_f32_bf16 v198, s71, v159
  v_dot2c_f32_bf16 v199, s90, v159
  v_max3_u32 v200, v200, v160, v162
  v_dot2c_f32_bf16 v192, s71, v160
  v_dot2c_f32_bf16 v193, s90, v160
  v_dot2c_f32_bf16 v194, s71, v161
  v_dot2c_f32_bf16 v195, s90, v161
  v_dot2c_f32_bf16 v196, s71, v162
  v_dot2c_f32_bf16 v197, s90, v162
  v_dot2c_f32_bf16 v198, s71, v163
  v_dot2c_f32_bf16 v199, s90, v163
  v_max3_u32 v200, v200, v164, v166
  v_dot2c_f32_bf16 v192, s71, v164
  v_dot2c_f32_bf16 v193, s90, v164
  v_dot2c_f32_bf16 v194, s71, v165
  v_dot2c_f32_bf16 v195, s90, v165
  v_dot2c_f32_bf16 v196, s71, v166
  v_dot2c_f32_bf16 v197, s90, v166
  v_dot2c_f32_bf16 v198, s71, v167
  v_dot2c_f32_bf16 v199, s90, v167
  v_max3_u32 v200, v200, v168, v170
  v_dot2c_f32_bf16 v192, s71, v168
  v_dot2c_f32_bf16 v193, s90, v168
  v_dot2c_f32_bf16 v194, s71, v169
  v_dot2c_f32_bf16 v195, s90, v169
  v_dot2c_f32_bf16 v196, s71, v170
  v_dot2c_f32_bf16 v197, s90, v170
  v_dot2c_f32_bf16 v198, s71, v171
  v_dot2c_f32_bf16 v199, s90, v171
  v_max3_u32 v200, v200, v180, v182
  v_dot2c_f32_bf16 v192, s71, v180
  v_dot2c_f32_bf16 v193, s90, v180
  v_dot2c_f32_bf16 v194, s71, v181
  v_dot2c_f32_bf16 v195, s90, v181
  v_dot2c_f32_bf16 v196, s71, v182
  v_dot2c_f32_bf16 v197, s90, v182
  v_dot2c_f32_bf16 v198, s71, v183
  v_dot2c_f32_bf16 v199, s90, v183
  v_max3_u32 v200, v200, v184, v186
  v_dot2c_f32_bf16 v192, s71, v184
  v_dot2c_f32_bf16 v193, s90, v184
  v_dot2c_f32_bf16 v194, s71, v185
  v_dot2c_f32_bf16 v195, s90, v185
  v_dot2c_f32_bf16 v196, s71, v186
  v_dot2c_f32_bf16 v197, s90, v186
  v_dot2c_f32_bf16 v198, s71, v187
  v_dot2c_f32_bf16 v199, s90, v187
  v_max3_u32 v200, v200, v188, v190
  v_dot2c_f32_bf16 v192, s71, v188
  v_dot2c_f32_bf16 v193, s90, v188
  v_dot2c_f32_bf16 v194, s71, v189
  v_dot2c_f32_bf16 v195, s90, v189
  v_dot2c_f32_bf16 v196, s71, v190
  v_dot2c_f32_bf16 v197, s90, v190
  v_dot2c_f32_bf16 v198, s71, v191
  v_dot2c_f32_bf16 v199, s90, v191
  v_max3_u32 v200, v200, v212, v214
  v_dot2c_f32_bf16 v192, s71, v212
  v_dot2c_f32_bf16 v193, s90, v212
  v_dot2c_f32_bf16 v194, s71, v213
  v_dot2c_f32_bf16 v195, s90, v213
  v_dot2c_f32_bf16 v196, s71, v214
  v_dot2c_f32_bf16 v197, s90, v214
  v_dot2c_f32_bf16 v198, s71, v215
  v_dot2c_f32_bf16 v199, s90, v215
  v_max3_u32 v200, v200, v216, v218
  v_dot2c_f32_bf16 v192, s71, v216
  v_dot2c_f32_bf16 v193, s90, v216
  v_dot2c_f32_bf16 v194, s71, v217
  v_dot2c_f32_bf16 v195, s90, v217
  v_dot2c_f32_bf16 v196, s71, v218
  v_dot2c_f32_bf16 v197, s90, v218
  v_dot2c_f32_bf16 v198, s71, v219
  v_dot2c_f32_bf16 v199, s90, v219
  v_max3_u32 v200, v200, v220, v222
  v_dot2c_f32_bf16 v192, s71, v220
  v_dot2c_f32_bf16 v193, s90, v220
  v_dot2c_f32_bf16 v194, s71, v221
  v_dot2c_f32_bf16 v195, s90, v221
  v_dot2c_f32_bf16 v196, s71, v222
  v_dot2c_f32_bf16 v197, s90, v222
  v_dot2c_f32_bf16 v198, s71, v223
  v_dot2c_f32_bf16 v199, s90, v223
  v_max3_u32 v200, v200, v224, v226
  v_dot2c_f32_bf16 v192, s71, v224
  v_dot2c_f32_bf16 v193, s90, v224
  v_dot2c_f32_bf16 v194, s71, v225
  v_dot2c_f32_bf16 v195, s90, v225
  v_dot2c_f32_bf16 v196, s71, v226
  v_dot2c_f32_bf16 v197, s90, v226
  v_dot2c_f32_bf16 v198, s71, v227
  v_dot2c_f32_bf16 v199, s90, v227
  v_cmp_eq_u32 vcc, -1, v200
  s_nop 0
  s_cmp_eq_u64 vcc, 0
  s_cbranch_scc1 Lagain_5
  s_cmp_lt_u32 s92, 0x4000
  s_cbranch_scc1 Lretry_6
  s_branch Lagain_5
Lslow_7:
  s_mov_b32 s92, 0
Lslow_7b:
  s_sleep 2
  buffer_load_dword v60, v124, s[36:39], s54 offen sc1
  s_add_u32 s92, s92, 1
  s_waitcnt vmcnt(0)
  v_cmp_gt_u32 vcc, s53, v60
  s_nop 0
  s_cmp_eq_u64 vcc, 0
  s_cbranch_scc1 Lback_8
  s_cmp_lt_u32 s92, 0x8000
  s_cbranch_scc1 Lslow_7b
  s_branch Lback_8
Lslow_9:
  s_mov_b32 s92, 0
Lslow_9b:
  s_sleep 2
  buffer_load_dword v61, v124, s[36:39], s54 offen offset:2048 sc1
  s_add_u32 s92, s92, 1
  s_waitcnt vmcnt(0)
  v_cmp_gt_u32 vcc, s53, v61
  s_nop 0
  s_cmp_eq_u64 vcc, 0
  s_cbranch_scc1 Lback_10
  s_cmp_lt_u32 s92, 0x8000
  s_cbranch_scc1 Lslow_9b
  s_branch Lback_10
LHmain:
  s_waitcnt vmcnt(10)
  s_barrier
  s_nop 0
  ds_read_b64_tr_b16 v[96:97], v14 offset:0
  ds_read_b64_tr_b16 v[98:99], v14 offset:1536
  ds_read_b128 v[64:67], v2 offset:0
  ds_read_b64_tr_b16 v[100:101], v15 offset:64
  ds_read_b64_tr_b16 v[102:103], v15 offset:1600
  ds_read_b128 v[68:71], v2 offset:4096
  ds_read_b64_tr_b16 v[104:105], v14 offset:128
  ds_read_b64_tr_b16 v[106:107], v14 offset:1664
  buffer_store_dword v125, v61, s[0:3], 0 offen sc1
  s_waitcnt lgkmcnt(0)
  v_mfma_f32_32x32x16_bf16 v[160:175], v[96:99], v[64:67], 0
  ds_read_b64_tr_b16 v[108:109], v14 offset:6144
  ds_read_b64_tr_b16 v[110:111], v14 offset:7680
  s_xor_b32 s98, 2, s99
  s_mul_i32 s65, s98, 196608
  s_add_u32 m0, s91, 81920
  s_add_u32 s65, s65, s94
  buffer_load_dwordx4 v24, s[32:35], s65 offen  lds
  v_mfma_f32_32x32x16_bf16 v[176:191], v[100:103], v[64:67], 0
  ds_read_b128 v[72:75], v3 offset:0
  ds_read_b64_tr_b16 v[112:113], v15 offset:6208
  s_lshl_b32 s69, s57, 7
  s_lshl_b32 s70, s58, 4
  s_add_u32 s69, s69, s70
  v_smfmac_f32_16x16x64_bf16 a[220:223], a[236:239], v[96:103], v95
  v_mfma_f32_32x32x16_bf16 v[192:207], v[104:107], v[64:67], 0
  ds_read_b64_tr_b16 v[114:115], v15 offset:7744
  ds_read_b128 v[76:79], v3 offset:4096
  s_lshl_b32 s64, s98, 7
  s_add_u32 m0, s81, 81920
  s_add_u32 s64, s64, s93
  buffer_load_dwordx4 v20, s[28:31], s64 offen  lds
  v_mfma_f32_32x32x16_bf16 v[208:223], v[96:99], v[68:71], 0
  ds_read_b64_tr_b16 v[116:117], v14 offset:6272
  ds_read_b64_tr_b16 v[118:119], v14 offset:7808
  s_add_u32 m0, s101, 81920
  s_lshl_b32 s70, s56, 2
  s_add_u32 s69, s69, s70
  v_mfma_f32_16x16x32_bf16 a[228:231], v[104:107], a[232:235], 0
  v_mfma_f32_32x32x16_bf16 v[224:239], v[100:103], v[68:71], 0
  buffer_load_dwordx4 v25, s[32:35], s65 offen  lds
  v_lshrrev_b32 v80, 4, v1
  v_add_u32 v124, s69, v80
  v_and_b32 v81, 15, v1
  v_mul_u32_u24 v80, 1280, v124
  v_mfma_f32_32x32x16_bf16 v[240:255], v[104:107], v[68:71], 0
  v_lshl_add_u32 v93, v81, 4, v80
  s_and_b32 s95, s26, 7
  s_lshl_b32 s95, s95, 7
  s_lshl_b32 s70, s61, 2
  s_add_u32 s95, s95, s70
  s_waitcnt lgkmcnt(0)
  v_mfma_f32_32x32x16_bf16 v[160:175], v[108:111], v[72:75], v[160:175]
  ds_read_b64_tr_b16 v[96:97], v14 offset:12288
  ds_read_b64_tr_b16 v[98:99], v14 offset:13824
  s_add_u32 m0, s83, 81920
  s_nop 0
  buffer_load_dwordx4 v21, s[28:31], s64 offen  lds
  s_add_u32 s95, s95, 10687488
  v_mfma_f32_32x32x16_bf16 v[176:191], v[112:115], v[72:75], v[176:191]
  ds_read_b128 v[64:67], v4 offset:0
  ds_read_b64_tr_b16 v[100:101], v15 offset:12352
  v_mov_b32 v47, 0x40000000
  v_and_b32 v30, 15, v1
  v_smfmac_f32_16x16x64_bf16 a[220:223], a[236:239], v[108:115], v95
  v_mfma_f32_32x32x16_bf16 v[192:207], v[116:119], v[72:75], v[192:207]
  ds_read_b64_tr_b16 v[102:103], v15 offset:13888
  ds_read_b128 v[68:71], v4 offset:4096
  v_mfma_f32_32x32x16_bf16 v[208:223], v[108:111], v[76:79], v[208:223]
  ds_read_b64_tr_b16 v[104:105], v14 offset:12416
  ds_read_b64_tr_b16 v[106:107], v14 offset:13952
  v_mfma_f32_16x16x32_bf16 a[228:231], v[116:119], a[232:235], a[228:231]
  v_mfma_f32_32x32x16_bf16 v[224:239], v[112:115], v[76:79], v[224:239]
  v_cmp_eq_u32 vcc, 0, v30
  v_lshlrev_b32 v124, 3, v124
  v_add_u32 v124, 10616832, v124
  v_cndmask_b32 v124, v47, v124, vcc
  v_mov_b32 v84, 0x3f803f80
  v_mfma_f32_32x32x16_bf16 v[240:255], v[116:119], v[76:79], v[240:255]
  s_and_b32 s70, s26, 127
  s_lshl_b32 s70, s70, 12
  s_add_u32 s70, s70, 9437184
  v_lshl_add_u32 v87, v0, 4, s70
  v_mov_b32 v148, -1
  s_waitcnt lgkmcnt(0)
  v_mfma_f32_32x32x16_bf16 v[160:175], v[96:99], v[64:67], v[160:175]
  ds_read_b64_tr_b16 v[108:109], v14 offset:18432
  ds_read_b64_tr_b16 v[110:111], v14 offset:19968
  v_mov_b32 v149, -1
  v_mov_b32 v150, -1
  v_mov_b32 v151, -1
  v_mfma_f32_32x32x16_bf16 v[176:191], v[100:103], v[64:67], v[176:191]
  ds_read_b128 v[72:75], v5 offset:0
  ds_read_b64_tr_b16 v[112:113], v15 offset:18496
  v_mov_b32 v89, 0x40000000
  v_mov_b32 v30, s95
  v_smfmac_f32_16x16x64_bf16 a[220:223], a[236:239], v[96:103], v95
  v_mfma_f32_32x32x16_bf16 v[192:207], v[104:107], v[64:67], v[192:207]
  ds_read_b64_tr_b16 v[114:115], v15 offset:20032
  ds_read_b128 v[76:79], v5 offset:4096
  v_cmp_eq_u32 vcc, 0, v0
  s_nop 1
  v_cndmask_b32 v89, v89, v30, vcc
  v_mfma_f32_32x32x16_bf16 v[208:223], v[96:99], v[68:71], v[208:223]
  ds_read_b64_tr_b16 v[116:117], v14 offset:18560
  ds_read_b64_tr_b16 v[118:119], v14 offset:20096
  s_and_b32 s70, s26, 255
  s_lshl_b32 s70, s70, 2
  s_add_u32 s70, s70, s56
  v_mfma_f32_16x16x32_bf16 a[228:231], v[104:107], a[232:235], a[228:231]
  v_mfma_f32_32x32x16_bf16 v[224:239], v[100:103], v[68:71], v[224:239]
  s_mul_i32 s71, s70, 1920
  v_min_u32 v30, 14, v1
  v_lshl_add_u32 v85, v30, 7, s71
  s_mul_i32 s71, s70, 800
  v_min_u32 v30, 6, v1
  v_mfma_f32_32x32x16_bf16 v[240:255], v[104:107], v[68:71], v[240:255]
  v_lshl_add_u32 v86, v30, 7, s71
  s_lshr_b32 s63, s61, 1
  s_and_b32 s71, s61, 1
  s_mul_i32 s62, s71, 6
  s_mul_i32 s79, s71, 4
  s_waitcnt lgkmcnt(0)
  v_mfma_f32_32x32x16_bf16 v[160:175], v[108:111], v[72:75], v[160:175]
  s_waitcnt vmcnt(5)
  s_barrier
  ds_read_b64_tr_b16 v[96:97], v16 offset:0
  ds_read_b64_tr_b16 v[98:99], v16 offset:1536
  ds_read_b128 v[64:67], v6 offset:0
  v_mfma_f32_32x32x16_bf16 v[176:191], v[112:115], v[72:75], v[176:191]
  ds_read_b64_tr_b16 v[100:101], v17 offset:64
  ds_read_b64_tr_b16 v[102:103], v17 offset:1600
  ds_read_b128 v[68:71], v6 offset:4096
  s_add_u32 m0, s22, 81920
  s_nop 0
  buffer_load_dwordx4 v26, s[32:35], s65 offen  lds
  s_add_u32 m0, s23, 81920
  v_smfmac_f32_16x16x64_bf16 a[220:223], a[236:239], v[108:115], v95
  v_mfma_f32_32x32x16_bf16 v[192:207], v[116:119], v[72:75], v[192:207]
  buffer_load_dwordx4 v27, s[32:35], s65 offen  lds
  ds_read_b64_tr_b16 v[104:105], v16 offset:128
  ds_read_b64_tr_b16 v[106:107], v16 offset:1664
  s_lshl_b32 s70, s59, 2
  s_add_u32 s70, s70, s60
  v_mfma_f32_32x32x16_bf16 v[208:223], v[108:111], v[76:79], v[208:223]
  s_add_u32 m0, s87, 81920
  s_lshl_b32 s70, s70, 4
  s_add_u32 s62, s62, s70
  s_add_u32 s79, s79, s63
  s_and_b32 s70, s26, 7
  v_mfma_f32_16x16x32_bf16 a[228:231], v[116:119], a[232:235], a[228:231]
  v_mfma_f32_32x32x16_bf16 v[224:239], v[112:115], v[76:79], v[224:239]
  buffer_load_dwordx4 v22, s[28:31], s64 offen  lds
  s_add_u32 s79, s79, s70
  s_cmp_ge_u32 s79, 8
  s_cselect_b32 s72, 8, 0
  s_sub_u32 s70, s79, s72
  v_mfma_f32_32x32x16_bf16 v[240:255], v[116:119], v[76:79], v[240:255]
  s_cmp_ge_u32 s70, 8
  s_cselect_b32 s72, 8, 0
  s_sub_u32 s70, s70, s72
  s_cmp_ge_u32 s70, 8
  s_cselect_b32 s72, 8, 0
  s_waitcnt lgkmcnt(0)
  v_mfma_f32_32x32x16_bf16 v[160:175], v[96:99], v[64:67], v[160:175]
  ds_read_b64_tr_b16 v[108:109], v16 offset:6144
  ds_read_b64_tr_b16 v[110:111], v16 offset:7680
  s_add_u32 m0, s24, 81920
  s_nop 0
  buffer_load_dwordx4 v28, s[32:35], s65 offen  lds
  s_sub_u32 s70, s70, s72
  v_mfma_f32_32x32x16_bf16 v[176:191], v[100:103], v[64:67], v[176:191]
  ds_read_b128 v[72:75], v7 offset:0
  ds_read_b64_tr_b16 v[112:113], v17 offset:6208
  s_add_u32 m0, s89, 81920
  s_cmp_ge_u32 s70, 8
  s_cselect_b32 s72, 8, 0
  v_smfmac_f32_16x16x64_bf16 a[220:223], a[236:239], v[96:103], v95
  v_mfma_f32_32x32x16_bf16 v[192:207], v[104:107], v[64:67], v[192:207]
  buffer_load_dwordx4 v23, s[28:31], s64 offen  lds
  ds_read_b64_tr_b16 v[114:115], v17 offset:7744
  ds_read_b128 v[76:79], v7 offset:4096
  s_sub_u32 s70, s70, s72
  s_add_u32 s71, s70, 0
  v_mfma_f32_32x32x16_bf16 v[208:223], v[96:99], v[68:71], v[208:223]
  ds_read_b64_tr_b16 v[116:117], v16 offset:6272
  ds_read_b64_tr_b16 v[118:119], v16 offset:7808
  s_add_u32 m0, s25, 81920
  s_cmp_ge_u32 s71, 8
  s_cselect_b32 s72, 8, 0
  v_mfma_f32_16x16x32_bf16 a[228:231], v[104:107], a[232:235], a[228:231]
  v_mfma_f32_32x32x16_bf16 v[224:239], v[100:103], v[68:71], v[224:239]
  buffer_load_dwordx4 v29, s[32:35], s65 offen  lds
  s_sub_u32 s71, s71, s72
  s_mul_i32 s4, s71, 3072
  s_add_u32 s71, s70, 1
  v_mfma_f32_32x32x16_bf16 v[240:255], v[104:107], v[68:71], v[240:255]
  s_cmp_ge_u32 s71, 8
  s_cselect_b32 s72, 8, 0
  s_sub_u32 s71, s71, s72
  s_mul_i32 s5, s71, 3072
  s_add_u32 s71, s70, 2
  s_waitcnt lgkmcnt(0)
  v_mfma_f32_32x32x16_bf16 v[160:175], v[108:111], v[72:75], v[160:175]
  ds_read_b64_tr_b16 v[96:97], v16 offset:12288
  ds_read_b64_tr_b16 v[98:99], v16 offset:13824
  s_xor_b32 s98, 3, s99
  s_mul_i32 s65, s98, 196608
  s_add_u32 m0, s91, 0
  s_add_u32 s65, s65, s94
  buffer_load_dwordx4 v24, s[32:35], s65 offen  lds
  v_mfma_f32_32x32x16_bf16 v[176:191], v[112:115], v[72:75], v[176:191]
  ds_read_b128 v[64:67], v8 offset:0
  ds_read_b64_tr_b16 v[100:101], v17 offset:12352
  s_cmp_ge_u32 s71, 8
  s_cselect_b32 s72, 8, 0
  s_sub_u32 s71, s71, s72
  v_smfmac_f32_16x16x64_bf16 a[220:223], a[236:239], v[108:115], v95
  v_mfma_f32_32x32x16_bf16 v[192:207], v[116:119], v[72:75], v[192:207]
  ds_read_b64_tr_b16 v[102:103], v17 offset:13888
  ds_read_b128 v[68:71], v8 offset:4096
  s_lshl_b32 s64, s98, 7
  s_add_u32 m0, s81, 0
  s_add_u32 s64, s64, s93
  buffer_load_dwordx4 v20, s[28:31], s64 offen  lds
  v_mfma_f32_32x32x16_bf16 v[208:223], v[108:111], v[76:79], v[208:223]
  ds_read_b64_tr_b16 v[104:105], v16 offset:12416
  ds_read_b64_tr_b16 v[106:107], v16 offset:13952
  s_add_u32 m0, s101, 0
  s_mul_i32 s6, s71, 3072
  s_add_u32 s71, s70, 3
  v_mfma_f32_16x16x32_bf16 a[228:231], v[116:119], a[232:235], a[228:231]
  v_mfma_f32_32x32x16_bf16 v[224:239], v[112:115], v[76:79], v[224:239]
  buffer_load_dwordx4 v25, s[32:35], s65 offen  lds
  s_cmp_ge_u32 s71, 8
  s_cselect_b32 s72, 8, 0
  s_sub_u32 s71, s71, s72
  s_mul_i32 s7, s71, 3072
  v_mfma_f32_32x32x16_bf16 v[240:255], v[116:119], v[76:79], v[240:255]
  s_add_u32 s71, s70, 4
  s_cmp_ge_u32 s71, 8
  s_cselect_b32 s72, 8, 0
  s_sub_u32 s71, s71, s72
  s_mul_i32 s8, s71, 3072
  s_waitcnt lgkmcnt(0)
  v_mfma_f32_32x32x16_bf16 v[160:175], v[96:99], v[64:67], v[160:175]
  ds_read_b64_tr_b16 v[108:109], v16 offset:18432
  ds_read_b64_tr_b16 v[110:111], v16 offset:19968
  s_add_u32 m0, s83, 0
  s_nop 0
  buffer_load_dwordx4 v21, s[28:31], s64 offen  lds
  s_add_u32 s71, s70, 5
  v_mfma_f32_32x32x16_bf16 v[176:191], v[100:103], v[64:67], v[176:191]
  ds_read_b128 v[72:75], v9 offset:0
  ds_read_b64_tr_b16 v[112:113], v17 offset:18496
  s_add_u32 m0, s22, 0
  s_cmp_ge_u32 s71, 8
  s_cselect_b32 s72, 8, 0
  v_smfmac_f32_16x16x64_bf16 a[220:223], a[236:239], v[96:103], v95
  v_mfma_f32_32x32x16_bf16 v[192:207], v[104:107], v[64:67], v[192:207]
  buffer_load_dwordx4 v26, s[32:35], s65 offen  lds
  ds_read_b64_tr_b16 v[114:115], v17 offset:20032
  ds_read_b128 v[76:79], v9 offset:4096
  s_sub_u32 s71, s71, s72
  s_mul_i32 s9, s71, 3072
  v_mfma_f32_32x32x16_bf16 v[208:223], v[96:99], v[68:71], v[208:223]
  ds_read_b64_tr_b16 v[116:117], v16 offset:18560
  ds_read_b64_tr_b16 v[118:119], v16 offset:20096
  s_add_u32 m0, s23, 0
  s_add_u32 s71, s70, 6
  v_mfma_f32_16x16x32_bf16 a[228:231], v[104:107], a[232:235], a[228:231]
  v_mfma_f32_32x32x16_bf16 v[224:239], v[100:103], v[68:71], v[224:239]
  buffer_load_dwordx4 v27, s[32:35], s65 offen  lds
  s_cmp_ge_u32 s71, 8
  s_cselect_b32 s72, 8, 0
  s_sub_u32 s71, s71, s72
  s_mul_i32 s20, s71, 3072
  v_mfma_f32_32x32x16_bf16 v[240:255], v[104:107], v[68:71], v[240:255]
  s_add_u32 s71, s70, 7
  s_cmp_ge_u32 s71, 8
  s_cselect_b32 s72, 8, 0
  s_sub_u32 s71, s71, s72
  s_mul_i32 s21, s71, 3072
  s_waitcnt lgkmcnt(0)
  v_mfma_f32_32x32x16_bf16 v[160:175], v[108:111], v[72:75], v[160:175]
  s_waitcnt vmcnt(6)
  s_barrier
  ds_read_b64_tr_b16 v[96:97], v18 offset:0
  ds_read_b64_tr_b16 v[98:99], v18 offset:1536
  ds_read_b128 v[64:67], v10 offset:0
  v_mfma_f32_32x32x16_bf16 v[176:191], v[112:115], v[72:75], v[176:191]
  ds_read_b64_tr_b16 v[100:101], v19 offset:64
  ds_read_b64_tr_b16 v[102:103], v19 offset:1600
  ds_read_b128 v[68:71], v10 offset:4096
  s_add_u32 m0, s87, 0
  s_nop 0
  buffer_load_dwordx4 v22, s[28:31], s64 offen  lds
  s_add_u32 m0, s24, 0
  s_nop 0
  buffer_load_dwordx4 v28, s[32:35], s65 offen  lds
  s_add_u32 m0, s89, 0
  s_nop 0
  buffer_load_dwordx4 v23, s[28:31], s64 offen  lds
  s_add_u32 m0, s25, 0
  v_smfmac_f32_16x16x64_bf16 a[220:223], a[236:239], v[108:115], v95
  v_mfma_f32_32x32x16_bf16 v[192:207], v[116:119], v[72:75], v[192:207]
  buffer_load_dwordx4 v29, s[32:35], s65 offen  lds
  ds_read_b64_tr_b16 v[104:105], v18 offset:128
  ds_read_b64_tr_b16 v[106:107], v18 offset:1664
  buffer_load_dwordx4 v[128:131], v93, s[28:31], 0 offen offset:0
  v_mfma_f32_32x32x16_bf16 v[208:223], v[108:111], v[76:79], v[208:223]
  buffer_load_dwordx4 v[132:135], v93, s[28:31], 0 offen offset:256
  buffer_load_dwordx4 v[136:139], v93, s[28:31], 0 offen offset:512
  buffer_load_dwordx4 v[140:143], v93, s[28:31], 0 offen offset:768
  s_cmp_ge_u32 s79, 5
  s_cselect_b32 s72, 5, 0
  v_mfma_f32_16x16x32_bf16 a[228:231], v[116:119], a[232:235], a[228:231]
  v_mfma_f32_32x32x16_bf16 v[224:239], v[112:115], v[76:79], v[224:239]
  buffer_load_dwordx4 v[144:147], v93, s[28:31], 0 offen offset:1024
  buffer_load_dword v127, v124, s[36:39], 0 offen
  s_sub_u32 s70, s79, s72
  s_cmp_ge_u32 s70, 5
  s_cselect_b32 s72, 5, 0
  v_mfma_f32_32x32x16_bf16 v[240:255], v[116:119], v[76:79], v[240:255]
  s_mov_b32 s69, 16384
  buffer_load_dword v127, v124, s[36:39], s69 offen
  buffer_store_dwordx4 v[148:151], v87, s[36:39], 0 offen sc1
  s_sub_u32 s70, s70, s72
  s_waitcnt lgkmcnt(0)
  v_mfma_f32_32x32x16_bf16 v[160:175], v[96:99], v[64:67], v[160:175]
  ds_read_b64_tr_b16 v[108:109], v18 offset:6144
  ds_read_b64_tr_b16 v[110:111], v18 offset:7680
  s_xor_b32 s98, 4, s99
  s_mul_i32 s65, s98, 196608
  s_add_u32 m0, s91, 40960
  s_add_u32 s65, s65, s94
  buffer_load_dwordx4 v24, s[32:35], s65 offen  lds
  v_mfma_f32_32x32x16_bf16 v[176:191], v[100:103], v[64:67], v[176:191]
  ds_read_b128 v[72:75], v11 offset:0
  ds_read_b64_tr_b16 v[112:113], v19 offset:6208
  s_cmp_ge_u32 s70, 5
  s_cselect_b32 s72, 5, 0
  s_sub_u32 s70, s70, s72
  v_smfmac_f32_16x16x64_bf16 a[220:223], a[236:239], v[96:103], v95
  v_mfma_f32_32x32x16_bf16 v[192:207], v[104:107], v[64:67], v[192:207]
  ds_read_b64_tr_b16 v[114:115], v19 offset:7744
  ds_read_b128 v[76:79], v11 offset:4096
  s_lshl_b32 s64, s98, 7
  s_add_u32 m0, s81, 40960
  s_add_u32 s64, s64, s93
  buffer_load_dwordx4 v20, s[28:31], s64 offen  lds
  v_mfma_f32_32x32x16_bf16 v[208:223], v[96:99], v[68:71], v[208:223]
  ds_read_b64_tr_b16 v[116:117], v18 offset:6272
  ds_read_b64_tr_b16 v[118:119], v18 offset:7808
  s_add_u32 m0, s101, 40960
  s_cmp_ge_u32 s70, 5
  s_cselect_b32 s72, 5, 0
  v_mfma_f32_16x16x32_bf16 a[228:231], v[104:107], a[232:235], a[228:231]
  v_mfma_f32_32x32x16_bf16 v[224:239], v[100:103], v[68:71], v[224:239]
  buffer_load_dwordx4 v25, s[32:35], s65 offen  lds
  s_sub_u32 s70, s70, s72
  s_add_u32 s71, s70, 0
  s_cmp_ge_u32 s71, 5
  s_cselect_b32 s72, 5, 0
  v_mfma_f32_32x32x16_bf16 v[240:255], v[104:107], v[68:71], v[240:255]
  s_sub_u32 s71, s71, s72
  s_mul_i32 s10, s71, 2048
  s_add_u32 s71, s70, 1
  s_cmp_ge_u32 s71, 5
  s_cselect_b32 s72, 5, 0
  s_waitcnt lgkmcnt(0)
  v_mfma_f32_32x32x16_bf16 v[160:175], v[108:111], v[72:75], v[160:175]
  ds_read_b64_tr_b16 v[96:97], v18 offset:12288
  ds_read_b64_tr_b16 v[98:99], v18 offset:13824
  s_add_u32 m0, s83, 40960
  s_nop 0
  buffer_load_dwordx4 v21, s[28:31], s64 offen  lds
  s_sub_u32 s71, s71, s72
  v_mfma_f32_32x32x16_bf16 v[176:191], v[112:115], v[72:75], v[176:191]
  ds_read_b128 v[64:67], v12 offset:0
  ds_read_b64_tr_b16 v[100:101], v19 offset:12352
  s_mul_i32 s11, s71, 2048
  s_add_u32 s71, s70, 2
  v_smfmac_f32_16x16x64_bf16 a[220:223], a[236:239], v[108:115], v95
  v_mfma_f32_32x32x16_bf16 v[192:207], v[116:119], v[72:75], v[192:207]
  ds_read_b64_tr_b16 v[102:103], v19 offset:13888
  ds_read_b128 v[68:71], v12 offset:4096
  s_cmp_ge_u32 s71, 5
  s_cselect_b32 s72, 5, 0
  s_sub_u32 s71, s71, s72
  v_mfma_f32_32x32x16_bf16 v[208:223], v[108:111], v[76:79], v[208:223]
  ds_read_b64_tr_b16 v[104:105], v18 offset:12416
  ds_read_b64_tr_b16 v[106:107], v18 offset:13952
  s_mul_i32 s12, s71, 2048
  s_add_u32 s71, s70, 3
  v_mfma_f32_16x16x32_bf16 a[228:231], v[116:119], a[232:235], a[228:231]
  v_mfma_f32_32x32x16_bf16 v[224:239], v[112:115], v[76:79], v[224:239]
  s_cmp_ge_u32 s71, 5
  s_cselect_b32 s72, 5, 0
  s_sub_u32 s71, s71, s72
  s_mul_i32 s13, s71, 2048
  s_add_u32 s71, s70, 4
  v_mfma_f32_32x32x16_bf16 v[240:255], v[116:119], v[76:79], v[240:255]
  s_cmp_ge_u32 s71, 5
  s_cselect_b32 s72, 5, 0
  s_sub_u32 s71, s71, s72
  s_mul_i32 s16, s71, 2048
  v_lshrrev_b32 v30, 3, v1
  s_waitcnt lgkmcnt(0)
  v_mfma_f32_32x32x16_bf16 v[160:175], v[96:99], v[64:67], v[160:175]
  ds_read_b64_tr_b16 v[108:109], v18 offset:18432
  ds_read_b64_tr_b16 v[110:111], v18 offset:19968
  v_and_b32 v46, 7, v1
  s_lshl_b32 s70, s56, 3
  v_add_u32 v47, s70, v30
  v_mfma_f32_32x32x16_bf16 v[176:191], v[100:103], v[64:67], v[176:191]
  ds_read_b128 v[72:75], v13 offset:0
  ds_read_b64_tr_b16 v[112:113], v19 offset:18496
  v_mul_u32_u24 v47, 1280, v47
  s_lshl_b32 s70, s63, 7
  v_add_u32 v47, s70, v47
  v_smfmac_f32_16x16x64_bf16 a[220:223], a[236:239], v[96:103], v95
  v_mfma_f32_32x32x16_bf16 v[192:207], v[104:107], v[64:67], v[192:207]
  ds_read_b64_tr_b16 v[114:115], v19 offset:20032
  ds_read_b128 v[76:79], v13 offset:4096
  v_and_b32 v52, 6, v30
  v_xor_b32 v52, v52, v46
  v_lshl_add_u32 v48, v52, 4, v47
  v_mfma_f32_32x32x16_bf16 v[208:223], v[96:99], v[68:71], v[208:223]
  ds_read_b64_tr_b16 v[116:117], v18 offset:18560
  ds_read_b64_tr_b16 v[118:119], v18 offset:20096
  v_add_u32 v49, 982016, v48
  v_and_b32 v52, 2, v30
  s_lshl_b32 s70, s78, 2
  v_mfma_f32_16x16x32_bf16 a[228:231], v[104:107], a[232:235], a[228:231]
  v_mfma_f32_32x32x16_bf16 v[224:239], v[100:103], v[68:71], v[224:239]
  v_or_b32 v52, s70, v52
  v_xor_b32 v52, v52, v46
  v_lshl_add_u32 v50, v52, 4, v47
  v_add_u32 v51, 408576, v50
  s_lshl_b32 s76, s56, 11
  v_mfma_f32_32x32x16_bf16 v[240:255], v[104:107], v[68:71], v[240:255]
  v_lshrrev_b32 v30, 1, v41
  v_lshl_add_u32 v30, v43, 1, v30
  v_lshl_add_u32 v46, v43, 2, v41
  v_lshlrev_b32 v46, 7, v46
  v_lshl_add_u32 v46, v31, 12, v46
  s_waitcnt lgkmcnt(0)
  v_mfma_f32_32x32x16_bf16 v[160:175], v[108:111], v[72:75], v[160:175]
  s_waitcnt vmcnt(12)
  s_barrier
  ds_read_b64_tr_b16 v[96:97], v14 offset:0
  ds_read_b64_tr_b16 v[98:99], v14 offset:1536
  ds_read_b128 v[64:67], v2 offset:0
  v_mfma_f32_32x32x16_bf16 v[176:191], v[112:115], v[72:75], v[176:191]
  ds_read_b64_tr_b16 v[100:101], v15 offset:64
  ds_read_b64_tr_b16 v[102:103], v15 offset:1600
  ds_read_b128 v[68:71], v2 offset:4096
  s_add_u32 m0, s22, 40960
  s_nop 0
  buffer_load_dwordx4 v26, s[32:35], s65 offen  lds
  s_add_u32 m0, s23, 40960
  v_smfmac_f32_16x16x64_bf16 a[220:223], a[236:239], v[108:115], v95
  v_mfma_f32_32x32x16_bf16 v[192:207], v[116:119], v[72:75], v[192:207]
  buffer_load_dwordx4 v27, s[32:35], s65 offen  lds
  ds_read_b64_tr_b16 v[104:105], v14 offset:128
  ds_read_b64_tr_b16 v[106:107], v14 offset:1664
  v_lshlrev_b32 v47, 7, v41
  v_lshl_add_u32 v47, v40, 11, v47
  v_mfma_f32_32x32x16_bf16 v[208:223], v[108:111], v[76:79], v[208:223]
  s_add_u32 m0, s87, 40960
  s_lshl_b32 s70, s77, 10
  v_lshl_add_u32 v46, v42, 3, v46
  v_add_u32 v46, s70, v46
  v_lshl_add_u32 v47, v42, 3, v47
  v_mfma_f32_16x16x32_bf16 a[228:231], v[116:119], a[232:235], a[228:231]
  v_mfma_f32_32x32x16_bf16 v[224:239], v[112:115], v[76:79], v[224:239]
  buffer_load_dwordx4 v22, s[28:31], s64 offen  lds
  v_add_u32 v47, s70, v47
  s_lshl_b32 s70, s77, 1
  v_xor_b32 v30, s70, v30
  v_xor_b32 v63, 0, v30
  v_mfma_f32_32x32x16_bf16 v[240:255], v[116:119], v[76:79], v[240:255]
  v_lshl_add_u32 v52, v63, 5, v46
  v_lshl_add_u32 v56, v63, 5, v47
  v_xor_b32 v63, 1, v30
  v_lshl_add_u32 v53, v63, 5, v46
  v_lshl_add_u32 v57, v63, 5, v47
  s_waitcnt lgkmcnt(0)
  v_mfma_f32_32x32x16_bf16 v[160:175], v[96:99], v[64:67], v[160:175]
  ds_read_b64_tr_b16 v[108:109], v14 offset:6144
  ds_read_b64_tr_b16 v[110:111], v14 offset:7680
  s_add_u32 m0, s24, 40960
  s_nop 0
  buffer_load_dwordx4 v28, s[32:35], s65 offen  lds
  v_xor_b32 v63, 2, v30
  v_mfma_f32_32x32x16_bf16 v[176:191], v[100:103], v[64:67], v[176:191]
  ds_read_b128 v[72:75], v3 offset:0
  ds_read_b64_tr_b16 v[112:113], v15 offset:6208
  s_add_u32 m0, s89, 40960
  v_lshl_add_u32 v54, v63, 5, v46
  v_lshl_add_u32 v58, v63, 5, v47
  v_smfmac_f32_16x16x64_bf16 a[220:223], a[236:239], v[96:103], v95
  v_mfma_f32_32x32x16_bf16 v[192:207], v[104:107], v[64:67], v[192:207]
  buffer_load_dwordx4 v23, s[28:31], s64 offen  lds
  ds_read_b64_tr_b16 v[114:115], v15 offset:7744
  ds_read_b128 v[76:79], v3 offset:4096
  v_xor_b32 v63, 3, v30
  v_lshl_add_u32 v55, v63, 5, v46
  v_mfma_f32_32x32x16_bf16 v[208:223], v[96:99], v[68:71], v[208:223]
  ds_read_b64_tr_b16 v[116:117], v14 offset:6272
  ds_read_b64_tr_b16 v[118:119], v14 offset:7808
  s_add_u32 m0, s25, 40960
  v_lshl_add_u32 v59, v63, 5, v47
  s_mov_b32 s80, 0x3fb8aa3b
  v_mfma_f32_16x16x32_bf16 a[228:231], v[104:107], a[232:235], a[228:231]
  v_mfma_f32_32x32x16_bf16 v[224:239], v[100:103], v[68:71], v[224:239]
  buffer_load_dwordx4 v29, s[32:35], s65 offen  lds
  s_mov_b32 s82, 0x358637bd
  s_mov_b32 s86, 0xc0135761
  s_mov_b32 s88, 0xbdd2d3e8
  s_mov_b32 s90, 0x3f800000
  v_mfma_f32_32x32x16_bf16 v[240:255], v[104:107], v[68:71], v[240:255]
  s_mov_b32 s84, 0
  s_mov_b32 s85, -1
  v_lshrrev_b32 v62, 3, v1
  v_and_b32 v30, 7, v1
  v_lshlrev_b32 v62, 7, v62
  s_waitcnt lgkmcnt(0)
  v_mfma_f32_32x32x16_bf16 v[160:175], v[108:111], v[72:75], v[160:175]
  ds_read_b64_tr_b16 v[96:97], v14 offset:12288
  ds_read_b64_tr_b16 v[98:99], v14 offset:13824
  s_xor_b32 s98, 5, s99
  s_mul_i32 s65, s98, 196608
  s_add_u32 m0, s91, 81920
  s_add_u32 s65, s65, s94
  buffer_load_dwordx4 v24, s[32:35], s65 offen  lds
  v_mfma_f32_32x32x16_bf16 v[176:191], v[112:115], v[72:75], v[176:191]
  ds_read_b128 v[64:67], v4 offset:0
  ds_read_b64_tr_b16 v[100:101], v15 offset:12352
  v_lshl_add_u32 v62, v30, 3, v62
  v_add_u32 v62, 10687488, v62
  v_and_b32 v63, 31, v1
  v_smfmac_f32_16x16x64_bf16 a[220:223], a[236:239], v[108:115], v95
  v_mfma_f32_32x32x16_bf16 v[192:207], v[116:119], v[72:75], v[192:207]
  ds_read_b64_tr_b16 v[102:103], v15 offset:13888
  ds_read_b128 v[68:71], v4 offset:4096
  s_lshl_b32 s64, s98, 7
  s_add_u32 m0, s81, 81920
  s_add_u32 s64, s64, s93
  buffer_load_dwordx4 v20, s[28:31], s64 offen  lds
  v_mfma_f32_32x32x16_bf16 v[208:223], v[108:111], v[76:79], v[208:223]
  ds_read_b64_tr_b16 v[104:105], v14 offset:12416
  ds_read_b64_tr_b16 v[106:107], v14 offset:13952
  s_add_u32 m0, s101, 81920
  v_lshlrev_b32 v63, 3, v63
  s_lshl_b32 s70, s57, 10
  v_mfma_f32_16x16x32_bf16 a[228:231], v[116:119], a[232:235], a[228:231]
  v_mfma_f32_32x32x16_bf16 v[224:239], v[112:115], v[76:79], v[224:239]
  buffer_load_dwordx4 v25, s[32:35], s65 offen  lds
  s_lshl_b32 s71, s78, 9
  s_add_u32 s70, s70, s71
  s_add_u32 s70, s70, 10633216
  v_add_u32 v63, s70, v63
  v_mfma_f32_32x32x16_bf16 v[240:255], v[116:119], v[76:79], v[240:255]
  s_mul_i32 s70, s58, 192
  s_mul_i32 s71, s77, 96
  s_add_u32 s70, s70, s71
  v_add_u32 v120, s70, v1
  v_min_u32 v30, 31, v1
  s_waitcnt lgkmcnt(0)
  v_mfma_f32_32x32x16_bf16 v[160:175], v[96:99], v[64:67], v[160:175]
  ds_read_b64_tr_b16 v[108:109], v14 offset:18432
  ds_read_b64_tr_b16 v[110:111], v14 offset:19968
  s_add_u32 m0, s83, 81920
  s_nop 0
  buffer_load_dwordx4 v21, s[28:31], s64 offen  lds
  v_add_u32 v121, s70, v30
  v_mfma_f32_32x32x16_bf16 v[176:191], v[100:103], v[64:67], v[176:191]
  ds_read_b128 v[72:75], v5 offset:0
  ds_read_b64_tr_b16 v[112:113], v15 offset:18496
  s_add_u32 m0, s22, 81920
  v_add_u32 v121, 64, v121
  v_lshlrev_b32 v122, 1, v120
  v_smfmac_f32_16x16x64_bf16 a[220:223], a[236:239], v[96:103], v95
  v_mfma_f32_32x32x16_bf16 v[192:207], v[104:107], v[64:67], v[192:207]
  buffer_load_dwordx4 v26, s[32:35], s65 offen  lds
  ds_read_b64_tr_b16 v[114:115], v15 offset:20032
  ds_read_b128 v[76:79], v5 offset:4096
  v_lshlrev_b32 v123, 1, v121
  s_lshl_b32 s70, s56, 10
  v_mfma_f32_32x32x16_bf16 v[208:223], v[96:99], v[68:71], v[208:223]
  ds_read_b64_tr_b16 v[116:117], v14 offset:18560
  ds_read_b64_tr_b16 v[118:119], v14 offset:20096
  s_add_u32 m0, s23, 81920
  s_add_u32 s70, s70, 155648
  v_lshl_add_u32 v80, v1, 2, s70
  v_mfma_f32_16x16x32_bf16 a[228:231], v[104:107], a[232:235], a[228:231]
  v_mfma_f32_32x32x16_bf16 v[224:239], v[100:103], v[68:71], v[224:239]
  buffer_load_dwordx4 v27, s[32:35], s65 offen  lds
  v_lshl_add_u32 v81, v30, 2, s70
  v_lshl_add_u32 v82, v31, 4, s70
  v_and_b32 v30, 1, v1
  v_lshlrev_b32 v30, 6, v30
  v_mfma_f32_32x32x16_bf16 v[240:255], v[104:107], v[68:71], v[240:255]
  v_lshrrev_b32 v46, 4, v1
  v_lshl_add_u32 v30, v46, 4, v30
  v_add_u32 v30, s70, v30
  v_and_b32 v46, 14, v1
  s_waitcnt lgkmcnt(0)
  v_mfma_f32_32x32x16_bf16 v[160:175], v[108:111], v[72:75], v[160:175]
  s_waitcnt vmcnt(6)
  s_barrier
  ds_read_b64_tr_b16 v[96:97], v16 offset:0
  ds_read_b64_tr_b16 v[98:99], v16 offset:1536
  ds_read_b128 v[64:67], v6 offset:0
  v_mfma_f32_32x32x16_bf16 v[176:191], v[112:115], v[72:75], v[176:191]
  ds_read_b64_tr_b16 v[100:101], v17 offset:64
  ds_read_b64_tr_b16 v[102:103], v17 offset:1600
  ds_read_b128 v[68:71], v6 offset:4096
  s_add_u32 m0, s87, 81920
  s_nop 0
  buffer_load_dwordx4 v22, s[28:31], s64 offen  lds
  s_add_u32 m0, s24, 81920
  s_nop 0
  buffer_load_dwordx4 v28, s[32:35], s65 offen  lds
  s_add_u32 m0, s89, 81920
  v_smfmac_f32_16x16x64_bf16 a[220:223], a[236:239], v[108:115], v95
  v_mfma_f32_32x32x16_bf16 v[192:207], v[116:119], v[72:75], v[192:207]
  buffer_load_dwordx4 v23, s[28:31], s64 offen  lds
  ds_read_b64_tr_b16 v[104:105], v16 offset:128
  ds_read_b64_tr_b16 v[106:107], v16 offset:1664
  s_add_u32 m0, s25, 81920
  v_mfma_f32_32x32x16_bf16 v[208:223], v[108:111], v[76:79], v[208:223]
  buffer_load_dwordx4 v29, s[32:35], s65 offen  lds
  buffer_load_dword v60, off, s[0:3], s54 sc1
  v_mfma_f32_16x16x32_bf16 a[228:231], v[116:119], a[232:235], a[228:231]
  v_mfma_f32_32x32x16_bf16 v[224:239], v[112:115], v[76:79], v[224:239]
  buffer_load_dword v127, v85, s[40:43], 0 offen
  v_cmp_eq_u32 vcc, 0, v46
  v_mov_b32 v83, 160768
  s_nop 0
  v_cndmask_b32 v83, v83, v30, vcc
  v_mfma_f32_32x32x16_bf16 v[240:255], v[116:119], v[76:79], v[240:255]
  buffer_load_dword v127, v86, s[44:47], 0 offen
  v_and_b32 v30, 15, v1
  v_lshlrev_b32 v30, 2, v30
  v_lshrrev_b32 v46, 4, v1
  v_lshl_add_u32 v30, v46, 7, v30
  s_waitcnt lgkmcnt(0)
  v_dot2c_f32_bf16 v32, v128, v84
  v_dot2c_f32_bf16 v34, v128, v128
  v_dot2c_f32_bf16 v33, v129, v84
  v_dot2c_f32_bf16 v35, v129, v129
  v_dot2c_f32_bf16 v32, v130, v84
  v_dot2c_f32_bf16 v34, v130, v130
  v_dot2c_f32_bf16 v33, v131, v84
  v_dot2c_f32_bf16 v35, v131, v131
  v_dot2c_f32_bf16 v32, v132, v84
  v_dot2c_f32_bf16 v34, v132, v132
  v_dot2c_f32_bf16 v33, v133, v84
  v_dot2c_f32_bf16 v35, v133, v133
  v_dot2c_f32_bf16 v32, v134, v84
  v_dot2c_f32_bf16 v34, v134, v134
  v_dot2c_f32_bf16 v33, v135, v84
  v_dot2c_f32_bf16 v35, v135, v135
  v_dot2c_f32_bf16 v32, v136, v84
  v_dot2c_f32_bf16 v34, v136, v136
  v_dot2c_f32_bf16 v33, v137, v84
  v_dot2c_f32_bf16 v35, v137, v137
  v_dot2c_f32_bf16 v32, v138, v84
  v_dot2c_f32_bf16 v34, v138, v138
  v_dot2c_f32_bf16 v33, v139, v84
  v_dot2c_f32_bf16 v35, v139, v139
  v_dot2c_f32_bf16 v32, v140, v84
  v_dot2c_f32_bf16 v34, v140, v140
  v_dot2c_f32_bf16 v33, v141, v84
  v_dot2c_f32_bf16 v35, v141, v141
  v_dot2c_f32_bf16 v32, v142, v84
  v_dot2c_f32_bf16 v34, v142, v142
  v_dot2c_f32_bf16 v33, v143, v84
  v_dot2c_f32_bf16 v35, v143, v143
  v_dot2c_f32_bf16 v32, v144, v84
  v_dot2c_f32_bf16 v34, v144, v144
  v_dot2c_f32_bf16 v33, v145, v84
  v_dot2c_f32_bf16 v35, v145, v145
  v_dot2c_f32_bf16 v32, v146, v84
  v_dot2c_f32_bf16 v34, v146, v146
  v_dot2c_f32_bf16 v33, v147, v84
  v_dot2c_f32_bf16 v35, v147, v147
  v_mfma_f32_32x32x16_bf16 v[160:175], v[96:99], v[64:67], v[160:175]
  ds_read_b64_tr_b16 v[108:109], v16 offset:6144
  ds_read_b64_tr_b16 v[110:111], v16 offset:7680
  s_xor_b32 s98, 6, s99
  s_mul_i32 s65, s98, 196608
  s_add_u32 m0, s91, 0
  s_add_u32 s65, s65, s94
  buffer_load_dwordx4 v24, s[32:35], s65 offen  lds
  v_mfma_f32_32x32x16_bf16 v[176:191], v[100:103], v[64:67], v[176:191]
  ds_read_b128 v[72:75], v7 offset:0
  ds_read_b64_tr_b16 v[112:113], v17 offset:6208
  s_nop 2
  v_add_f32 v32, v32, v33
  v_add_f32 v34, v34, v35
  v_smfmac_f32_16x16x64_bf16 a[220:223], a[236:239], v[96:103], v95
  v_mfma_f32_32x32x16_bf16 v[192:207], v[104:107], v[64:67], v[192:207]
  ds_read_b64_tr_b16 v[114:115], v17 offset:7744
  ds_read_b128 v[76:79], v7 offset:4096
  s_lshl_b32 s64, s98, 7
  s_add_u32 m0, s81, 0
  s_add_u32 s64, s64, s93
  buffer_load_dwordx4 v20, s[28:31], s64 offen  lds
  v_mfma_f32_32x32x16_bf16 v[208:223], v[96:99], v[68:71], v[208:223]
  ds_read_b64_tr_b16 v[116:117], v16 offset:6272
  ds_read_b64_tr_b16 v[118:119], v16 offset:7808
  s_add_u32 m0, s101, 0
  s_nop 0
  v_add_f32 v32, v32, v32 row_ror:8
  v_mfma_f32_16x16x32_bf16 a[228:231], v[104:107], a[232:235], a[228:231]
  v_mfma_f32_32x32x16_bf16 v[224:239], v[100:103], v[68:71], v[224:239]
  buffer_load_dwordx4 v25, s[32:35], s65 offen  lds
  v_add_f32 v34, v34, v34 row_ror:8
  s_nop 0
  v_add_f32 v32, v32, v32 row_ror:4
  v_add_f32 v34, v34, v34 row_ror:4
  v_mfma_f32_32x32x16_bf16 v[240:255], v[104:107], v[68:71], v[240:255]
  s_nop 0
  v_add_f32 v32, v32, v32 row_ror:2
  v_add_f32 v34, v34, v34 row_ror:2
  s_nop 0
  v_add_f32 v32, v32, v32 row_ror:1
  s_waitcnt lgkmcnt(0)
  v_mfma_f32_32x32x16_bf16 v[160:175], v[108:111], v[72:75], v[160:175]
  ds_read_b64_tr_b16 v[96:97], v16 offset:12288
  ds_read_b64_tr_b16 v[98:99], v16 offset:13824
  s_add_u32 m0, s83, 0
  s_nop 0
  buffer_load_dwordx4 v21, s[28:31], s64 offen  lds
  v_add_f32 v34, v34, v34 row_ror:1
  v_mfma_f32_32x32x16_bf16 v[176:191], v[112:115], v[72:75], v[176:191]
  ds_read_b128 v[64:67], v8 offset:0
  ds_read_b64_tr_b16 v[100:101], v17 offset:12352
  v_mul_f32 v32, 0x3acccccd, v32
  v_mul_f32 v34, 0x3acccccd, v34
  v_fma_f32 v34, -v32, v32, v34
  v_smfmac_f32_16x16x64_bf16 a[220:223], a[236:239], v[108:115], v95
  v_mfma_f32_32x32x16_bf16 v[192:207], v[116:119], v[72:75], v[192:207]
  ds_read_b64_tr_b16 v[102:103], v17 offset:13888
  ds_read_b128 v[68:71], v8 offset:4096
  v_max_f32 v34, 0, v34
  v_add_f32 v35, 0x3727c5ac, v34
  v_rsq_f32 v36, v35
  v_mfma_f32_32x32x16_bf16 v[208:223], v[108:111], v[76:79], v[208:223]
  ds_read_b64_tr_b16 v[104:105], v16 offset:12416
  ds_read_b64_tr_b16 v[106:107], v16 offset:13952
  s_nop 0
  v_mul_f32 v34, v34, v36
  v_mul_f32 v37, v36, v32
  v_mfma_f32_16x16x32_bf16 a[228:231], v[116:119], a[232:235], a[228:231]
  v_mfma_f32_32x32x16_bf16 v[224:239], v[112:115], v[76:79], v[224:239]
  v_mul_f32 v34, v34, v36
  v_add_f32 v34, 0x3727c5ac, v34
  v_rsq_f32 v34, v34
  s_nop 0
  v_mul_f32 v38, v34, v36
  v_mfma_f32_32x32x16_bf16 v[240:255], v[116:119], v[76:79], v[240:255]
  v_mul_f32 v39, v34, v37
  buffer_store_dwordx2 v[36:37], v124, s[36:39], 0 offen sc1
  s_mov_b32 s69, 16384
  buffer_store_dwordx2 v[38:39], v124, s[36:39], s69 offen sc1
  v_add_u32 v30, s70, v30
  s_waitcnt lgkmcnt(0)
  v_mfma_f32_32x32x16_bf16 v[160:175], v[96:99], v[64:67], v[160:175]
  ds_read_b64_tr_b16 v[108:109], v16 offset:18432
  ds_read_b64_tr_b16 v[110:111], v16 offset:19968
  v_mfma_f32_32x32x16_bf16 v[176:191], v[100:103], v[64:67], v[176:191]
  ds_read_b128 v[72:75], v9 offset:0
  ds_read_b64_tr_b16 v[112:113], v17 offset:18496
  v_smfmac_f32_16x16x64_bf16 a[220:223], a[236:239], v[96:103], v95
  v_mfma_f32_32x32x16_bf16 v[192:207], v[104:107], v[64:67], v[192:207]
  ds_read_b64_tr_b16 v[114:115], v17 offset:20032
  ds_read_b128 v[76:79], v9 offset:4096
  v_mfma_f32_32x32x16_bf16 v[208:223], v[96:99], v[68:71], v[208:223]
  ds_read_b64_tr_b16 v[116:117], v16 offset:18560
  ds_read_b64_tr_b16 v[118:119], v16 offset:20096
  v_mfma_f32_16x16x32_bf16 a[228:231], v[104:107], a[232:235], a[228:231]
  v_mfma_f32_32x32x16_bf16 v[224:239], v[100:103], v[68:71], v[224:239]
  v_cmp_gt_u32 vcc, 32, v1
  v_mov_b32 v120, 160768
  s_nop 0
  v_cndmask_b32 v120, v120, v30, vcc
  s_lshl_b32 s70, s57, 3
  v_mfma_f32_32x32x16_bf16 v[240:255], v[104:107], v[68:71], v[240:255]
  s_lshl_b32 s71, s78, 2
  s_add_u32 s70, s70, s71
  v_bfe_u32 v30, v1, 4, 1
  v_add_u32 v30, s70, v30
  v_mul_u32_u24 v30, 69632, v30
  s_waitcnt lgkmcnt(0)
  v_mfma_f32_32x32x16_bf16 v[160:175], v[108:111], v[72:75], v[160:175]
  s_waitcnt vmcnt(9)
  s_barrier
  ds_read_b64_tr_b16 v[96:97], v18 offset:0
  ds_read_b64_tr_b16 v[98:99], v18 offset:1536
  ds_read_b128 v[64:67], v10 offset:0
  v_mfma_f32_32x32x16_bf16 v[176:191], v[112:115], v[72:75], v[176:191]
  ds_read_b64_tr_b16 v[100:101], v19 offset:64
  ds_read_b64_tr_b16 v[102:103], v19 offset:1600
  ds_read_b128 v[68:71], v10 offset:4096
  s_add_u32 m0, s22, 0
  s_nop 0
  buffer_load_dwordx4 v26, s[32:35], s65 offen  lds
  s_add_u32 m0, s23, 0
  v_smfmac_f32_16x16x64_bf16 a[220:223], a[236:239], v[108:115], v95
  v_mfma_f32_32x32x16_bf16 v[192:207], v[116:119], v[72:75], v[192:207]
  buffer_load_dwordx4 v27, s[32:35], s65 offen  lds
  ds_read_b64_tr_b16 v[104:105], v18 offset:128
  ds_read_b64_tr_b16 v[106:107], v18 offset:1664
  v_and_b32 v46, 15, v1
  v_lshl_add_u32 v30, v46, 4, v30
  v_mfma_f32_32x32x16_bf16 v[208:223], v[108:111], v[76:79], v[208:223]
  s_add_u32 m0, s87, 0
  v_lshl_add_u32 v30, v31, 8, v30
  s_mul_i32 s70, s58, 6144
  s_mul_i32 s71, s77, 3072
  s_add_u32 s70, s70, s71
  v_mfma_f32_16x16x32_bf16 a[228:231], v[116:119], a[232:235], a[228:231]
  v_mfma_f32_32x32x16_bf16 v[224:239], v[112:115], v[76:79], v[224:239]
  buffer_load_dwordx4 v22, s[28:31], s64 offen  lds
  v_add_u32 v90, s70, v30
  v_add_u32 v91, 139264, v90
  s_lshl_b32 s70, s57, 7
  s_lshl_b32 s71, s58, 2
  v_mfma_f32_32x32x16_bf16 v[240:255], v[116:119], v[76:79], v[240:255]
  s_add_u32 s70, s70, s71
  s_add_u32 s70, s70, 10683392
  v_mov_b32 v94, 0x40000000
  v_mov_b32 v30, s70
  s_waitcnt lgkmcnt(0)
  v_mfma_f32_32x32x16_bf16 v[160:175], v[96:99], v[64:67], v[160:175]
  ds_read_b64_tr_b16 v[108:109], v18 offset:6144
  ds_read_b64_tr_b16 v[110:111], v18 offset:7680
  s_add_u32 m0, s24, 0
  s_nop 0
  buffer_load_dwordx4 v28, s[32:35], s65 offen  lds
  v_mfma_f32_32x32x16_bf16 v[176:191], v[100:103], v[64:67], v[176:191]
  ds_read_b128 v[72:75], v11 offset:0
  ds_read_b64_tr_b16 v[112:113], v19 offset:6208
  s_add_u32 m0, s89, 0
  v_smfmac_f32_16x16x64_bf16 a[220:223], a[236:239], v[96:103], v95
  v_mfma_f32_32x32x16_bf16 v[192:207], v[104:107], v[64:67], v[192:207]
  buffer_load_dwordx4 v23, s[28:31], s64 offen  lds
  ds_read_b64_tr_b16 v[114:115], v19 offset:7744
  ds_read_b128 v[76:79], v11 offset:4096
  v_mfma_f32_32x32x16_bf16 v[208:223], v[96:99], v[68:71], v[208:223]
  ds_read_b64_tr_b16 v[116:117], v18 offset:6272
  ds_read_b64_tr_b16 v[118:119], v18 offset:7808
  s_add_u32 m0, s25, 0
  v_mfma_f32_16x16x32_bf16 a[228:231], v[104:107], a[232:235], a[228:231]
  v_mfma_f32_32x32x16_bf16 v[224:239], v[100:103], v[68:71], v[224:239]
  buffer_load_dwordx4 v29, s[32:35], s65 offen  lds
  v_cmp_eq_u32 vcc, 0, v0
  s_nop 1
  v_cndmask_b32 v94, v94, v30, vcc
  s_mul_i32 s70, s78, 3
  v_mfma_f32_32x32x16_bf16 v[240:255], v[104:107], v[68:71], v[240:255]
  s_add_u32 s70, s70, s62
  s_mul_i32 s71, s70, 69632
  s_mul_i32 s72, s77, 24576
  s_add_u32 s71, s71, s72
  v_lshl_add_u32 v47, v1, 4, s71
  s_waitcnt lgkmcnt(0)
  v_mfma_f32_32x32x16_bf16 v[160:175], v[108:111], v[72:75], v[160:175]
  ds_read_b64_tr_b16 v[96:97], v18 offset:12288
  ds_read_b64_tr_b16 v[98:99], v18 offset:13824
  s_xor_b32 s98, 7, s99
  s_mul_i32 s65, s98, 196608
  s_add_u32 m0, s91, 40960
  s_add_u32 s65, s65, s94
  buffer_load_dwordx4 v24, s[32:35], s65 offen  lds
  v_mfma_f32_32x32x16_bf16 v[176:191], v[112:115], v[72:75], v[176:191]
  ds_read_b128 v[64:67], v12 offset:0
  ds_read_b64_tr_b16 v[100:101], v19 offset:12352
  v_accvgpr_write_b32 a200, v47
  s_mul_i32 s72, s77, 14336
  s_sub_u32 s79, 49152, s72
  v_smfmac_f32_16x16x64_bf16 a[220:223], a[236:239], v[108:115], v95
  v_mfma_f32_32x32x16_bf16 v[192:207], v[116:119], v[72:75], v[192:207]
  ds_read_b64_tr_b16 v[102:103], v19 offset:13888
  ds_read_b128 v[68:71], v12 offset:4096
  s_lshl_b32 s64, s98, 7
  s_add_u32 m0, s81, 40960
  s_add_u32 s64, s64, s93
  buffer_load_dwordx4 v20, s[28:31], s64 offen  lds
  v_mfma_f32_32x32x16_bf16 v[208:223], v[108:111], v[76:79], v[208:223]
  ds_read_b64_tr_b16 v[104:105], v18 offset:12416
  ds_read_b64_tr_b16 v[106:107], v18 offset:13952
  s_add_u32 m0, s101, 40960
  s_lshr_b32 s71, s62, 3
  s_add_u32 s72, s62, 5
  v_mfma_f32_16x16x32_bf16 a[228:231], v[116:119], a[232:235], a[228:231]
  v_mfma_f32_32x32x16_bf16 v[224:239], v[112:115], v[76:79], v[224:239]
  buffer_load_dwordx4 v25, s[32:35], s65 offen  lds
  s_lshr_b32 s72, s72, 3
  s_sub_u32 s72, s72, s71
  s_lshl_b32 s72, s72, 7
  s_lshl_b32 s71, s71, 7
  v_mfma_f32_32x32x16_bf16 v[240:255], v[116:119], v[76:79], v[240:255]
  s_add_u32 s71, s71, 10683392
  v_bfe_u32 v30, v1, 3, 1
  v_mul_lo_u32 v30, s72, v30
  v_and_b32 v46, 7, v1
  v_lshl_add_u32 v30, v46, 2, v30
  s_waitcnt lgkmcnt(0)
  v_mfma_f32_32x32x16_bf16 v[160:175], v[96:99], v[64:67], v[160:175]
  ds_read_b64_tr_b16 v[108:109], v18 offset:18432
  ds_read_b64_tr_b16 v[110:111], v18 offset:19968
  s_add_u32 m0, s83, 40960
  s_nop 0
  buffer_load_dwordx4 v21, s[28:31], s64 offen  lds
  v_add_u32 v47, s71, v30
  v_mfma_f32_32x32x16_bf16 v[176:191], v[100:103], v[64:67], v[176:191]
  ds_read_b128 v[72:75], v13 offset:0
  ds_read_b64_tr_b16 v[112:113], v19 offset:18496
  s_add_u32 m0, s22, 40960
  v_accvgpr_write_b32 a201, v47
  s_lshl_b32 s70, s70, 4
  v_smfmac_f32_16x16x64_bf16 a[220:223], a[236:239], v[96:103], v95
  v_mfma_f32_32x32x16_bf16 v[192:207], v[104:107], v[64:67], v[192:207]
  buffer_load_dwordx4 v26, s[32:35], s65 offen  lds
  ds_read_b64_tr_b16 v[114:115], v19 offset:20032
  ds_read_b128 v[76:79], v13 offset:4096
  v_and_b32 v30, 15, v1
  v_add_u32 v30, s70, v30
  v_mfma_f32_32x32x16_bf16 v[208:223], v[96:99], v[68:71], v[208:223]
  ds_read_b64_tr_b16 v[116:117], v18 offset:18560
  ds_read_b64_tr_b16 v[118:119], v18 offset:20096
  s_add_u32 m0, s23, 40960
  v_mul_u32_u24 v30, 1280, v30
  v_bfe_u32 v46, v1, 4, 1
  v_mfma_f32_16x16x32_bf16 a[228:231], v[104:107], a[232:235], a[228:231]
  v_mfma_f32_32x32x16_bf16 v[224:239], v[100:103], v[68:71], v[224:239]
  buffer_load_dwordx4 v27, s[32:35], s65 offen  lds
  v_lshl_add_u32 v46, v46, 1, v31
  v_lshl_add_u32 v30, v46, 4, v30
  s_lshl_b32 s70, s63, 7
  s_lshl_b32 s71, s77, 6
  v_mfma_f32_32x32x16_bf16 v[240:255], v[104:107], v[68:71], v[240:255]
  s_add_u32 s70, s70, s71
  v_add_u32 v47, s70, v30
  v_mov_b32 v87, v47
  v_accvgpr_write_b32 a202, v47
  v_lshrrev_b32 v46, 4, v1
  v_lshl_add_u32 v88, v46, 3, s70
  s_lshl_b32 s70, s56, 3
  s_xor_b32 s71, s70, 16
  s_lshr_b32 s72, 0x5020100, s70
  s_and_b32 s72, s72, 31
  s_lshl_b32 s72, s72, 13
  v_lshl_add_u32 v47, v1, 4, s72
  v_accvgpr_write_b32 a204, v47
  s_lshr_b32 s72, 0x5020100, s71
  s_and_b32 s72, s72, 31
  s_lshl_b32 s72, s72, 13
  v_lshl_add_u32 v47, v1, 4, s72
  v_accvgpr_write_b32 a205, v47
  s_lshr_b32 s72, 0x100f0706, s70
  s_and_b32 s72, s72, 31
  s_lshl_b32 s72, s72, 13
  v_lshl_add_u32 v47, v1, 4, s72
  v_accvgpr_write_b32 a206, v47
  s_lshr_b32 s72, 0x100f0706, s71
  s_and_b32 s72, s72, 31
  s_lshl_b32 s72, s72, 13
  v_lshl_add_u32 v47, v1, 4, s72
  v_accvgpr_write_b32 a207, v47
  s_waitcnt lgkmcnt(0)
  v_mfma_f32_32x32x16_bf16 v[160:175], v[108:111], v[72:75], v[160:175]
  s_waitcnt vmcnt(6)
  v_cmp_gt_u32 vcc, s53, v60
  s_nop 0
  s_cmp_eq_u64 vcc, 0
  s_cbranch_scc0 Lslow_13
Lback_14:
  s_barrier
  ds_read_b64_tr_b16 v[96:97], v14 offset:0
  ds_read_b64_tr_b16 v[98:99], v14 offset:1536
  ds_read_b128 v[64:67], v2 offset:0
  v_mfma_f32_32x32x16_bf16 v[176:191], v[112:115], v[72:75], v[176:191]
  ds_read_b64_tr_b16 v[100:101], v15 offset:64
  ds_read_b64_tr_b16 v[102:103], v15 offset:1600
  ds_read_b128 v[68:71], v2 offset:4096
  s_add_u32 m0, s87, 40960
  s_nop 0
  buffer_load_dwordx4 v22, s[28:31], s64 offen  lds
  s_add_u32 m0, s24, 40960
  s_nop 0
  buffer_load_dwordx4 v28, s[32:35], s65 offen  lds
  s_add_u32 m0, s89, 40960
  v_smfmac_f32_16x16x64_bf16 a[220:223], a[236:239], v[108:115], v95
  v_mfma_f32_32x32x16_bf16 v[192:207], v[116:119], v[72:75], v[192:207]
  buffer_load_dwordx4 v23, s[28:31], s64 offen  lds
  ds_read_b64_tr_b16 v[104:105], v14 offset:128
  ds_read_b64_tr_b16 v[106:107], v14 offset:1664
  s_add_u32 m0, s25, 40960
  s_nop 0
  buffer_load_dwordx4 v29, s[32:35], s65 offen  lds
  v_mfma_f32_32x32x16_bf16 v[208:223], v[108:111], v[76:79], v[208:223]
  buffer_store_dword v125, v89, s[36:39], 0 offen sc1
  global_load_dwordx2 a[216:217], v88, s[18:19]
  v_mfma_f32_16x16x32_bf16 a[228:231], v[116:119], a[232:235], a[228:231]
  v_mfma_f32_32x32x16_bf16 v[224:239], v[112:115], v[76:79], v[224:239]
  global_load_dwordx2 a[218:219], v88, s[18:19] offset:32
  s_xor_b32 s98, 8, s100
  s_mul_i32 s65, s98, 196608
  s_add_u32 m0, s91, 81920
  s_add_u32 s65, s65, s94
  buffer_load_dwordx4 v24, s[32:35], s65 offen  lds
  v_mfma_f32_32x32x16_bf16 v[240:255], v[116:119], v[76:79], v[240:255]
  s_lshl_b32 s64, s98, 7
  s_add_u32 m0, s81, 81920
  s_add_u32 s64, s64, s93
  buffer_load_dwordx4 v20, s[28:31], s64 offen  lds
  s_waitcnt lgkmcnt(0)
  v_mfma_f32_32x32x16_bf16 v[160:175], v[96:99], v[64:67], v[160:175]
  ds_read_b64_tr_b16 v[108:109], v14 offset:6144
  ds_read_b64_tr_b16 v[110:111], v14 offset:7680
  s_add_u32 m0, s101, 81920
  s_nop 0
  buffer_load_dwordx4 v25, s[32:35], s65 offen  lds
  v_mfma_f32_32x32x16_bf16 v[176:191], v[100:103], v[64:67], v[176:191]
  ds_read_b128 v[72:75], v3 offset:0
  ds_read_b64_tr_b16 v[112:113], v15 offset:6208
  s_add_u32 m0, s83, 81920
  v_smfmac_f32_16x16x64_bf16 a[220:223], a[236:239], v[96:103], v95
  v_mfma_f32_32x32x16_bf16 v[192:207], v[104:107], v[64:67], v[192:207]
  buffer_load_dwordx4 v21, s[28:31], s64 offen  lds
  ds_read_b64_tr_b16 v[114:115], v15 offset:7744
  ds_read_b128 v[76:79], v3 offset:4096
  v_mfma_f32_32x32x16_bf16 v[208:223], v[96:99], v[68:71], v[208:223]
  ds_read_b64_tr_b16 v[116:117], v14 offset:6272
  ds_read_b64_tr_b16 v[118:119], v14 offset:7808
  s_add_u32 m0, s22, 81920
  v_mfma_f32_16x16x32_bf16 a[228:231], v[104:107], a[232:235], a[228:231]
  v_mfma_f32_32x32x16_bf16 v[224:239], v[100:103], v[68:71], v[224:239]
  buffer_load_dwordx4 v26, s[32:35], s65 offen  lds
  v_mfma_f32_32x32x16_bf16 v[240:255], v[104:107], v[68:71], v[240:255]
  s_waitcnt lgkmcnt(0)
  v_mfma_f32_32x32x16_bf16 v[160:175], v[108:111], v[72:75], v[160:175]
  ds_read_b64_tr_b16 v[96:97], v14 offset:12288
  ds_read_b64_tr_b16 v[98:99], v14 offset:13824
  s_add_u32 m0, s23, 81920
  s_nop 0
  buffer_load_dwordx4 v27, s[32:35], s65 offen  lds
  v_mfma_f32_32x32x16_bf16 v[176:191], v[112:115], v[72:75], v[176:191]
  ds_read_b128 v[64:67], v4 offset:0
  ds_read_b64_tr_b16 v[100:101], v15 offset:12352
  v_smfmac_f32_16x16x64_bf16 a[220:223], a[236:239], v[108:115], v95
  v_mfma_f32_32x32x16_bf16 v[192:207], v[116:119], v[72:75], v[192:207]
  ds_read_b64_tr_b16 v[102:103], v15 offset:13888
  ds_read_b128 v[68:71], v4 offset:4096
  v_mfma_f32_32x32x16_bf16 v[208:223], v[108:111], v[76:79], v[208:223]
  ds_read_b64_tr_b16 v[104:105], v14 offset:12416
  ds_read_b64_tr_b16 v[106:107], v14 offset:13952
  v_mfma_f32_16x16x32_bf16 a[228:231], v[116:119], a[232:235], a[228:231]
  v_mfma_f32_32x32x16_bf16 v[224:239], v[112:115], v[76:79], v[224:239]
  v_mfma_f32_32x32x16_bf16 v[240:255], v[116:119], v[76:79], v[240:255]
  s_waitcnt lgkmcnt(0)
  v_mfma_f32_32x32x16_bf16 v[160:175], v[96:99], v[64:67], v[160:175]
  ds_read_b64_tr_b16 v[108:109], v14 offset:18432
  ds_read_b64_tr_b16 v[110:111], v14 offset:19968
  v_mfma_f32_32x32x16_bf16 v[176:191], v[100:103], v[64:67], v[176:191]
  ds_read_b128 v[72:75], v5 offset:0
  ds_read_b64_tr_b16 v[112:113], v15 offset:18496
  v_smfmac_f32_16x16x64_bf16 a[220:223], a[236:239], v[96:103], v95
  v_mfma_f32_32x32x16_bf16 v[192:207], v[104:107], v[64:67], v[192:207]
  ds_read_b64_tr_b16 v[114:115], v15 offset:20032
  ds_read_b128 v[76:79], v5 offset:4096
  v_mfma_f32_32x32x16_bf16 v[208:223], v[96:99], v[68:71], v[208:223]
  ds_read_b64_tr_b16 v[116:117], v14 offset:18560
  ds_read_b64_tr_b16 v[118:119], v14 offset:20096
  v_mfma_f32_16x16x32_bf16 a[228:231], v[104:107], a[232:235], a[228:231]
  v_mfma_f32_32x32x16_bf16 v[224:239], v[100:103], v[68:71], v[224:239]
  v_mfma_f32_32x32x16_bf16 v[240:255], v[104:107], v[68:71], v[240:255]
  s_waitcnt lgkmcnt(0)
  v_mfma_f32_32x32x16_bf16 v[160:175], v[108:111], v[72:75], v[160:175]
  s_waitcnt vmcnt(9)
  s_barrier
  ds_read_b64_tr_b16 v[96:97], v16 offset:0
  ds_read_b64_tr_b16 v[98:99], v16 offset:1536
  ds_read_b128 v[64:67], v6 offset:0
  v_mfma_f32_32x32x16_bf16 v[176:191], v[112:115], v[72:75], v[176:191]
  ds_read_b64_tr_b16 v[100:101], v17 offset:64
  ds_read_b64_tr_b16 v[102:103], v17 offset:1600
  ds_read_b128 v[68:71], v6 offset:4096
  s_add_u32 m0, s87, 81920
  s_nop 0
  buffer_load_dwordx4 v22, s[28:31], s64 offen  lds
  s_add_u32 m0, s24, 81920
  s_nop 0
  buffer_load_dwordx4 v28, s[32:35], s65 offen  lds
  s_add_u32 m0, s89, 81920
  v_smfmac_f32_16x16x64_bf16 a[220:223], a[236:239], v[108:115], v95
  v_mfma_f32_32x32x16_bf16 v[192:207], v[116:119], v[72:75], v[192:207]
  buffer_load_dwordx4 v23, s[28:31], s64 offen  lds
  ds_read_b64_tr_b16 v[104:105], v16 offset:128
  ds_read_b64_tr_b16 v[106:107], v16 offset:1664
  s_add_u32 m0, s25, 81920
  v_mfma_f32_32x32x16_bf16 v[208:223], v[108:111], v[76:79], v[208:223]
  buffer_load_dwordx4 v29, s[32:35], s65 offen  lds
  s_add_u32 m0, s76, 122880
  s_mul_i32 s17, s4, 40
  buffer_load_dwordx4 v48, s[40:43], s17 offen  lds
  v_mfma_f32_16x16x32_bf16 a[228:231], v[116:119], a[232:235], a[228:231]
  v_mfma_f32_32x32x16_bf16 v[224:239], v[112:115], v[76:79], v[224:239]
  buffer_load_dwordx4 v49, s[40:43], s17 offen offset:1024  lds
  v_mfma_f32_32x32x16_bf16 v[240:255], v[116:119], v[76:79], v[240:255]
  s_add_u32 m0, s76, 131072
  s_mul_i32 s17, s4, 40
  s_add_u32 s17, s17, 40960
  buffer_load_dwordx4 v48, s[40:43], s17 offen  lds
  s_waitcnt lgkmcnt(0)
  v_mfma_f32_32x32x16_bf16 v[160:175], v[96:99], v[64:67], v[160:175]
  ds_read_b64_tr_b16 v[108:109], v16 offset:6144
  ds_read_b64_tr_b16 v[110:111], v16 offset:7680
  buffer_load_dwordx4 v49, s[40:43], s17 offen offset:1024  lds
  v_mfma_f32_32x32x16_bf16 v[176:191], v[100:103], v[64:67], v[176:191]
  ds_read_b128 v[72:75], v7 offset:0
  ds_read_b64_tr_b16 v[112:113], v17 offset:6208
  global_load_ushort v136, v122, s[14:15]
  v_smfmac_f32_16x16x64_bf16 a[220:223], a[236:239], v[96:103], v95
  v_mfma_f32_32x32x16_bf16 v[192:207], v[104:107], v[64:67], v[192:207]
  ds_read_b64_tr_b16 v[114:115], v17 offset:7744
  ds_read_b128 v[76:79], v7 offset:4096
  global_load_ushort v137, v123, s[14:15]
  v_mfma_f32_32x32x16_bf16 v[208:223], v[96:99], v[68:71], v[208:223]
  ds_read_b64_tr_b16 v[116:117], v16 offset:6272
  ds_read_b64_tr_b16 v[118:119], v16 offset:7808
  s_xor_b32 s98, 9, s100
  s_mul_i32 s65, s98, 196608
  s_add_u32 m0, s91, 0
  s_add_u32 s65, s65, s94
  buffer_load_dwordx4 v24, s[32:35], s65 offen  lds
  v_mfma_f32_16x16x32_bf16 a[228:231], v[104:107], a[232:235], a[228:231]
  v_mfma_f32_32x32x16_bf16 v[224:239], v[100:103], v[68:71], v[224:239]
  s_lshl_b32 s64, s98, 7
  s_add_u32 m0, s81, 0
  s_add_u32 s64, s64, s93
  buffer_load_dwordx4 v20, s[28:31], s64 offen  lds
  v_mfma_f32_32x32x16_bf16 v[240:255], v[104:107], v[68:71], v[240:255]
  s_waitcnt lgkmcnt(0)
  v_mfma_f32_32x32x16_bf16 v[160:175], v[108:111], v[72:75], v[160:175]
  ds_read_b64_tr_b16 v[96:97], v16 offset:12288
  ds_read_b64_tr_b16 v[98:99], v16 offset:13824
  s_add_u32 m0, s101, 0
  s_nop 0
  buffer_load_dwordx4 v25, s[32:35], s65 offen  lds
  s_add_u32 m0, s83, 0
  v_mfma_f32_32x32x16_bf16 v[176:191], v[112:115], v[72:75], v[176:191]
  buffer_load_dwordx4 v21, s[28:31], s64 offen  lds
  ds_read_b128 v[64:67], v8 offset:0
  ds_read_b64_tr_b16 v[100:101], v17 offset:12352
  s_add_u32 m0, s22, 0
  v_smfmac_f32_16x16x64_bf16 a[220:223], a[236:239], v[108:115], v95
  v_mfma_f32_32x32x16_bf16 v[192:207], v[116:119], v[72:75], v[192:207]
  buffer_load_dwordx4 v26, s[32:35], s65 offen  lds
  ds_read_b64_tr_b16 v[102:103], v17 offset:13888
  ds_read_b128 v[68:71], v8 offset:4096
  s_add_u32 m0, s23, 0
  v_mfma_f32_32x32x16_bf16 v[208:223], v[108:111], v[76:79], v[208:223]
  buffer_load_dwordx4 v27, s[32:35], s65 offen  lds
  ds_read_b64_tr_b16 v[104:105], v16 offset:12416
  ds_read_b64_tr_b16 v[106:107], v16 offset:13952
  s_add_u32 m0, s87, 0
  v_mfma_f32_16x16x32_bf16 a[228:231], v[116:119], a[232:235], a[228:231]
  v_mfma_f32_32x32x16_bf16 v[224:239], v[112:115], v[76:79], v[224:239]
  buffer_load_dwordx4 v22, s[28:31], s64 offen  lds
  v_mfma_f32_32x32x16_bf16 v[240:255], v[116:119], v[76:79], v[240:255]
  s_waitcnt lgkmcnt(0)
  v_mfma_f32_32x32x16_bf16 v[160:175], v[96:99], v[64:67], v[160:175]
  ds_read_b64_tr_b16 v[108:109], v16 offset:18432
  ds_read_b64_tr_b16 v[110:111], v16 offset:19968
  s_add_u32 m0, s24, 0
  s_nop 0
  buffer_load_dwordx4 v28, s[32:35], s65 offen  lds
  v_mfma_f32_32x32x16_bf16 v[176:191], v[100:103], v[64:67], v[176:191]
  ds_read_b128 v[72:75], v9 offset:0
  ds_read_b64_tr_b16 v[112:113], v17 offset:18496
  s_add_u32 m0, s89, 0
  v_smfmac_f32_16x16x64_bf16 a[220:223], a[236:239], v[96:103], v95
  v_mfma_f32_32x32x16_bf16 v[192:207], v[104:107], v[64:67], v[192:207]
  buffer_load_dwordx4 v23, s[28:31], s64 offen  lds
  ds_read_b64_tr_b16 v[114:115], v17 offset:20032
  ds_read_b128 v[76:79], v9 offset:4096
  v_mfma_f32_32x32x16_bf16 v[208:223], v[96:99], v[68:71], v[208:223]
  ds_read_b64_tr_b16 v[116:117], v16 offset:18560
  ds_read_b64_tr_b16 v[118:119], v16 offset:20096
  s_add_u32 m0, s25, 0
  v_mfma_f32_16x16x32_bf16 a[228:231], v[104:107], a[232:235], a[228:231]
  v_mfma_f32_32x32x16_bf16 v[224:239], v[100:103], v[68:71], v[224:239]
  buffer_load_dwordx4 v29, s[32:35], s65 offen  lds
  v_mfma_f32_32x32x16_bf16 v[240:255], v[104:107], v[68:71], v[240:255]
  s_waitcnt lgkmcnt(0)
  v_mfma_f32_32x32x16_bf16 v[160:175], v[108:111], v[72:75], v[160:175]
  s_waitcnt vmcnt(16)
  s_barrier
  ds_read_b64_tr_b16 v[96:97], v18 offset:0
  ds_read_b64_tr_b16 v[98:99], v18 offset:1536
  ds_read_b128 v[64:67], v10 offset:0
  v_mfma_f32_32x32x16_bf16 v[176:191], v[112:115], v[72:75], v[176:191]
  ds_read_b64_tr_b16 v[100:101], v19 offset:64
  ds_read_b64_tr_b16 v[102:103], v19 offset:1600
  ds_read_b128 v[68:71], v10 offset:4096
  s_add_u32 m0, s76, 139264
  s_mul_i32 s17, s4, 40
  s_add_u32 s17, s17, 81920
  buffer_load_dwordx4 v48, s[40:43], s17 offen  lds
  v_smfmac_f32_16x16x64_bf16 a[220:223], a[236:239], v[108:115], v95
  v_mfma_f32_32x32x16_bf16 v[192:207], v[116:119], v[72:75], v[192:207]
  ds_read_b64_tr_b16 v[104:105], v18 offset:128
  ds_read_b64_tr_b16 v[106:107], v18 offset:1664
  buffer_load_dwordx4 v49, s[40:43], s17 offen offset:1024  lds
  v_mfma_f32_32x32x16_bf16 v[208:223], v[108:111], v[76:79], v[208:223]
  s_add_u32 m0, s76, 147456
  s_mul_i32 s17, s5, 40
  buffer_load_dwordx4 v48, s[40:43], s17 offen  lds
  v_mfma_f32_16x16x32_bf16 a[228:231], v[116:119], a[232:235], a[228:231]
  v_mfma_f32_32x32x16_bf16 v[224:239], v[112:115], v[76:79], v[224:239]
  buffer_load_dwordx4 v49, s[40:43], s17 offen offset:1024  lds
  v_mfma_f32_32x32x16_bf16 v[240:255], v[116:119], v[76:79], v[240:255]
  s_waitcnt lgkmcnt(0)
  v_mfma_f32_32x32x16_bf16 v[160:175], v[96:99], v[64:67], v[160:175]
  ds_read_b64_tr_b16 v[108:109], v18 offset:6144
  ds_read_b64_tr_b16 v[110:111], v18 offset:7680
  buffer_load_dwordx2 v[60:61], v62, s[36:39], s54 offen sc1
  v_mfma_f32_32x32x16_bf16 v[176:191], v[100:103], v[64:67], v[176:191]
  ds_read_b128 v[72:75], v11 offset:0
  ds_read_b64_tr_b16 v[112:113], v19 offset:6208
  s_mov_b32 s75, 0
  buffer_load_dwordx4 a[240:243], v87, s[28:31], s75 offen
  v_smfmac_f32_16x16x64_bf16 a[220:223], a[236:239], v[96:103], v95
  v_mfma_f32_32x32x16_bf16 v[192:207], v[104:107], v[64:67], v[192:207]
  ds_read_b64_tr_b16 v[114:115], v19 offset:7744
  ds_read_b128 v[76:79], v11 offset:4096
  v_mfma_f32_32x32x16_bf16 v[208:223], v[96:99], v[68:71], v[208:223]
  ds_read_b64_tr_b16 v[116:117], v18 offset:6272
  ds_read_b64_tr_b16 v[118:119], v18 offset:7808
  s_mov_b32 s75, 20480
  buffer_load_dwordx4 a[244:247], v87, s[28:31], s75 offen
  v_mfma_f32_16x16x32_bf16 a[228:231], v[104:107], a[232:235], a[228:231]
  v_mfma_f32_32x32x16_bf16 v[224:239], v[100:103], v[68:71], v[224:239]
  s_mov_b32 s75, 40960
  buffer_load_dwordx4 a[248:251], v87, s[28:31], s75 offen
  v_mfma_f32_32x32x16_bf16 v[240:255], v[104:107], v[68:71], v[240:255]
  s_waitcnt lgkmcnt(0)
  v_mfma_f32_32x32x16_bf16 v[160:175], v[108:111], v[72:75], v[160:175]
  s_waitcnt vmcnt(4)
  s_barrier
  ds_read_b64_tr_b16 v[96:97], v18 offset:12288
  ds_read_b64_tr_b16 v[98:99], v18 offset:13824
  s_add_u32 m0, s76, 40960
  s_mul_i32 s17, s5, 40
  s_add_u32 s17, s17, 40960
  buffer_load_dwordx4 v48, s[40:43], s17 offen  lds
  v_mfma_f32_32x32x16_bf16 v[176:191], v[112:115], v[72:75], v[176:191]
  ds_read_b128 v[64:67], v12 offset:0
  ds_read_b64_tr_b16 v[100:101], v19 offset:12352
  buffer_load_dwordx4 v49, s[40:43], s17 offen offset:1024  lds
  v_lshlrev_b32 v136, 16, v136
  v_smfmac_f32_16x16x64_bf16 a[220:223], a[236:239], v[108:115], v95
  v_mfma_f32_32x32x16_bf16 v[192:207], v[116:119], v[72:75], v[192:207]
  ds_read_b64_tr_b16 v[102:103], v19 offset:13888
  ds_read_b128 v[68:71], v12 offset:4096
  v_lshlrev_b32 v137, 16, v137
  ds_write_b32 v80, v136 offset:512
  v_mfma_f32_32x32x16_bf16 v[208:223], v[108:111], v[76:79], v[208:223]
  ds_read_b64_tr_b16 v[104:105], v18 offset:12416
  ds_read_b64_tr_b16 v[106:107], v18 offset:13952
  s_add_u32 m0, s76, 49152
  s_mul_i32 s17, s5, 40
  s_add_u32 s17, s17, 81920
  buffer_load_dwordx4 v48, s[40:43], s17 offen  lds
  v_mfma_f32_16x16x32_bf16 a[228:231], v[116:119], a[232:235], a[228:231]
  v_mfma_f32_32x32x16_bf16 v[224:239], v[112:115], v[76:79], v[224:239]
  buffer_load_dwordx4 v49, s[40:43], s17 offen offset:1024  lds
  ds_write_b32 v81, v137 offset:768
  v_add_u32 v52, 0x18000, v52
  v_add_u32 v53, 0x18000, v53
  v_mfma_f32_32x32x16_bf16 v[240:255], v[116:119], v[76:79], v[240:255]
  v_add_u32 v54, 0x18000, v54
  v_add_u32 v55, 0x18000, v55
  ds_read_b64_tr_b16 a[0:1], v52 offset:24576
  ds_read_b64_tr_b16 a[2:3], v52 offset:26624
  s_waitcnt lgkmcnt(0)
  v_mfma_f32_32x32x16_bf16 v[160:175], v[96:99], v[64:67], v[160:175]
  ds_read_b64_tr_b16 v[108:109], v18 offset:18432
  ds_read_b64_tr_b16 v[110:111], v18 offset:19968
  s_add_u32 m0, s76, 57344
  s_mul_i32 s17, s6, 40
  buffer_load_dwordx4 v48, s[40:43], s17 offen  lds
  v_mfma_f32_32x32x16_bf16 v[176:191], v[100:103], v[64:67], v[176:191]
  ds_read_b128 v[72:75], v13 offset:0
  ds_read_b64_tr_b16 v[112:113], v19 offset:18496
  ds_read_b64_tr_b16 a[4:5], v53 offset:24576
  ds_read_b64_tr_b16 a[6:7], v53 offset:26624
  v_smfmac_f32_16x16x64_bf16 a[220:223], a[236:239], v[96:103], v95
  v_mfma_f32_32x32x16_bf16 v[192:207], v[104:107], v[64:67], v[192:207]
  ds_read_b64_tr_b16 v[114:115], v19 offset:20032
  ds_read_b128 v[76:79], v13 offset:4096
  ds_read_b64_tr_b16 a[8:9], v54 offset:24576
  ds_read_b64_tr_b16 a[10:11], v54 offset:26624
  v_mfma_f32_32x32x16_bf16 v[208:223], v[96:99], v[68:71], v[208:223]
  ds_read_b64_tr_b16 v[116:117], v18 offset:18560
  ds_read_b64_tr_b16 v[118:119], v18 offset:20096
  buffer_load_dwordx4 v49, s[40:43], s17 offen offset:1024  lds
  ds_read_b64_tr_b16 a[12:13], v55 offset:24576
  v_mfma_f32_16x16x32_bf16 a[228:231], v[104:107], a[232:235], a[228:231]
  v_mfma_f32_32x32x16_bf16 v[224:239], v[100:103], v[68:71], v[224:239]
  ds_read_b64_tr_b16 a[14:15], v55 offset:26624
  ds_read_b64_tr_b16 a[16:17], v52 offset:32768
  ds_read_b64_tr_b16 a[18:19], v52 offset:34816
  ds_read_b64_tr_b16 a[20:21], v53 offset:32768
  v_mfma_f32_32x32x16_bf16 v[240:255], v[104:107], v[68:71], v[240:255]
  ds_read_b64_tr_b16 a[22:23], v53 offset:34816
  ds_read_b64_tr_b16 a[24:25], v54 offset:32768
  ds_read_b64_tr_b16 a[26:27], v54 offset:34816
  ds_read_b64_tr_b16 a[28:29], v55 offset:32768
  s_waitcnt lgkmcnt(0)
  v_mfma_f32_32x32x16_bf16 v[160:175], v[108:111], v[72:75], v[160:175]
  s_waitcnt vmcnt(9)
  v_and_b32 v60, v60, v61
  v_cmp_gt_u32 vcc, s53, v60
  s_nop 0
  s_cmp_eq_u64 vcc, 0
  s_cbranch_scc0 Lslow_15
Lback_16:
  s_barrier
  ds_read_b64_tr_b16 v[96:97], v14 offset:0
  ds_read_b64_tr_b16 v[98:99], v14 offset:1536
  ds_read_b128 v[64:67], v2 offset:0
  v_mfma_f32_32x32x16_bf16 v[176:191], v[112:115], v[72:75], v[176:191]
  ds_read_b64_tr_b16 v[100:101], v15 offset:64
  ds_read_b64_tr_b16 v[102:103], v15 offset:1600
  ds_read_b128 v[68:71], v2 offset:4096
  buffer_load_dwordx2 v[32:33], v63, s[36:39], 0 offen offset:0 sc1
  v_smfmac_f32_16x16x64_bf16 a[220:223], a[236:239], v[108:115], v95
  v_mfma_f32_32x32x16_bf16 v[192:207], v[116:119], v[72:75], v[192:207]
  ds_read_b64_tr_b16 v[104:105], v14 offset:128
  ds_read_b64_tr_b16 v[106:107], v14 offset:1664
  ds_read_b64_tr_b16 a[30:31], v55 offset:34816
  ds_read_b64_tr_b16 a[32:33], v52 offset:40960
  v_mfma_f32_32x32x16_bf16 v[208:223], v[108:111], v[76:79], v[208:223]
  buffer_load_dwordx2 v[34:35], v63, s[36:39], 0 offen offset:256 sc1
  ds_read_b64_tr_b16 a[34:35], v52 offset:43008
  ds_read_b64_tr_b16 a[36:37], v53 offset:40960
  ds_read_b64_tr_b16 a[38:39], v53 offset:43008
  v_mfma_f32_16x16x32_bf16 a[228:231], v[116:119], a[232:235], a[228:231]
  v_mfma_f32_32x32x16_bf16 v[224:239], v[112:115], v[76:79], v[224:239]
  ds_read_b64_tr_b16 a[40:41], v54 offset:40960
  ds_read_b64_tr_b16 a[42:43], v54 offset:43008
  ds_read_b64_tr_b16 a[44:45], v55 offset:40960
  ds_read_b64_tr_b16 a[46:47], v55 offset:43008
  v_mfma_f32_32x32x16_bf16 v[240:255], v[116:119], v[76:79], v[240:255]
  ds_read_b64_tr_b16 a[48:49], v52 offset:49152
  ds_read_b64_tr_b16 a[50:51], v52 offset:51200
  ds_read_b64_tr_b16 a[52:53], v53 offset:49152
  ds_read_b64_tr_b16 a[54:55], v53 offset:51200
  s_waitcnt lgkmcnt(0)
  v_mfma_f32_32x32x16_bf16 v[160:175], v[96:99], v[64:67], v[160:175]
  ds_read_b64_tr_b16 v[108:109], v14 offset:6144
  ds_read_b64_tr_b16 v[110:111], v14 offset:7680
  s_add_u32 m0, s76, 65536
  s_mul_i32 s17, s6, 40
  s_add_u32 s17, s17, 40960
  buffer_load_dwordx4 v48, s[40:43], s17 offen  lds
  v_mfma_f32_32x32x16_bf16 v[176:191], v[100:103], v[64:67], v[176:191]
  ds_read_b128 v[72:75], v3 offset:0
  ds_read_b64_tr_b16 v[112:113], v15 offset:6208
  ds_read_b64_tr_b16 a[56:57], v54 offset:49152
  ds_read_b64_tr_b16 a[58:59], v54 offset:51200
  v_smfmac_f32_16x16x64_bf16 a[220:223], a[236:239], v[96:103], v95
  v_mfma_f32_32x32x16_bf16 v[192:207], v[104:107], v[64:67], v[192:207]
  ds_read_b64_tr_b16 v[114:115], v15 offset:7744
  ds_read_b128 v[76:79], v3 offset:4096
  ds_read_b64_tr_b16 a[60:61], v55 offset:49152
  ds_read_b64_tr_b16 a[62:63], v55 offset:51200
  v_mfma_f32_32x32x16_bf16 v[208:223], v[96:99], v[68:71], v[208:223]
  ds_read_b64_tr_b16 v[116:117], v14 offset:6272
  ds_read_b64_tr_b16 v[118:119], v14 offset:7808
  buffer_load_dwordx4 v49, s[40:43], s17 offen offset:1024  lds
  v_mfma_f32_16x16x32_bf16 a[228:231], v[104:107], a[232:235], a[228:231]
  v_mfma_f32_32x32x16_bf16 v[224:239], v[100:103], v[68:71], v[224:239]
  v_mfma_f32_32x32x16_bf16 v[240:255], v[104:107], v[68:71], v[240:255]
  s_waitcnt lgkmcnt(0)
  v_mfma_f32_32x32x16_bf16 v[160:175], v[108:111], v[72:75], v[160:175]
  s_waitcnt vmcnt(4)
  s_barrier
  ds_read_b64_tr_b16 v[96:97], v14 offset:12288
  ds_read_b64_tr_b16 v[98:99], v14 offset:13824
  s_add_u32 m0, s76, 73728
  s_mul_i32 s17, s6, 40
  s_add_u32 s17, s17, 81920
  buffer_load_dwordx4 v48, s[40:43], s17 offen  lds
  v_mfma_f32_32x32x16_bf16 v[176:191], v[112:115], v[72:75], v[176:191]
  ds_read_b128 v[64:67], v4 offset:0
  ds_read_b64_tr_b16 v[100:101], v15 offset:12352
  ds_read_b128 v[144:147], v82 offset:512
  ds_read_b128 v[148:151], v82 offset:544
  ds_read_b128 v[152:155], v82 offset:576
  v_smfmac_f32_16x16x64_bf16 a[220:223], a[236:239], v[108:115], v95
  v_mfma_f32_32x32x16_bf16 v[192:207], v[116:119], v[72:75], v[192:207]
  ds_read_b64_tr_b16 v[102:103], v15 offset:13888
  ds_read_b128 v[68:71], v4 offset:4096
  ds_read_b128 v[156:159], v82 offset:608
  v_add_u32 v52, 0xfffe8000, v52
  v_add_u32 v53, 0xfffe8000, v53
  v_mfma_f32_32x32x16_bf16 v[208:223], v[108:111], v[76:79], v[208:223]
  ds_read_b64_tr_b16 v[104:105], v14 offset:12416
  ds_read_b64_tr_b16 v[106:107], v14 offset:13952
  buffer_load_dwordx4 v49, s[40:43], s17 offen offset:1024  lds
  v_add_u32 v54, 0xfffe8000, v54
  v_add_u32 v55, 0xfffe8000, v55
  v_mfma_f32_16x16x32_bf16 a[228:231], v[116:119], a[232:235], a[228:231]
  v_mfma_f32_32x32x16_bf16 v[224:239], v[112:115], v[76:79], v[224:239]
  ds_read_b64_tr_b16 a[64:65], v52 offset:40960
  ds_read_b64_tr_b16 a[66:67], v52 offset:43008
  ds_read_b64_tr_b16 a[68:69], v53 offset:40960
  ds_read_b64_tr_b16 a[70:71], v53 offset:43008
  ds_read_b64_tr_b16 a[72:73], v54 offset:40960
  v_mfma_f32_32x32x16_bf16 v[240:255], v[116:119], v[76:79], v[240:255]
  ds_read_b64_tr_b16 a[74:75], v54 offset:43008
  ds_read_b64_tr_b16 a[76:77], v55 offset:40960
  ds_read_b64_tr_b16 a[78:79], v55 offset:43008
  ds_read_b64_tr_b16 a[80:81], v52 offset:49152
  ds_read_b64_tr_b16 a[82:83], v52 offset:51200
  s_waitcnt lgkmcnt(0)
  v_mfma_f32_32x32x16_bf16 v[160:175], v[96:99], v[64:67], v[160:175]
  ds_read_b64_tr_b16 v[108:109], v14 offset:18432
  ds_read_b64_tr_b16 v[110:111], v14 offset:19968
  s_add_u32 m0, s76, 81920
  s_mul_i32 s17, s7, 40
  buffer_load_dwordx4 v48, s[40:43], s17 offen  lds
  v_mfma_f32_32x32x16_bf16 v[176:191], v[100:103], v[64:67], v[176:191]
  ds_read_b128 v[72:75], v5 offset:0
  ds_read_b64_tr_b16 v[112:113], v15 offset:18496
  ds_read_b64_tr_b16 a[84:85], v53 offset:49152
  ds_read_b64_tr_b16 a[86:87], v53 offset:51200
  ds_read_b64_tr_b16 a[88:89], v54 offset:49152
  v_smfmac_f32_16x16x64_bf16 a[220:223], a[236:239], v[96:103], v95
  v_mfma_f32_32x32x16_bf16 v[192:207], v[104:107], v[64:67], v[192:207]
  ds_read_b64_tr_b16 v[114:115], v15 offset:20032
  ds_read_b128 v[76:79], v5 offset:4096
  ds_read_b64_tr_b16 a[90:91], v54 offset:51200
  ds_read_b64_tr_b16 a[92:93], v55 offset:49152
  ds_read_b64_tr_b16 a[94:95], v55 offset:51200
  v_mfma_f32_32x32x16_bf16 v[208:223], v[96:99], v[68:71], v[208:223]
  ds_read_b64_tr_b16 v[116:117], v14 offset:18560
  ds_read_b64_tr_b16 v[118:119], v14 offset:20096
  buffer_load_dwordx4 v49, s[40:43], s17 offen offset:1024  lds
  ds_read_b64_tr_b16 a[96:97], v52 offset:57344
  ds_read_b64_tr_b16 a[98:99], v52 offset:59392
  v_mfma_f32_16x16x32_bf16 a[228:231], v[104:107], a[232:235], a[228:231]
  v_mfma_f32_32x32x16_bf16 v[224:239], v[100:103], v[68:71], v[224:239]
  ds_read_b64_tr_b16 a[100:101], v53 offset:57344
  ds_read_b64_tr_b16 a[102:103], v53 offset:59392
  ds_read_b64_tr_b16 a[104:105], v54 offset:57344
  ds_read_b64_tr_b16 a[106:107], v54 offset:59392
  ds_read_b64_tr_b16 a[108:109], v55 offset:57344
  v_mfma_f32_32x32x16_bf16 v[240:255], v[104:107], v[68:71], v[240:255]
  ds_read_b64_tr_b16 a[110:111], v55 offset:59392
  s_waitcnt lgkmcnt(0)
  v_mfma_f32_32x32x16_bf16 v[160:175], v[108:111], v[72:75], v[160:175]
  s_barrier
  v_smfmac_f32_16x16x64_bf16 a[220:223], a[236:239], v[108:115], v95
  v_mfma_f32_32x32x16_bf16 v[176:191], v[112:115], v[72:75], v[176:191]
  v_mfma_f32_16x16x32_bf16 a[228:231], v[116:119], a[232:235], a[228:231]
  v_mfma_f32_32x32x16_bf16 v[192:207], v[116:119], v[72:75], v[192:207]
  s_nop 4
  v_accvgpr_read_b32 v36, a220
  v_accvgpr_read_b32 v37, a221
  v_accvgpr_read_b32 v38, a222
  v_accvgpr_read_b32 v39, a223
  v_mfma_f32_32x32x16_bf16 v[208:223], v[108:111], v[76:79], v[208:223]
  v_add_f32 v36, v36, v37
  v_add_f32 v38, v38, v39
  v_mfma_f32_32x32x16_bf16 v[224:239], v[112:115], v[76:79], v[224:239]
  ds_write2_b32 v120, v36, v38 offset0:0 offset1:16
  ds_write_b128 v83, a[228:231] offset:256
  v_mfma_f32_32x32x16_bf16 v[240:255], v[116:119], v[76:79], v[240:255]
  ds_read_b128 v[128:131], v82 offset:0
  ds_read_b128 v[132:135], v82 offset:32
  ds_read_b128 v[136:139], v82 offset:64
  ds_read_b128 v[140:143], v82 offset:96
  s_waitcnt lgkmcnt(0)
LHpost:
  s_waitcnt vmcnt(6)
  v_mov_b32 v2, s86
  v_mov_b32 v3, s86
  v_mov_b32 v92, 2
  v_mov_b32 v93, 3
  v_accvgpr_read_b32 v124, a201
  ds_read_b128 v[96:99], v82 offset:128
  ds_read_b128 v[100:103], v82 offset:160
  ds_read_b128 v[104:107], v82 offset:192
  ds_read_b128 v[108:111], v82 offset:224
  ds_read_b128 v[4:7], v82 offset:640
  ds_read_b128 v[8:11], v82 offset:672
  ds_read_b128 v[12:15], v82 offset:704
  ds_read_b128 v[16:19], v82 offset:736
  s_add_u32 m0, s76, 90112
  s_mul_i32 s17, s7, 40
  s_add_u32 s17, s17, 40960
  buffer_load_dwordx4 v48, s[40:43], s17 offen  lds
  buffer_load_dwordx4 v49, s[40:43], s17 offen offset:1024  lds
  s_add_u32 m0, s76, 98304
  s_mul_i32 s17, s7, 40
  s_add_u32 s17, s17, 81920
  buffer_load_dwordx4 v48, s[40:43], s17 offen  lds
  buffer_load_dwordx4 v49, s[40:43], s17 offen offset:1024  lds
  s_add_u32 m0, s76, 106496
  s_mul_i32 s17, s8, 40
  s_nop 0
  buffer_load_dwordx4 v48, s[40:43], s17 offen  lds
  buffer_load_dwordx4 v49, s[40:43], s17 offen offset:1024  lds
  v_pk_fma_f32 v[64:65], v[128:129], v[32:33], v[144:145] op_sel:[0,1,0] op_sel_hi:[1,1,1] neg_lo:[1,0,0] neg_hi:[1,0,0]
  v_pk_fma_f32 v[66:67], v[130:131], v[32:33], v[146:147] op_sel:[0,1,0] op_sel_hi:[1,1,1] neg_lo:[1,0,0] neg_hi:[1,0,0]
  v_pk_fma_f32 v[68:69], v[132:133], v[32:33], v[148:149] op_sel:[0,1,0] op_sel_hi:[1,1,1] neg_lo:[1,0,0] neg_hi:[1,0,0]
  v_pk_fma_f32 v[70:71], v[134:135], v[32:33], v[150:151] op_sel:[0,1,0] op_sel_hi:[1,1,1] neg_lo:[1,0,0] neg_hi:[1,0,0]
  v_pk_fma_f32 v[72:73], v[136:137], v[32:33], v[152:153] op_sel:[0,1,0] op_sel_hi:[1,1,1] neg_lo:[1,0,0] neg_hi:[1,0,0]
  v_pk_fma_f32 v[74:75], v[138:139], v[32:33], v[154:155] op_sel:[0,1,0] op_sel_hi:[1,1,1] neg_lo:[1,0,0] neg_hi:[1,0,0]
  v_pk_fma_f32 v[76:77], v[140:141], v[32:33], v[156:157] op_sel:[0,1,0] op_sel_hi:[1,1,1] neg_lo:[1,0,0] neg_hi:[1,0,0]
  v_pk_fma_f32 v[78:79], v[142:143], v[32:33], v[158:159] op_sel:[0,1,0] op_sel_hi:[1,1,1] neg_lo:[1,0,0] neg_hi:[1,0,0]
  v_pk_fma_f32 v[160:161], v[160:161], v[32:33], v[64:65] op_sel:[0,0,0] op_sel_hi:[1,0,1]
  v_pk_fma_f32 v[162:163], v[162:163], v[32:33], v[66:67] op_sel:[0,0,0] op_sel_hi:[1,0,1]
  v_pk_fma_f32 v[164:165], v[164:165], v[32:33], v[68:69] op_sel:[0,0,0] op_sel_hi:[1,0,1]
  v_pk_fma_f32 v[166:167], v[166:167], v[32:33], v[70:71] op_sel:[0,0,0] op_sel_hi:[1,0,1]
  v_pk_fma_f32 v[168:169], v[168:169], v[32:33], v[72:73] op_sel:[0,0,0] op_sel_hi:[1,0,1]
  v_pk_fma_f32 v[170:171], v[170:171], v[32:33], v[74:75] op_sel:[0,0,0] op_sel_hi:[1,0,1]
  v_pk_fma_f32 v[172:173], v[172:173], v[32:33], v[76:77] op_sel:[0,0,0] op_sel_hi:[1,0,1]
  v_pk_fma_f32 v[174:175], v[174:175], v[32:33], v[78:79] op_sel:[0,0,0] op_sel_hi:[1,0,1]
  v_pk_mul_f32 v[64:65], v[160:161], v[160:161]
  v_pk_mul_f32 v[66:67], v[162:163], v[162:163]
  v_pk_mul_f32 v[68:69], v[164:165], v[164:165]
  v_pk_mul_f32 v[70:71], v[166:167], v[166:167]
  v_pk_mul_f32 v[72:73], v[168:169], v[168:169]
  v_pk_mul_f32 v[74:75], v[170:171], v[170:171]
  v_pk_mul_f32 v[76:77], v[172:173], v[172:173]
  v_pk_mul_f32 v[78:79], v[174:175], v[174:175]
  v_pk_fma_f32 v[64:65], v[64:65], s[88:89], v[2:3] op_sel_hi:[1,0,1]
  v_pk_fma_f32 v[66:67], v[66:67], s[88:89], v[2:3] op_sel_hi:[1,0,1]
  v_pk_fma_f32 v[68:69], v[68:69], s[88:89], v[2:3] op_sel_hi:[1,0,1]
  v_pk_fma_f32 v[70:71], v[70:71], s[88:89], v[2:3] op_sel_hi:[1,0,1]
  v_pk_fma_f32 v[72:73], v[72:73], s[88:89], v[2:3] op_sel_hi:[1,0,1]
  v_pk_fma_f32 v[74:75], v[74:75], s[88:89], v[2:3] op_sel_hi:[1,0,1]
  v_pk_fma_f32 v[76:77], v[76:77], s[88:89], v[2:3] op_sel_hi:[1,0,1]
  v_pk_fma_f32 v[78:79], v[78:79], s[88:89], v[2:3] op_sel_hi:[1,0,1]
  v_pk_mul_f32 v[64:65], v[64:65], v[160:161]
  v_pk_mul_f32 v[66:67], v[66:67], v[162:163]
  v_pk_mul_f32 v[68:69], v[68:69], v[164:165]
  v_pk_mul_f32 v[70:71], v[70:71], v[166:167]
  v_pk_mul_f32 v[72:73], v[72:73], v[168:169]
  v_pk_mul_f32 v[74:75], v[74:75], v[170:171]
  v_pk_mul_f32 v[76:77], v[76:77], v[172:173]
  v_pk_mul_f32 v[78:79], v[78:79], v[174:175]
  s_add_u32 m0, s76, 114688
  s_mul_i32 s17, s8, 40
  s_add_u32 s17, s17, 40960
  buffer_load_dwordx4 v48, s[40:43], s17 offen  lds
  buffer_load_dwordx4 v49, s[40:43], s17 offen offset:1024  lds
  s_add_u32 m0, s76, 24576
  s_mul_i32 s17, s8, 40
  s_add_u32 s17, s17, 81920
  buffer_load_dwordx4 v48, s[40:43], s17 offen  lds
  buffer_load_dwordx4 v49, s[40:43], s17 offen offset:1024  lds
  v_exp_f32 v64, v64
  v_exp_f32 v65, v65
  v_exp_f32 v66, v66
  v_exp_f32 v67, v67
  v_exp_f32 v68, v68
  v_exp_f32 v69, v69
  v_exp_f32 v70, v70
  v_exp_f32 v71, v71
  v_exp_f32 v72, v72
  v_exp_f32 v73, v73
  v_exp_f32 v74, v74
  v_exp_f32 v75, v75
  v_exp_f32 v76, v76
  v_exp_f32 v77, v77
  v_exp_f32 v78, v78
  v_exp_f32 v79, v79
  v_pk_add_f32 v[64:65], v[64:65], s[90:91] op_sel_hi:[1,0]
  v_pk_add_f32 v[66:67], v[66:67], s[90:91] op_sel_hi:[1,0]
  v_pk_add_f32 v[68:69], v[68:69], s[90:91] op_sel_hi:[1,0]
  v_pk_add_f32 v[70:71], v[70:71], s[90:91] op_sel_hi:[1,0]
  v_pk_add_f32 v[72:73], v[72:73], s[90:91] op_sel_hi:[1,0]
  v_pk_add_f32 v[74:75], v[74:75], s[90:91] op_sel_hi:[1,0]
  v_pk_add_f32 v[76:77], v[76:77], s[90:91] op_sel_hi:[1,0]
  v_pk_add_f32 v[78:79], v[78:79], s[90:91] op_sel_hi:[1,0]
  v_rcp_f32 v64, v64
  v_rcp_f32 v65, v65
  v_rcp_f32 v66, v66
  v_rcp_f32 v67, v67
  v_rcp_f32 v68, v68
  v_rcp_f32 v69, v69
  v_rcp_f32 v70, v70
  v_rcp_f32 v71, v71
  v_rcp_f32 v72, v72
  v_rcp_f32 v73, v73
  v_rcp_f32 v74, v74
  v_rcp_f32 v75, v75
  v_rcp_f32 v76, v76
  v_rcp_f32 v77, v77
  v_rcp_f32 v78, v78
  v_rcp_f32 v79, v79
  v_pk_mul_f32 v[160:161], v[160:161], v[64:65]
  v_pk_mul_f32 v[162:163], v[162:163], v[66:67]
  v_pk_mul_f32 v[164:165], v[164:165], v[68:69]
  v_pk_mul_f32 v[166:167], v[166:167], v[70:71]
  v_pk_mul_f32 v[168:169], v[168:169], v[72:73]
  v_pk_mul_f32 v[170:171], v[170:171], v[74:75]
  v_pk_mul_f32 v[172:173], v[172:173], v[76:77]
  v_pk_mul_f32 v[174:175], v[174:175], v[78:79]
  v_cvt_pk_bf16_f32 v160, v160, v161
  v_cvt_pk_bf16_f32 v161, v162, v163
  v_cvt_pk_bf16_f32 v162, v164, v165
  v_cvt_pk_bf16_f32 v163, v166, v167
  v_cvt_pk_bf16_f32 v164, v168, v169
  v_cvt_pk_bf16_f32 v165, v170, v171
  v_cvt_pk_bf16_f32 v166, v172, v173
  v_cvt_pk_bf16_f32 v167, v174, v175
  buffer_store_dwordx4 v[160:163], v90, s[36:39], 0 offen offset:0 sc1
  buffer_store_dwordx4 v[164:167], v90, s[36:39], 0 offen offset:512 sc1
  s_add_u32 m0, s76, 32768
  s_mul_i32 s17, s9, 40
  buffer_load_dwordx4 v48, s[40:43], s17 offen  lds
  buffer_load_dwordx4 v49, s[40:43], s17 offen offset:1024  lds
  s_add_u32 m0, s76, 0
  s_mul_i32 s17, s9, 40
  s_nop 0
  s_add_u32 s17, s17, 40960
  buffer_load_dwordx4 v48, s[40:43], s17 offen  lds
  buffer_load_dwordx4 v49, s[40:43], s17 offen offset:1024  lds
  v_pk_fma_f32 v[64:65], v[128:129], v[34:35], v[144:145] op_sel:[0,1,0] op_sel_hi:[1,1,1] neg_lo:[1,0,0] neg_hi:[1,0,0]
  v_pk_fma_f32 v[66:67], v[130:131], v[34:35], v[146:147] op_sel:[0,1,0] op_sel_hi:[1,1,1] neg_lo:[1,0,0] neg_hi:[1,0,0]
  v_pk_fma_f32 v[68:69], v[132:133], v[34:35], v[148:149] op_sel:[0,1,0] op_sel_hi:[1,1,1] neg_lo:[1,0,0] neg_hi:[1,0,0]
  v_pk_fma_f32 v[70:71], v[134:135], v[34:35], v[150:151] op_sel:[0,1,0] op_sel_hi:[1,1,1] neg_lo:[1,0,0] neg_hi:[1,0,0]
  v_pk_fma_f32 v[72:73], v[136:137], v[34:35], v[152:153] op_sel:[0,1,0] op_sel_hi:[1,1,1] neg_lo:[1,0,0] neg_hi:[1,0,0]
  v_pk_fma_f32 v[74:75], v[138:139], v[34:35], v[154:155] op_sel:[0,1,0] op_sel_hi:[1,1,1] neg_lo:[1,0,0] neg_hi:[1,0,0]
  v_pk_fma_f32 v[76:77], v[140:141], v[34:35], v[156:157] op_sel:[0,1,0] op_sel_hi:[1,1,1] neg_lo:[1,0,0] neg_hi:[1,0,0]
  v_pk_fma_f32 v[78:79], v[142:143], v[34:35], v[158:159] op_sel:[0,1,0] op_sel_hi:[1,1,1] neg_lo:[1,0,0] neg_hi:[1,0,0]
  v_pk_fma_f32 v[208:209], v[208:209], v[34:35], v[64:65] op_sel:[0,0,0] op_sel_hi:[1,0,1]
  v_pk_fma_f32 v[210:211], v[210:211], v[34:35], v[66:67] op_sel:[0,0,0] op_sel_hi:[1,0,1]
  v_pk_fma_f32 v[212:213], v[212:213], v[34:35], v[68:69] op_sel:[0,0,0] op_sel_hi:[1,0,1]
  v_pk_fma_f32 v[214:215], v[214:215], v[34:35], v[70:71] op_sel:[0,0,0] op_sel_hi:[1,0,1]
  v_pk_fma_f32 v[216:217], v[216:217], v[34:35], v[72:73] op_sel:[0,0,0] op_sel_hi:[1,0,1]
  v_pk_fma_f32 v[218:219], v[218:219], v[34:35], v[74:75] op_sel:[0,0,0] op_sel_hi:[1,0,1]
  v_pk_fma_f32 v[220:221], v[220:221], v[34:35], v[76:77] op_sel:[0,0,0] op_sel_hi:[1,0,1]
  v_pk_fma_f32 v[222:223], v[222:223], v[34:35], v[78:79] op_sel:[0,0,0] op_sel_hi:[1,0,1]
  v_pk_mul_f32 v[64:65], v[208:209], v[208:209]
  v_pk_mul_f32 v[66:67], v[210:211], v[210:211]
  v_pk_mul_f32 v[68:69], v[212:213], v[212:213]
  v_pk_mul_f32 v[70:71], v[214:215], v[214:215]
  v_pk_mul_f32 v[72:73], v[216:217], v[216:217]
  v_pk_mul_f32 v[74:75], v[218:219], v[218:219]
  v_pk_mul_f32 v[76:77], v[220:221], v[220:221]
  v_pk_mul_f32 v[78:79], v[222:223], v[222:223]
  v_pk_fma_f32 v[64:65], v[64:65], s[88:89], v[2:3] op_sel_hi:[1,0,1]
  v_pk_fma_f32 v[66:67], v[66:67], s[88:89], v[2:3] op_sel_hi:[1,0,1]
  v_pk_fma_f32 v[68:69], v[68:69], s[88:89], v[2:3] op_sel_hi:[1,0,1]
  v_pk_fma_f32 v[70:71], v[70:71], s[88:89], v[2:3] op_sel_hi:[1,0,1]
  v_pk_fma_f32 v[72:73], v[72:73], s[88:89], v[2:3] op_sel_hi:[1,0,1]
  v_pk_fma_f32 v[74:75], v[74:75], s[88:89], v[2:3] op_sel_hi:[1,0,1]
  v_pk_fma_f32 v[76:77], v[76:77], s[88:89], v[2:3] op_sel_hi:[1,0,1]
  v_pk_fma_f32 v[78:79], v[78:79], s[88:89], v[2:3] op_sel_hi:[1,0,1]
  v_pk_mul_f32 v[64:65], v[64:65], v[208:209]
  v_pk_mul_f32 v[66:67], v[66:67], v[210:211]
  v_pk_mul_f32 v[68:69], v[68:69], v[212:213]
  v_pk_mul_f32 v[70:71], v[70:71], v[214:215]
  v_pk_mul_f32 v[72:73], v[72:73], v[216:217]
  v_pk_mul_f32 v[74:75], v[74:75], v[218:219]
  v_pk_mul_f32 v[76:77], v[76:77], v[220:221]
  v_pk_mul_f32 v[78:79], v[78:79], v[222:223]
  s_add_u32 m0, s76, 8192
  s_mul_i32 s17, s9, 40
  s_add_u32 s17, s17, 81920
  buffer_load_dwordx4 v48, s[40:43], s17 offen  lds
  buffer_load_dwordx4 v49, s[40:43], s17 offen offset:1024  lds
  s_add_u32 m0, s76, 16384
  s_mul_i32 s17, s20, 40
  buffer_load_dwordx4 v48, s[40:43], s17 offen  lds
  buffer_load_dwordx4 v49, s[40:43], s17 offen offset:1024  lds
  v_exp_f32 v64, v64
  v_exp_f32 v65, v65
  v_exp_f32 v66, v66
  v_exp_f32 v67, v67
  v_exp_f32 v68, v68
  v_exp_f32 v69, v69
  v_exp_f32 v70, v70
  v_exp_f32 v71, v71
  v_exp_f32 v72, v72
  v_exp_f32 v73, v73
  v_exp_f32 v74, v74
  v_exp_f32 v75, v75
  v_exp_f32 v76, v76
  v_exp_f32 v77, v77
  v_exp_f32 v78, v78
  v_exp_f32 v79, v79
  v_pk_add_f32 v[64:65], v[64:65], s[90:91] op_sel_hi:[1,0]
  v_pk_add_f32 v[66:67], v[66:67], s[90:91] op_sel_hi:[1,0]
  v_pk_add_f32 v[68:69], v[68:69], s[90:91] op_sel_hi:[1,0]
  v_pk_add_f32 v[70:71], v[70:71], s[90:91] op_sel_hi:[1,0]
  v_pk_add_f32 v[72:73], v[72:73], s[90:91] op_sel_hi:[1,0]
  v_pk_add_f32 v[74:75], v[74:75], s[90:91] op_sel_hi:[1,0]
  v_pk_add_f32 v[76:77], v[76:77], s[90:91] op_sel_hi:[1,0]
  v_pk_add_f32 v[78:79], v[78:79], s[90:91] op_sel_hi:[1,0]
  v_rcp_f32 v64, v64
  v_rcp_f32 v65, v65
  v_rcp_f32 v66, v66
  v_rcp_f32 v67, v67
  v_rcp_f32 v68, v68
  v_rcp_f32 v69, v69
  v_rcp_f32 v70, v70
  v_rcp_f32 v71, v71
  v_rcp_f32 v72, v72
  v_rcp_f32 v73, v73
  v_rcp_f32 v74, v74
  v_rcp_f32 v75, v75
  v_rcp_f32 v76, v76
  v_rcp_f32 v77, v77
  v_rcp_f32 v78, v78
  v_rcp_f32 v79, v79
  v_pk_mul_f32 v[208:209], v[208:209], v[64:65]
  v_pk_mul_f32 v[210:211], v[210:211], v[66:67]
  v_pk_mul_f32 v[212:213], v[212:213], v[68:69]
  v_pk_mul_f32 v[214:215], v[214:215], v[70:71]
  v_pk_mul_f32 v[216:217], v[216:217], v[72:73]
  v_pk_mul_f32 v[218:219], v[218:219], v[74:75]
  v_pk_mul_f32 v[220:221], v[220:221], v[76:77]
  v_pk_mul_f32 v[222:223], v[222:223], v[78:79]
  v_cvt_pk_bf16_f32 v208, v208, v209
  v_cvt_pk_bf16_f32 v209, v210, v211
  v_cvt_pk_bf16_f32 v210, v212, v213
  v_cvt_pk_bf16_f32 v211, v214, v215
  v_cvt_pk_bf16_f32 v212, v216, v217
  v_cvt_pk_bf16_f32 v213, v218, v219
  v_cvt_pk_bf16_f32 v214, v220, v221
  v_cvt_pk_bf16_f32 v215, v222, v223
  buffer_store_dwordx4 v[208:211], v91, s[36:39], 0 offen offset:0 sc1
  buffer_store_dwordx4 v[212:215], v91, s[36:39], 0 offen offset:512 sc1
  ds_read_b128 v[128:131], v82 offset:256
  ds_read_b128 v[132:135], v82 offset:288
  ds_read_b128 v[136:139], v82 offset:320
  ds_read_b128 v[140:143], v82 offset:352
  ds_read_b128 v[144:147], v82 offset:768
  ds_read_b128 v[148:151], v82 offset:800
  ds_read_b128 v[152:155], v82 offset:832
  ds_read_b128 v[156:159], v82 offset:864
  s_waitcnt lgkmcnt(0)
  s_add_u32 m0, s76, 40960
  s_mul_i32 s17, s20, 40
  s_add_u32 s17, s17, 40960
  buffer_load_dwordx4 v48, s[40:43], s17 offen  lds
  buffer_load_dwordx4 v49, s[40:43], s17 offen offset:1024  lds
  s_add_u32 m0, s76, 49152
  s_mul_i32 s17, s20, 40
  s_nop 0
  s_add_u32 s17, s17, 81920
  buffer_load_dwordx4 v48, s[40:43], s17 offen  lds
  buffer_load_dwordx4 v49, s[40:43], s17 offen offset:1024  lds
  v_pk_fma_f32 v[64:65], v[96:97], v[32:33], v[4:5] op_sel:[0,1,0] op_sel_hi:[1,1,1] neg_lo:[1,0,0] neg_hi:[1,0,0]
  v_pk_fma_f32 v[66:67], v[98:99], v[32:33], v[6:7] op_sel:[0,1,0] op_sel_hi:[1,1,1] neg_lo:[1,0,0] neg_hi:[1,0,0]
  v_pk_fma_f32 v[68:69], v[100:101], v[32:33], v[8:9] op_sel:[0,1,0] op_sel_hi:[1,1,1] neg_lo:[1,0,0] neg_hi:[1,0,0]
  v_pk_fma_f32 v[70:71], v[102:103], v[32:33], v[10:11] op_sel:[0,1,0] op_sel_hi:[1,1,1] neg_lo:[1,0,0] neg_hi:[1,0,0]
  v_pk_fma_f32 v[72:73], v[104:105], v[32:33], v[12:13] op_sel:[0,1,0] op_sel_hi:[1,1,1] neg_lo:[1,0,0] neg_hi:[1,0,0]
  v_pk_fma_f32 v[74:75], v[106:107], v[32:33], v[14:15] op_sel:[0,1,0] op_sel_hi:[1,1,1] neg_lo:[1,0,0] neg_hi:[1,0,0]
  v_pk_fma_f32 v[76:77], v[108:109], v[32:33], v[16:17] op_sel:[0,1,0] op_sel_hi:[1,1,1] neg_lo:[1,0,0] neg_hi:[1,0,0]
  v_pk_fma_f32 v[78:79], v[110:111], v[32:33], v[18:19] op_sel:[0,1,0] op_sel_hi:[1,1,1] neg_lo:[1,0,0] neg_hi:[1,0,0]
  v_pk_fma_f32 v[176:177], v[176:177], v[32:33], v[64:65] op_sel:[0,0,0] op_sel_hi:[1,0,1]
  v_pk_fma_f32 v[178:179], v[178:179], v[32:33], v[66:67] op_sel:[0,0,0] op_sel_hi:[1,0,1]
  v_pk_fma_f32 v[180:181], v[180:181], v[32:33], v[68:69] op_sel:[0,0,0] op_sel_hi:[1,0,1]
  v_pk_fma_f32 v[182:183], v[182:183], v[32:33], v[70:71] op_sel:[0,0,0] op_sel_hi:[1,0,1]
  v_pk_fma_f32 v[184:185], v[184:185], v[32:33], v[72:73] op_sel:[0,0,0] op_sel_hi:[1,0,1]
  v_pk_fma_f32 v[186:187], v[186:187], v[32:33], v[74:75] op_sel:[0,0,0] op_sel_hi:[1,0,1]
  v_pk_fma_f32 v[188:189], v[188:189], v[32:33], v[76:77] op_sel:[0,0,0] op_sel_hi:[1,0,1]
  v_pk_fma_f32 v[190:191], v[190:191], v[32:33], v[78:79] op_sel:[0,0,0] op_sel_hi:[1,0,1]
  v_pk_mul_f32 v[64:65], v[176:177], v[176:177]
  v_pk_mul_f32 v[66:67], v[178:179], v[178:179]
  v_pk_mul_f32 v[68:69], v[180:181], v[180:181]
  v_pk_mul_f32 v[70:71], v[182:183], v[182:183]
  v_pk_mul_f32 v[72:73], v[184:185], v[184:185]
  v_pk_mul_f32 v[74:75], v[186:187], v[186:187]
  v_pk_mul_f32 v[76:77], v[188:189], v[188:189]
  v_pk_mul_f32 v[78:79], v[190:191], v[190:191]
  v_pk_fma_f32 v[64:65], v[64:65], s[88:89], v[2:3] op_sel_hi:[1,0,1]
  v_pk_fma_f32 v[66:67], v[66:67], s[88:89], v[2:3] op_sel_hi:[1,0,1]
  v_pk_fma_f32 v[68:69], v[68:69], s[88:89], v[2:3] op_sel_hi:[1,0,1]
  v_pk_fma_f32 v[70:71], v[70:71], s[88:89], v[2:3] op_sel_hi:[1,0,1]
  v_pk_fma_f32 v[72:73], v[72:73], s[88:89], v[2:3] op_sel_hi:[1,0,1]
  v_pk_fma_f32 v[74:75], v[74:75], s[88:89], v[2:3] op_sel_hi:[1,0,1]
  v_pk_fma_f32 v[76:77], v[76:77], s[88:89], v[2:3] op_sel_hi:[1,0,1]
  v_pk_fma_f32 v[78:79], v[78:79], s[88:89], v[2:3] op_sel_hi:[1,0,1]
  v_pk_mul_f32 v[64:65], v[64:65], v[176:177]
  v_pk_mul_f32 v[66:67], v[66:67], v[178:179]
  v_pk_mul_f32 v[68:69], v[68:69], v[180:181]
  v_pk_mul_f32 v[70:71], v[70:71], v[182:183]
  v_pk_mul_f32 v[72:73], v[72:73], v[184:185]
  v_pk_mul_f32 v[74:75], v[74:75], v[186:187]
  v_pk_mul_f32 v[76:77], v[76:77], v[188:189]
  v_pk_mul_f32 v[78:79], v[78:79], v[190:191]
  s_add_u32 m0, s76, 57344
  s_mul_i32 s17, s21, 40
  buffer_load_dwordx4 v48, s[40:43], s17 offen  lds
  buffer_load_dwordx4 v49, s[40:43], s17 offen offset:1024  lds
  v_exp_f32 v64, v64
  v_exp_f32 v65, v65
  v_exp_f32 v66, v66
  v_exp_f32 v67, v67
  v_exp_f32 v68, v68
  v_exp_f32 v69, v69
  v_exp_f32 v70, v70
  v_exp_f32 v71, v71
  v_exp_f32 v72, v72
  v_exp_f32 v73, v73
  v_exp_f32 v74, v74
  v_exp_f32 v75, v75
  v_exp_f32 v76, v76
  v_exp_f32 v77, v77
  v_exp_f32 v78, v78
  v_exp_f32_e64 v79, v79
  v_pk_add_f32 v[64:65], v[64:65], s[90:91] op_sel_hi:[1,0]
  v_pk_add_f32 v[66:67], v[66:67], s[90:91] op_sel_hi:[1,0]
  v_pk_add_f32 v[68:69], v[68:69], s[90:91] op_sel_hi:[1,0]
  v_pk_add_f32 v[70:71], v[70:71], s[90:91] op_sel_hi:[1,0]
  v_pk_add_f32 v[72:73], v[72:73], s[90:91] op_sel_hi:[1,0]
  v_pk_add_f32 v[74:75], v[74:75], s[90:91] op_sel_hi:[1,0]
  v_pk_add_f32 v[76:77], v[76:77], s[90:91] op_sel_hi:[1,0]
  v_pk_add_f32 v[78:79], v[78:79], s[90:91] op_sel_hi:[1,0]
  v_rcp_f32 v64, v64
  v_rcp_f32 v65, v65
  v_rcp_f32 v66, v66
  v_rcp_f32 v67, v67
  v_rcp_f32 v68, v68
  v_rcp_f32 v69, v69
  v_rcp_f32 v70, v70
  v_rcp_f32 v71, v71
  v_rcp_f32 v72, v72
  v_rcp_f32 v73, v73
  v_rcp_f32 v74, v74
  v_rcp_f32 v75, v75
  v_rcp_f32 v76, v76
  v_rcp_f32 v77, v77
  v_rcp_f32 v78, v78
  v_rcp_f32 v79, v79
  v_pk_mul_f32 v[176:177], v[176:177], v[64:65]
  v_pk_mul_f32 v[178:179], v[178:179], v[66:67]
  v_pk_mul_f32 v[180:181], v[180:181], v[68:69]
  v_pk_mul_f32 v[182:183], v[182:183], v[70:71]
  v_pk_mul_f32 v[184:185], v[184:185], v[72:73]
  v_pk_mul_f32 v[186:187], v[186:187], v[74:75]
  v_pk_mul_f32 v[188:189], v[188:189], v[76:77]
  v_pk_mul_f32 v[190:191], v[190:191], v[78:79]
  v_cvt_pk_bf16_f32 v176, v176, v177
  v_cvt_pk_bf16_f32 v177, v178, v179
  v_cvt_pk_bf16_f32 v178, v180, v181
  v_cvt_pk_bf16_f32 v179, v182, v183
  v_cvt_pk_bf16_f32 v180, v184, v185
  v_cvt_pk_bf16_f32 v181, v186, v187
  v_cvt_pk_bf16_f32 v182, v188, v189
  v_cvt_pk_bf16_f32 v183, v190, v191
  buffer_store_dwordx4 v[176:179], v90, s[36:39], 0 offen offset:1024 sc1
  buffer_store_dwordx4 v[180:183], v90, s[36:39], 0 offen offset:1536 sc1
  s_add_u32 m0, s76, 122880
  s_mul_i32 s17, s21, 40
  s_add_u32 s17, s17, 40960
  buffer_load_dwordx4 v48, s[40:43], s17 offen  lds
  buffer_load_dwordx4 v49, s[40:43], s17 offen offset:1024  lds
  s_add_u32 m0, s76, 131072
  s_mul_i32 s17, s21, 40
  s_add_u32 s17, s17, 81920
  buffer_load_dwordx4 v48, s[40:43], s17 offen  lds
  buffer_load_dwordx4 v49, s[40:43], s17 offen offset:1024  lds
  v_pk_fma_f32 v[64:65], v[96:97], v[34:35], v[4:5] op_sel:[0,1,0] op_sel_hi:[1,1,1] neg_lo:[1,0,0] neg_hi:[1,0,0]
  v_pk_fma_f32 v[66:67], v[98:99], v[34:35], v[6:7] op_sel:[0,1,0] op_sel_hi:[1,1,1] neg_lo:[1,0,0] neg_hi:[1,0,0]
  v_pk_fma_f32 v[68:69], v[100:101], v[34:35], v[8:9] op_sel:[0,1,0] op_sel_hi:[1,1,1] neg_lo:[1,0,0] neg_hi:[1,0,0]
  v_pk_fma_f32 v[70:71], v[102:103], v[34:35], v[10:11] op_sel:[0,1,0] op_sel_hi:[1,1,1] neg_lo:[1,0,0] neg_hi:[1,0,0]
  v_pk_fma_f32 v[72:73], v[104:105], v[34:35], v[12:13] op_sel:[0,1,0] op_sel_hi:[1,1,1] neg_lo:[1,0,0] neg_hi:[1,0,0]
  v_pk_fma_f32 v[74:75], v[106:107], v[34:35], v[14:15] op_sel:[0,1,0] op_sel_hi:[1,1,1] neg_lo:[1,0,0] neg_hi:[1,0,0]
  v_pk_fma_f32 v[76:77], v[108:109], v[34:35], v[16:17] op_sel:[0,1,0] op_sel_hi:[1,1,1] neg_lo:[1,0,0] neg_hi:[1,0,0]
  v_pk_fma_f32 v[78:79], v[110:111], v[34:35], v[18:19] op_sel:[0,1,0] op_sel_hi:[1,1,1] neg_lo:[1,0,0] neg_hi:[1,0,0]
  v_pk_fma_f32 v[224:225], v[224:225], v[34:35], v[64:65] op_sel:[0,0,0] op_sel_hi:[1,0,1]
  v_pk_fma_f32 v[226:227], v[226:227], v[34:35], v[66:67] op_sel:[0,0,0] op_sel_hi:[1,0,1]
  v_pk_fma_f32 v[228:229], v[228:229], v[34:35], v[68:69] op_sel:[0,0,0] op_sel_hi:[1,0,1]
  v_pk_fma_f32 v[230:231], v[230:231], v[34:35], v[70:71] op_sel:[0,0,0] op_sel_hi:[1,0,1]
  v_pk_fma_f32 v[232:233], v[232:233], v[34:35], v[72:73] op_sel:[0,0,0] op_sel_hi:[1,0,1]
  v_pk_fma_f32 v[234:235], v[234:235], v[34:35], v[74:75] op_sel:[0,0,0] op_sel_hi:[1,0,1]
  v_pk_fma_f32 v[236:237], v[236:237], v[34:35], v[76:77] op_sel:[0,0,0] op_sel_hi:[1,0,1]
  v_pk_fma_f32 v[238:239], v[238:239], v[34:35], v[78:79] op_sel:[0,0,0] op_sel_hi:[1,0,1]
  v_pk_mul_f32 v[64:65], v[224:225], v[224:225]
  v_pk_mul_f32 v[66:67], v[226:227], v[226:227]
  v_pk_mul_f32 v[68:69], v[228:229], v[228:229]
  v_pk_mul_f32 v[70:71], v[230:231], v[230:231]
  v_pk_mul_f32 v[72:73], v[232:233], v[232:233]
  v_pk_mul_f32 v[74:75], v[234:235], v[234:235]
  v_pk_mul_f32 v[76:77], v[236:237], v[236:237]
  v_pk_mul_f32 v[78:79], v[238:239], v[238:239]
  v_pk_fma_f32 v[64:65], v[64:65], s[88:89], v[2:3] op_sel_hi:[1,0,1]
  v_pk_fma_f32 v[66:67], v[66:67], s[88:89], v[2:3] op_sel_hi:[1,0,1]
  v_pk_fma_f32 v[68:69], v[68:69], s[88:89], v[2:3] op_sel_hi:[1,0,1]
  v_pk_fma_f32 v[70:71], v[70:71], s[88:89], v[2:3] op_sel_hi:[1,0,1]
  v_pk_fma_f32 v[72:73], v[72:73], s[88:89], v[2:3] op_sel_hi:[1,0,1]
  v_pk_fma_f32 v[74:75], v[74:75], s[88:89], v[2:3] op_sel_hi:[1,0,1]
  v_pk_fma_f32 v[76:77], v[76:77], s[88:89], v[2:3] op_sel_hi:[1,0,1]
  v_pk_fma_f32 v[78:79], v[78:79], s[88:89], v[2:3] op_sel_hi:[1,0,1]
  v_pk_mul_f32 v[64:65], v[64:65], v[224:225]
  v_pk_mul_f32 v[66:67], v[66:67], v[226:227]
  v_pk_mul_f32 v[68:69], v[68:69], v[228:229]
  v_pk_mul_f32 v[70:71], v[70:71], v[230:231]
  v_pk_mul_f32 v[72:73], v[72:73], v[232:233]
  v_pk_mul_f32 v[74:75], v[74:75], v[234:235]
  v_pk_mul_f32 v[76:77], v[76:77], v[236:237]
  v_pk_mul_f32 v[78:79], v[78:79], v[238:239]
  s_add_u32 m0, s76, 139264
  s_mul_i32 s17, s10, 40
  s_nop 0
  buffer_load_dwordx4 v50, s[44:47], s17 offen  lds
  buffer_load_dwordx4 v51, s[44:47], s17 offen offset:1024  lds
  s_add_u32 m0, s76, 147456
  s_add_u32 s17, s17, 40960
  buffer_load_dwordx4 v50, s[44:47], s17 offen  lds
  buffer_load_dwordx4 v51, s[44:47], s17 offen offset:1024  lds
  v_exp_f32 v64, v64
  v_exp_f32 v65, v65
  v_exp_f32 v66, v66
  v_exp_f32 v67, v67
  v_exp_f32 v68, v68
  v_exp_f32 v69, v69
  v_exp_f32 v70, v70
  v_exp_f32 v71, v71
  v_exp_f32 v72, v72
  v_exp_f32 v73, v73
  v_exp_f32 v74, v74
  v_exp_f32 v75, v75
  v_exp_f32 v76, v76
  v_exp_f32 v77, v77
  v_exp_f32 v78, v78
  v_exp_f32 v79, v79
  v_pk_add_f32 v[64:65], v[64:65], s[90:91] op_sel_hi:[1,0]
  v_pk_add_f32 v[66:67], v[66:67], s[90:91] op_sel_hi:[1,0]
  v_pk_add_f32 v[68:69], v[68:69], s[90:91] op_sel_hi:[1,0]
  v_pk_add_f32 v[70:71], v[70:71], s[90:91] op_sel_hi:[1,0]
  v_pk_add_f32 v[72:73], v[72:73], s[90:91] op_sel_hi:[1,0]
  v_pk_add_f32 v[74:75], v[74:75], s[90:91] op_sel_hi:[1,0]
  v_pk_add_f32 v[76:77], v[76:77], s[90:91] op_sel_hi:[1,0]
  v_pk_add_f32 v[78:79], v[78:79], s[90:91] op_sel_hi:[1,0]
  v_rcp_f32 v64, v64
  v_rcp_f32 v65, v65
  v_rcp_f32 v66, v66
  v_rcp_f32 v67, v67
  v_rcp_f32 v68, v68
  v_rcp_f32 v69, v69
  v_rcp_f32 v70, v70
  v_rcp_f32 v71, v71
  v_rcp_f32 v72, v72
  v_rcp_f32 v73, v73
  v_rcp_f32 v74, v74
  v_rcp_f32 v75, v75
  v_rcp_f32 v76, v76
  v_rcp_f32 v77, v77
  v_rcp_f32 v78, v78
  v_rcp_f32 v79, v79
  v_pk_mul_f32 v[224:225], v[224:225], v[64:65]
  v_pk_mul_f32 v[226:227], v[226:227], v[66:67]
  v_pk_mul_f32 v[228:229], v[228:229], v[68:69]
  v_pk_mul_f32 v[230:231], v[230:231], v[70:71]
  v_pk_mul_f32 v[232:233], v[232:233], v[72:73]
  v_pk_mul_f32 v[234:235], v[234:235], v[74:75]
  v_pk_mul_f32 v[236:237], v[236:237], v[76:77]
  v_pk_mul_f32 v[238:239], v[238:239], v[78:79]
  v_cvt_pk_bf16_f32 v224, v224, v225
  v_cvt_pk_bf16_f32 v225, v226, v227
  v_cvt_pk_bf16_f32 v226, v228, v229
  v_cvt_pk_bf16_f32 v227, v230, v231
  v_cvt_pk_bf16_f32 v228, v232, v233
  v_cvt_pk_bf16_f32 v229, v234, v235
  v_cvt_pk_bf16_f32 v230, v236, v237
  v_cvt_pk_bf16_f32 v231, v238, v239
  buffer_store_dwordx4 v[224:227], v91, s[36:39], 0 offen offset:1024 sc1
  buffer_store_dwordx4 v[228:231], v91, s[36:39], 0 offen offset:1536 sc1
  s_waitcnt lgkmcnt(0)
  s_nop 0
  v_pk_fma_f32 v[64:65], v[128:129], v[32:33], v[144:145] op_sel:[0,1,0] op_sel_hi:[1,1,1] neg_lo:[1,0,0] neg_hi:[1,0,0]
  v_pk_fma_f32 v[66:67], v[130:131], v[32:33], v[146:147] op_sel:[0,1,0] op_sel_hi:[1,1,1] neg_lo:[1,0,0] neg_hi:[1,0,0]
  v_pk_fma_f32 v[68:69], v[132:133], v[32:33], v[148:149] op_sel:[0,1,0] op_sel_hi:[1,1,1] neg_lo:[1,0,0] neg_hi:[1,0,0]
  v_pk_fma_f32 v[70:71], v[134:135], v[32:33], v[150:151] op_sel:[0,1,0] op_sel_hi:[1,1,1] neg_lo:[1,0,0] neg_hi:[1,0,0]
  v_pk_fma_f32 v[72:73], v[136:137], v[32:33], v[152:153] op_sel:[0,1,0] op_sel_hi:[1,1,1] neg_lo:[1,0,0] neg_hi:[1,0,0]
  v_pk_fma_f32 v[74:75], v[138:139], v[32:33], v[154:155] op_sel:[0,1,0] op_sel_hi:[1,1,1] neg_lo:[1,0,0] neg_hi:[1,0,0]
  v_pk_fma_f32 v[76:77], v[140:141], v[32:33], v[156:157] op_sel:[0,1,0] op_sel_hi:[1,1,1] neg_lo:[1,0,0] neg_hi:[1,0,0]
  v_pk_fma_f32 v[78:79], v[142:143], v[32:33], v[158:159] op_sel:[0,1,0] op_sel_hi:[1,1,1] neg_lo:[1,0,0] neg_hi:[1,0,0]
  v_pk_fma_f32 v[192:193], v[192:193], v[32:33], v[64:65] op_sel:[0,0,0] op_sel_hi:[1,0,1]
  v_pk_fma_f32 v[194:195], v[194:195], v[32:33], v[66:67] op_sel:[0,0,0] op_sel_hi:[1,0,1]
  v_pk_fma_f32 v[196:197], v[196:197], v[32:33], v[68:69] op_sel:[0,0,0] op_sel_hi:[1,0,1]
  v_pk_fma_f32 v[198:199], v[198:199], v[32:33], v[70:71] op_sel:[0,0,0] op_sel_hi:[1,0,1]
  v_pk_fma_f32 v[200:201], v[200:201], v[32:33], v[72:73] op_sel:[0,0,0] op_sel_hi:[1,0,1]
  v_pk_fma_f32 v[202:203], v[202:203], v[32:33], v[74:75] op_sel:[0,0,0] op_sel_hi:[1,0,1]
  v_pk_fma_f32 v[204:205], v[204:205], v[32:33], v[76:77] op_sel:[0,0,0] op_sel_hi:[1,0,1]
  v_pk_fma_f32 v[206:207], v[206:207], v[32:33], v[78:79] op_sel:[0,0,0] op_sel_hi:[1,0,1]
  v_pk_mul_f32 v[64:65], v[192:193], v[192:193]
  v_pk_mul_f32 v[66:67], v[194:195], v[194:195]
  v_pk_mul_f32 v[68:69], v[196:197], v[196:197]
  v_pk_mul_f32 v[70:71], v[198:199], v[198:199]
  v_pk_mul_f32 v[72:73], v[200:201], v[200:201]
  v_pk_mul_f32 v[74:75], v[202:203], v[202:203]
  v_pk_mul_f32 v[76:77], v[204:205], v[204:205]
  v_pk_mul_f32 v[78:79], v[206:207], v[206:207]
  v_pk_fma_f32 v[64:65], v[64:65], s[88:89], v[2:3] op_sel_hi:[1,0,1]
  v_pk_fma_f32 v[66:67], v[66:67], s[88:89], v[2:3] op_sel_hi:[1,0,1]
  v_pk_fma_f32 v[68:69], v[68:69], s[88:89], v[2:3] op_sel_hi:[1,0,1]
  v_pk_fma_f32 v[70:71], v[70:71], s[88:89], v[2:3] op_sel_hi:[1,0,1]
  v_pk_fma_f32 v[72:73], v[72:73], s[88:89], v[2:3] op_sel_hi:[1,0,1]
  v_pk_fma_f32 v[74:75], v[74:75], s[88:89], v[2:3] op_sel_hi:[1,0,1]
  v_pk_fma_f32 v[76:77], v[76:77], s[88:89], v[2:3] op_sel_hi:[1,0,1]
  v_pk_fma_f32 v[78:79], v[78:79], s[88:89], v[2:3] op_sel_hi:[1,0,1]
  v_pk_mul_f32 v[64:65], v[64:65], v[192:193]
  v_pk_mul_f32 v[66:67], v[66:67], v[194:195]
  v_pk_mul_f32 v[68:69], v[68:69], v[196:197]
  v_pk_mul_f32 v[70:71], v[70:71], v[198:199]
  v_pk_mul_f32 v[72:73], v[72:73], v[200:201]
  v_pk_mul_f32 v[74:75], v[74:75], v[202:203]
  v_pk_mul_f32 v[76:77], v[76:77], v[204:205]
  v_pk_mul_f32 v[78:79], v[78:79], v[206:207]
  v_exp_f32 v64, v64
  v_exp_f32 v65, v65
  v_exp_f32 v66, v66
  v_exp_f32 v67, v67
  v_exp_f32 v68, v68
  v_exp_f32 v69, v69
  v_exp_f32 v70, v70
  v_exp_f32 v71, v71
  v_exp_f32 v72, v72
  v_exp_f32 v73, v73
  v_exp_f32 v74, v74
  v_exp_f32 v75, v75
  v_exp_f32 v76, v76
  v_exp_f32 v77, v77
  v_exp_f32 v78, v78
  v_exp_f32 v79, v79
  v_pk_add_f32 v[64:65], v[64:65], s[90:91] op_sel_hi:[1,0]
  v_pk_add_f32 v[66:67], v[66:67], s[90:91] op_sel_hi:[1,0]
  v_pk_add_f32 v[68:69], v[68:69], s[90:91] op_sel_hi:[1,0]
  v_pk_add_f32 v[70:71], v[70:71], s[90:91] op_sel_hi:[1,0]
  v_pk_add_f32 v[72:73], v[72:73], s[90:91] op_sel_hi:[1,0]
  v_pk_add_f32 v[74:75], v[74:75], s[90:91] op_sel_hi:[1,0]
  v_pk_add_f32 v[76:77], v[76:77], s[90:91] op_sel_hi:[1,0]
  v_pk_add_f32 v[78:79], v[78:79], s[90:91] op_sel_hi:[1,0]
  v_rcp_f32 v64, v64
  v_rcp_f32 v65, v65
  v_rcp_f32 v66, v66
  v_rcp_f32 v67, v67
  v_rcp_f32 v68, v68
  v_rcp_f32 v69, v69
  v_rcp_f32 v70, v70
  v_rcp_f32 v71, v71
  v_rcp_f32 v72, v72
  v_rcp_f32 v73, v73
  v_rcp_f32 v74, v74
  v_rcp_f32 v75, v75
  v_rcp_f32 v76, v76
  v_rcp_f32 v77, v77
  v_rcp_f32 v78, v78
  v_rcp_f32 v79, v79
  v_pk_mul_f32 v[192:193], v[192:193], v[64:65]
  v_pk_mul_f32 v[194:195], v[194:195], v[66:67]
  v_pk_mul_f32 v[196:197], v[196:197], v[68:69]
  v_pk_mul_f32 v[198:199], v[198:199], v[70:71]
  v_pk_mul_f32 v[200:201], v[200:201], v[72:73]
  v_pk_mul_f32 v[202:203], v[202:203], v[74:75]
  v_pk_mul_f32 v[204:205], v[204:205], v[76:77]
  v_pk_mul_f32 v[206:207], v[206:207], v[78:79]
  v_cvt_pk_bf16_f32 v192, v192, v193
  v_cvt_pk_bf16_f32 v193, v194, v195
  v_cvt_pk_bf16_f32 v194, v196, v197
  v_cvt_pk_bf16_f32 v195, v198, v199
  v_cvt_pk_bf16_f32 v196, v200, v201
  v_cvt_pk_bf16_f32 v197, v202, v203
  v_cvt_pk_bf16_f32 v198, v204, v205
  v_cvt_pk_bf16_f32 v199, v206, v207
  buffer_store_dwordx4 v[192:195], v90, s[36:39], 0 offen offset:2048 sc1
  buffer_store_dwordx4 v[196:199], v90, s[36:39], 0 offen offset:2560 sc1
  v_pk_fma_f32 v[64:65], v[128:129], v[34:35], v[144:145] op_sel:[0,1,0] op_sel_hi:[1,1,1] neg_lo:[1,0,0] neg_hi:[1,0,0]
  v_pk_fma_f32 v[66:67], v[130:131], v[34:35], v[146:147] op_sel:[0,1,0] op_sel_hi:[1,1,1] neg_lo:[1,0,0] neg_hi:[1,0,0]
  v_pk_fma_f32 v[68:69], v[132:133], v[34:35], v[148:149] op_sel:[0,1,0] op_sel_hi:[1,1,1] neg_lo:[1,0,0] neg_hi:[1,0,0]
  v_pk_fma_f32 v[70:71], v[134:135], v[34:35], v[150:151] op_sel:[0,1,0] op_sel_hi:[1,1,1] neg_lo:[1,0,0] neg_hi:[1,0,0]
  v_pk_fma_f32 v[72:73], v[136:137], v[34:35], v[152:153] op_sel:[0,1,0] op_sel_hi:[1,1,1] neg_lo:[1,0,0] neg_hi:[1,0,0]
  v_pk_fma_f32 v[74:75], v[138:139], v[34:35], v[154:155] op_sel:[0,1,0] op_sel_hi:[1,1,1] neg_lo:[1,0,0] neg_hi:[1,0,0]
  v_pk_fma_f32 v[76:77], v[140:141], v[34:35], v[156:157] op_sel:[0,1,0] op_sel_hi:[1,1,1] neg_lo:[1,0,0] neg_hi:[1,0,0]
  v_pk_fma_f32 v[78:79], v[142:143], v[34:35], v[158:159] op_sel:[0,1,0] op_sel_hi:[1,1,1] neg_lo:[1,0,0] neg_hi:[1,0,0]
  v_pk_fma_f32 v[240:241], v[240:241], v[34:35], v[64:65] op_sel:[0,0,0] op_sel_hi:[1,0,1]
  v_pk_fma_f32 v[242:243], v[242:243], v[34:35], v[66:67] op_sel:[0,0,0] op_sel_hi:[1,0,1]
  v_pk_fma_f32 v[244:245], v[244:245], v[34:35], v[68:69] op_sel:[0,0,0] op_sel_hi:[1,0,1]
  v_pk_fma_f32 v[246:247], v[246:247], v[34:35], v[70:71] op_sel:[0,0,0] op_sel_hi:[1,0,1]
  v_pk_fma_f32 v[248:249], v[248:249], v[34:35], v[72:73] op_sel:[0,0,0] op_sel_hi:[1,0,1]
  v_pk_fma_f32 v[250:251], v[250:251], v[34:35], v[74:75] op_sel:[0,0,0] op_sel_hi:[1,0,1]
  v_pk_fma_f32 v[252:253], v[252:253], v[34:35], v[76:77] op_sel:[0,0,0] op_sel_hi:[1,0,1]
  v_pk_fma_f32 v[254:255], v[254:255], v[34:35], v[78:79] op_sel:[0,0,0] op_sel_hi:[1,0,1]
  v_pk_mul_f32 v[64:65], v[240:241], v[240:241]
  v_pk_mul_f32 v[66:67], v[242:243], v[242:243]
  v_pk_mul_f32 v[68:69], v[244:245], v[244:245]
  v_pk_mul_f32 v[70:71], v[246:247], v[246:247]
  v_pk_mul_f32 v[72:73], v[248:249], v[248:249]
  v_pk_mul_f32 v[74:75], v[250:251], v[250:251]
  v_pk_mul_f32 v[76:77], v[252:253], v[252:253]
  v_pk_mul_f32 v[78:79], v[254:255], v[254:255]
  v_pk_fma_f32 v[64:65], v[64:65], s[88:89], v[2:3] op_sel_hi:[1,0,1]
  v_pk_fma_f32 v[66:67], v[66:67], s[88:89], v[2:3] op_sel_hi:[1,0,1]
  v_pk_fma_f32 v[68:69], v[68:69], s[88:89], v[2:3] op_sel_hi:[1,0,1]
  v_pk_fma_f32 v[70:71], v[70:71], s[88:89], v[2:3] op_sel_hi:[1,0,1]
  v_pk_fma_f32 v[72:73], v[72:73], s[88:89], v[2:3] op_sel_hi:[1,0,1]
  v_pk_fma_f32 v[74:75], v[74:75], s[88:89], v[2:3] op_sel_hi:[1,0,1]
  v_pk_fma_f32 v[76:77], v[76:77], s[88:89], v[2:3] op_sel_hi:[1,0,1]
  v_pk_fma_f32 v[78:79], v[78:79], s[88:89], v[2:3] op_sel_hi:[1,0,1]
  v_pk_mul_f32 v[64:65], v[64:65], v[240:241]
  v_pk_mul_f32 v[66:67], v[66:67], v[242:243]
  v_pk_mul_f32 v[68:69], v[68:69], v[244:245]
  v_pk_mul_f32 v[70:71], v[70:71], v[246:247]
  v_pk_mul_f32 v[72:73], v[72:73], v[248:249]
  v_pk_mul_f32 v[74:75], v[74:75], v[250:251]
  v_pk_mul_f32 v[76:77], v[76:77], v[252:253]
  v_pk_mul_f32 v[78:79], v[78:79], v[254:255]
  v_exp_f32 v64, v64
  v_exp_f32 v65, v65
  v_exp_f32 v66, v66
  v_exp_f32 v67, v67
  v_exp_f32 v68, v68
  v_exp_f32 v69, v69
  v_exp_f32 v70, v70
  v_exp_f32 v71, v71
  v_exp_f32 v72, v72
  v_exp_f32 v73, v73
  v_exp_f32 v74, v74
  v_exp_f32 v75, v75
  v_exp_f32 v76, v76
  v_exp_f32 v77, v77
  v_exp_f32 v78, v78
  v_exp_f32 v79, v79
  v_pk_add_f32 v[64:65], v[64:65], s[90:91] op_sel_hi:[1,0]
  v_pk_add_f32 v[66:67], v[66:67], s[90:91] op_sel_hi:[1,0]
  v_pk_add_f32 v[68:69], v[68:69], s[90:91] op_sel_hi:[1,0]
  v_pk_add_f32 v[70:71], v[70:71], s[90:91] op_sel_hi:[1,0]
  v_pk_add_f32 v[72:73], v[72:73], s[90:91] op_sel_hi:[1,0]
  v_pk_add_f32 v[74:75], v[74:75], s[90:91] op_sel_hi:[1,0]
  v_pk_add_f32 v[76:77], v[76:77], s[90:91] op_sel_hi:[1,0]
  v_pk_add_f32 v[78:79], v[78:79], s[90:91] op_sel_hi:[1,0]
  v_rcp_f32 v64, v64
  v_rcp_f32 v65, v65
  v_rcp_f32 v66, v66
  v_rcp_f32 v67, v67
  v_rcp_f32 v68, v68
  v_rcp_f32 v69, v69
  v_rcp_f32 v70, v70
  v_rcp_f32 v71, v71
  v_rcp_f32 v72, v72
  v_rcp_f32 v73, v73
  v_rcp_f32 v74, v74
  v_rcp_f32 v75, v75
  v_rcp_f32 v76, v76
  v_rcp_f32 v77, v77
  v_rcp_f32 v78, v78
  v_rcp_f32 v79, v79
  v_pk_mul_f32 v[240:241], v[240:241], v[64:65]
  v_pk_mul_f32 v[242:243], v[242:243], v[66:67]
  v_pk_mul_f32 v[244:245], v[244:245], v[68:69]
  v_pk_mul_f32 v[246:247], v[246:247], v[70:71]
  v_pk_mul_f32 v[248:249], v[248:249], v[72:73]
  v_pk_mul_f32 v[250:251], v[250:251], v[74:75]
  v_pk_mul_f32 v[252:253], v[252:253], v[76:77]
  v_pk_mul_f32 v[254:255], v[254:255], v[78:79]
  v_cvt_pk_bf16_f32 v240, v240, v241
  v_cvt_pk_bf16_f32 v241, v242, v243
  v_cvt_pk_bf16_f32 v242, v244, v245
  v_cvt_pk_bf16_f32 v243, v246, v247
  v_cvt_pk_bf16_f32 v244, v248, v249
  v_cvt_pk_bf16_f32 v245, v250, v251
  v_cvt_pk_bf16_f32 v246, v252, v253
  v_cvt_pk_bf16_f32 v247, v254, v255
  buffer_store_dwordx4 v[240:243], v91, s[36:39], 0 offen offset:2048 sc1
  buffer_store_dwordx4 v[244:247], v91, s[36:39], 0 offen offset:2560 sc1
  v_accvgpr_read_b32 v2, a200
  v_accvgpr_read_b32 v124, a201
  v_accvgpr_read_b32 v5, a202
  v_accvgpr_read_b32 v9, a204
  v_accvgpr_read_b32 v10, a205
  v_accvgpr_read_b32 v28, a206
  v_accvgpr_read_b32 v29, a207
  v_accvgpr_read_b32 v24, a216
  v_accvgpr_read_b32 v25, a217
  v_accvgpr_read_b32 v26, a218
  v_accvgpr_read_b32 v27, a219
  v_add_u32 v3, 69632, v2
  v_add_u32 v6, 20480, v5
  v_add_u32 v4, 139264, v2
  v_add_u32 v7, 40960, v5
  s_waitcnt vmcnt(58)
  s_nop 0
  v_accvgpr_read_b32 v12, a240
  v_accvgpr_read_b32 v13, a241
  v_accvgpr_read_b32 v14, a242
  v_accvgpr_read_b32 v15, a243
  v_accvgpr_read_b32 v16, a244
  v_accvgpr_read_b32 v17, a245
  v_accvgpr_read_b32 v18, a246
  v_accvgpr_read_b32 v19, a247
  v_accvgpr_read_b32 v20, a248
  v_accvgpr_read_b32 v21, a249
  v_accvgpr_read_b32 v22, a250
  v_accvgpr_read_b32 v23, a251
  s_waitcnt vmcnt(30)
  s_barrier
  v_add_u32 v52, 0x10000, v52
  v_add_u32 v53, 0x10000, v53
  v_add_u32 v54, 0x10000, v54
  v_add_u32 v55, 0x10000, v55
  ds_read_b64_tr_b16 a[112:113], v52 offset:0
  ds_read_b64_tr_b16 a[114:115], v52 offset:2048
  ds_read_b64_tr_b16 a[116:117], v53 offset:0
  ds_read_b64_tr_b16 a[118:119], v53 offset:2048
  ds_read_b64_tr_b16 a[120:121], v54 offset:0
  ds_read_b64_tr_b16 a[122:123], v54 offset:2048
  ds_read_b64_tr_b16 a[124:125], v55 offset:0
  ds_read_b64_tr_b16 a[126:127], v55 offset:2048
  ds_read_b64_tr_b16 a[128:129], v52 offset:8192
  ds_read_b64_tr_b16 a[130:131], v52 offset:10240
  ds_read_b64_tr_b16 a[132:133], v53 offset:8192
  ds_read_b64_tr_b16 a[134:135], v53 offset:10240
  ds_read_b64_tr_b16 a[136:137], v54 offset:8192
  ds_read_b64_tr_b16 a[138:139], v54 offset:10240
  ds_read_b64_tr_b16 a[140:141], v55 offset:8192
  ds_read_b64_tr_b16 a[142:143], v55 offset:10240
  ds_read_b64_tr_b16 a[144:145], v52 offset:16384
  ds_read_b64_tr_b16 a[146:147], v52 offset:18432
  ds_read_b64_tr_b16 a[148:149], v53 offset:16384
  ds_read_b64_tr_b16 a[150:151], v53 offset:18432
  ds_read_b64_tr_b16 a[152:153], v54 offset:16384
  ds_read_b64_tr_b16 a[154:155], v54 offset:18432
  ds_read_b64_tr_b16 a[156:157], v55 offset:16384
  ds_read_b64_tr_b16 a[158:159], v55 offset:18432
  ds_read_b64_tr_b16 a[160:161], v52 offset:24576
  ds_read_b64_tr_b16 a[162:163], v52 offset:26624
  ds_read_b64_tr_b16 a[164:165], v53 offset:24576
  ds_read_b64_tr_b16 a[166:167], v53 offset:26624
  ds_read_b64_tr_b16 a[168:169], v54 offset:24576
  ds_read_b64_tr_b16 a[170:171], v54 offset:26624
  ds_read_b64_tr_b16 a[172:173], v55 offset:24576
  ds_read_b64_tr_b16 a[174:175], v55 offset:26624
  ds_read_b64_tr_b16 a[176:177], v52 offset:32768
  ds_read_b64_tr_b16 a[178:179], v52 offset:34816
  ds_read_b64_tr_b16 a[180:181], v53 offset:32768
  ds_read_b64_tr_b16 a[182:183], v53 offset:34816
  ds_read_b64_tr_b16 a[184:185], v54 offset:32768
  ds_read_b64_tr_b16 a[186:187], v54 offset:34816
  ds_read_b64_tr_b16 a[188:189], v55 offset:32768
  ds_read_b64_tr_b16 a[190:191], v55 offset:34816
  ds_read_b64_tr_b16 a[192:193], v52 offset:40960
  ds_read_b64_tr_b16 a[194:195], v52 offset:43008
  ds_read_b64_tr_b16 a[196:197], v53 offset:40960
  ds_read_b64_tr_b16 a[198:199], v53 offset:43008
  ds_read_b64_tr_b16 a[200:201], v54 offset:40960
  ds_read_b64_tr_b16 a[202:203], v54 offset:43008
  ds_read_b64_tr_b16 a[204:205], v55 offset:40960
  ds_read_b64_tr_b16 a[206:207], v55 offset:43008
  ds_read_b64_tr_b16 a[208:209], v52 offset:49152
  ds_read_b64_tr_b16 a[210:211], v52 offset:51200
  ds_read_b64_tr_b16 a[212:213], v53 offset:49152
  ds_read_b64_tr_b16 a[214:215], v53 offset:51200
  ds_read_b64_tr_b16 a[216:217], v54 offset:49152
  ds_read_b64_tr_b16 a[218:219], v54 offset:51200
  ds_read_b64_tr_b16 a[220:221], v55 offset:49152
  ds_read_b64_tr_b16 a[222:223], v55 offset:51200
  v_add_u32 v52, 0xffff0000, v52
  v_add_u32 v53, 0xffff0000, v53
  v_add_u32 v54, 0xffff0000, v54
  v_add_u32 v55, 0xffff0000, v55
  ds_read_b64_tr_b16 a[224:225], v52 offset:24576
  ds_read_b64_tr_b16 a[226:227], v52 offset:26624
  ds_read_b64_tr_b16 a[228:229], v53 offset:24576
  ds_read_b64_tr_b16 a[230:231], v53 offset:26624
  ds_read_b64_tr_b16 a[232:233], v54 offset:24576
  ds_read_b64_tr_b16 a[234:235], v54 offset:26624
  ds_read_b64_tr_b16 a[236:237], v55 offset:24576
  ds_read_b64_tr_b16 a[238:239], v55 offset:26624
  ds_read_b64_tr_b16 a[240:241], v52 offset:32768
  ds_read_b64_tr_b16 a[242:243], v52 offset:34816
  ds_read_b64_tr_b16 a[244:245], v53 offset:32768
  ds_read_b64_tr_b16 a[246:247], v53 offset:34816
  ds_read_b64_tr_b16 a[248:249], v54 offset:32768
  ds_read_b64_tr_b16 a[250:251], v54 offset:34816
  ds_read_b64_tr_b16 a[252:253], v55 offset:32768
  ds_read_b64_tr_b16 a[254:255], v55 offset:34816
  s_waitcnt vmcnt(0) lgkmcnt(0)
  s_barrier
  buffer_store_dword v93, v94, s[36:39], 0 offen sc1
  s_add_u32 m0, s76, 65536
  s_mul_i32 s17, s11, 40
  s_nop 0
  buffer_load_dwordx4 v50, s[44:47], s17 offen  lds
  buffer_load_dwordx4 v51, s[44:47], s17 offen offset:1024  lds
  s_add_u32 m0, s76, 73728
  s_add_u32 s17, s17, 40960
  buffer_load_dwordx4 v50, s[44:47], s17 offen  lds
  buffer_load_dwordx4 v51, s[44:47], s17 offen offset:1024  lds
  s_add_u32 m0, s76, 81920
  s_mul_i32 s17, s12, 40
  s_nop 0
  buffer_load_dwordx4 v50, s[44:47], s17 offen  lds
  buffer_load_dwordx4 v51, s[44:47], s17 offen offset:1024  lds
  s_add_u32 m0, s76, 90112
  s_add_u32 s17, s17, 40960
  buffer_load_dwordx4 v50, s[44:47], s17 offen  lds
  buffer_load_dwordx4 v51, s[44:47], s17 offen offset:1024  lds
  s_add_u32 m0, s76, 98304
  s_mul_i32 s17, s13, 40
  s_nop 0
  buffer_load_dwordx4 v50, s[44:47], s17 offen  lds
  buffer_load_dwordx4 v51, s[44:47], s17 offen offset:1024  lds
  s_add_u32 m0, s76, 106496
  s_add_u32 s17, s17, 40960
  buffer_load_dwordx4 v50, s[44:47], s17 offen  lds
  buffer_load_dwordx4 v51, s[44:47], s17 offen offset:1024  lds
  s_add_u32 m0, s76, 114688
  s_mul_i32 s17, s16, 40
  s_nop 0
  buffer_load_dwordx4 v50, s[44:47], s17 offen  lds
  buffer_load_dwordx4 v51, s[44:47], s17 offen offset:1024  lds
  s_add_u32 m0, s76, 24576
  s_add_u32 s17, s17, 40960
  buffer_load_dwordx4 v50, s[44:47], s17 offen  lds
  buffer_load_dwordx4 v51, s[44:47], s17 offen offset:1024  lds
  buffer_load_dword v60, v124, s[36:39], s54 offen sc1
LHp2:
  s_waitcnt vmcnt(0)
  v_cmp_gt_u32 vcc, s53, v60
  s_nop 0
  s_cmp_eq_u64 vcc, 0
  s_cbranch_scc0 Lslow_17
Lback_18:
  s_barrier
  buffer_load_dwordx4 v[64:67], v2, s[36:39], s4 offen offset:0 sc1
  buffer_load_dwordx4 v[68:71], v3, s[36:39], s4 offen offset:0 sc1
  buffer_load_dwordx4 v[72:75], v4, s[36:39], s4 offen offset:0 sc1
  buffer_load_dwordx4 v[76:79], v2, s[36:39], s4 offen offset:1024 sc1
  buffer_load_dwordx4 v[80:83], v3, s[36:39], s4 offen offset:1024 sc1
  buffer_load_dwordx4 v[84:87], v4, s[36:39], s4 offen offset:1024 sc1
  buffer_load_dwordx4 v[88:91], v2, s[36:39], s4 offen offset:2048 sc1
  buffer_load_dwordx4 v[92:95], v3, s[36:39], s4 offen offset:2048 sc1
  buffer_load_dwordx4 v[96:99], v4, s[36:39], s4 offen offset:2048 sc1
  buffer_load_dwordx4 v[100:103], v2, s[36:39], s5 offen offset:0 sc1
  buffer_load_dwordx4 v[104:107], v3, s[36:39], s5 offen offset:0 sc1
  buffer_load_dwordx4 v[108:111], v4, s[36:39], s5 offen offset:0 sc1
  s_waitcnt vmcnt(9)
  v_mfma_f32_16x16x32_bf16 v[160:163], a[0:3], v[64:67], 0
  v_mfma_f32_16x16x32_bf16 v[164:167], a[4:7], v[64:67], 0
  buffer_load_dwordx4 v[112:115], v2, s[36:39], s5 offen offset:1024 sc1
  v_mfma_f32_16x16x32_bf16 v[168:171], a[8:11], v[64:67], 0
  v_mfma_f32_16x16x32_bf16 v[172:175], a[12:15], v[64:67], 0
  buffer_load_dwordx4 v[116:119], v3, s[36:39], s5 offen offset:1024 sc1
  v_mfma_f32_16x16x32_bf16 v[176:179], a[0:3], v[68:71], 0
  v_mfma_f32_16x16x32_bf16 v[180:183], a[4:7], v[68:71], 0
  buffer_load_dwordx4 v[120:123], v4, s[36:39], s5 offen offset:1024 sc1
  v_mfma_f32_16x16x32_bf16 v[184:187], a[8:11], v[68:71], 0
  v_mfma_f32_16x16x32_bf16 v[188:191], a[12:15], v[68:71], 0
  buffer_load_dwordx4 v[64:67], v2, s[36:39], s5 offen offset:2048 sc1
  v_mfma_f32_16x16x32_bf16 v[192:195], a[0:3], v[72:75], 0
  v_mfma_f32_16x16x32_bf16 v[196:199], a[4:7], v[72:75], 0
  buffer_load_dwordx4 v[68:71], v3, s[36:39], s5 offen offset:2048 sc1
  v_mfma_f32_16x16x32_bf16 v[200:203], a[8:11], v[72:75], 0
  v_mfma_f32_16x16x32_bf16 v[204:207], a[12:15], v[72:75], 0
  buffer_load_dwordx4 v[72:75], v4, s[36:39], s5 offen offset:2048 sc1
  s_waitcnt vmcnt(12)
  v_mfma_f32_16x16x32_bf16 v[160:163], a[16:19], v[76:79], v[160:163]
  v_mfma_f32_16x16x32_bf16 v[164:167], a[20:23], v[76:79], v[164:167]
  v_mfma_f32_16x16x32_bf16 v[168:171], a[24:27], v[76:79], v[168:171]
  v_mfma_f32_16x16x32_bf16 v[172:175], a[28:31], v[76:79], v[172:175]
  buffer_load_dwordx4 v[76:79], v2, s[36:39], s6 offen offset:0 sc1
  v_mfma_f32_16x16x32_bf16 v[176:179], a[16:19], v[80:83], v[176:179]
  v_mfma_f32_16x16x32_bf16 v[180:183], a[20:23], v[80:83], v[180:183]
  v_mfma_f32_16x16x32_bf16 v[184:187], a[24:27], v[80:83], v[184:187]
  v_mfma_f32_16x16x32_bf16 v[188:191], a[28:31], v[80:83], v[188:191]
  buffer_load_dwordx4 v[80:83], v3, s[36:39], s6 offen offset:0 sc1
  v_mfma_f32_16x16x32_bf16 v[192:195], a[16:19], v[84:87], v[192:195]
  v_mfma_f32_16x16x32_bf16 v[196:199], a[20:23], v[84:87], v[196:199]
  v_mfma_f32_16x16x32_bf16 v[200:203], a[24:27], v[84:87], v[200:203]
  v_mfma_f32_16x16x32_bf16 v[204:207], a[28:31], v[84:87], v[204:207]
  buffer_load_dwordx4 v[84:87], v4, s[36:39], s6 offen offset:0 sc1
  s_waitcnt vmcnt(12)
  v_mfma_f32_16x16x32_bf16 v[160:163], a[32:35], v[88:91], v[160:163]
  v_mfma_f32_16x16x32_bf16 v[164:167], a[36:39], v[88:91], v[164:167]
  v_mfma_f32_16x16x32_bf16 v[168:171], a[40:43], v[88:91], v[168:171]
  v_mfma_f32_16x16x32_bf16 v[172:175], a[44:47], v[88:91], v[172:175]
  buffer_load_dwordx4 v[88:91], v2, s[36:39], s6 offen offset:1024 sc1
  v_mfma_f32_16x16x32_bf16 v[176:179], a[32:35], v[92:95], v[176:179]
  v_mfma_f32_16x16x32_bf16 v[180:183], a[36:39], v[92:95], v[180:183]
  v_mfma_f32_16x16x32_bf16 v[184:187], a[40:43], v[92:95], v[184:187]
  v_mfma_f32_16x16x32_bf16 v[188:191], a[44:47], v[92:95], v[188:191]
  buffer_load_dwordx4 v[92:95], v3, s[36:39], s6 offen offset:1024 sc1
  v_mfma_f32_16x16x32_bf16 v[192:195], a[32:35], v[96:99], v[192:195]
  v_mfma_f32_16x16x32_bf16 v[196:199], a[36:39], v[96:99], v[196:199]
  v_mfma_f32_16x16x32_bf16 v[200:203], a[40:43], v[96:99], v[200:203]
  v_mfma_f32_16x16x32_bf16 v[204:207], a[44:47], v[96:99], v[204:207]
  buffer_load_dwordx4 v[96:99], v4, s[36:39], s6 offen offset:1024 sc1
  s_waitcnt vmcnt(12)
  v_mfma_f32_16x16x32_bf16 v[160:163], a[48:51], v[100:103], v[160:163]
  v_mfma_f32_16x16x32_bf16 v[164:167], a[52:55], v[100:103], v[164:167]
  v_mfma_f32_16x16x32_bf16 v[168:171], a[56:59], v[100:103], v[168:171]
  v_mfma_f32_16x16x32_bf16 v[172:175], a[60:63], v[100:103], v[172:175]
  buffer_load_dwordx4 v[100:103], v2, s[36:39], s6 offen offset:2048 sc1
  v_mfma_f32_16x16x32_bf16 v[176:179], a[48:51], v[104:107], v[176:179]
  v_mfma_f32_16x16x32_bf16 v[180:183], a[52:55], v[104:107], v[180:183]
  v_mfma_f32_16x16x32_bf16 v[184:187], a[56:59], v[104:107], v[184:187]
  v_mfma_f32_16x16x32_bf16 v[188:191], a[60:63], v[104:107], v[188:191]
  buffer_load_dwordx4 v[104:107], v3, s[36:39], s6 offen offset:2048 sc1
  v_mfma_f32_16x16x32_bf16 v[192:195], a[48:51], v[108:111], v[192:195]
  v_mfma_f32_16x16x32_bf16 v[196:199], a[52:55], v[108:111], v[196:199]
  v_mfma_f32_16x16x32_bf16 v[200:203], a[56:59], v[108:111], v[200:203]
  v_mfma_f32_16x16x32_bf16 v[204:207], a[60:63], v[108:111], v[204:207]
  buffer_load_dwordx4 v[108:111], v4, s[36:39], s6 offen offset:2048 sc1
  s_waitcnt vmcnt(12)
  v_mfma_f32_16x16x32_bf16 v[160:163], a[64:67], v[112:115], v[160:163]
  v_mfma_f32_16x16x32_bf16 v[164:167], a[68:71], v[112:115], v[164:167]
  v_mfma_f32_16x16x32_bf16 v[168:171], a[72:75], v[112:115], v[168:171]
  v_mfma_f32_16x16x32_bf16 v[172:175], a[76:79], v[112:115], v[172:175]
  buffer_load_dwordx4 v[112:115], v2, s[36:39], s7 offen offset:0 sc1
  v_mfma_f32_16x16x32_bf16 v[176:179], a[64:67], v[116:119], v[176:179]
  v_mfma_f32_16x16x32_bf16 v[180:183], a[68:71], v[116:119], v[180:183]
  v_mfma_f32_16x16x32_bf16 v[184:187], a[72:75], v[116:119], v[184:187]
  v_mfma_f32_16x16x32_bf16 v[188:191], a[76:79], v[116:119], v[188:191]
  buffer_load_dwordx4 v[116:119], v3, s[36:39], s7 offen offset:0 sc1
  v_mfma_f32_16x16x32_bf16 v[192:195], a[64:67], v[120:123], v[192:195]
  v_mfma_f32_16x16x32_bf16 v[196:199], a[68:71], v[120:123], v[196:199]
  v_mfma_f32_16x16x32_bf16 v[200:203], a[72:75], v[120:123], v[200:203]
  v_mfma_f32_16x16x32_bf16 v[204:207], a[76:79], v[120:123], v[204:207]
  buffer_load_dwordx4 v[120:123], v4, s[36:39], s7 offen offset:0 sc1
  s_waitcnt vmcnt(12)
  v_mfma_f32_16x16x32_bf16 v[160:163], a[80:83], v[64:67], v[160:163]
  v_mfma_f32_16x16x32_bf16 v[164:167], a[84:87], v[64:67], v[164:167]
  v_mfma_f32_16x16x32_bf16 v[168:171], a[88:91], v[64:67], v[168:171]
  v_mfma_f32_16x16x32_bf16 v[172:175], a[92:95], v[64:67], v[172:175]
  buffer_load_dwordx4 v[64:67], v2, s[36:39], s7 offen offset:1024 sc1
  v_mfma_f32_16x16x32_bf16 v[176:179], a[80:83], v[68:71], v[176:179]
  v_mfma_f32_16x16x32_bf16 v[180:183], a[84:87], v[68:71], v[180:183]
  v_mfma_f32_16x16x32_bf16 v[184:187], a[88:91], v[68:71], v[184:187]
  v_mfma_f32_16x16x32_bf16 v[188:191], a[92:95], v[68:71], v[188:191]
  buffer_load_dwordx4 v[68:71], v3, s[36:39], s7 offen offset:1024 sc1
  v_mfma_f32_16x16x32_bf16 v[192:195], a[80:83], v[72:75], v[192:195]
  v_mfma_f32_16x16x32_bf16 v[196:199], a[84:87], v[72:75], v[196:199]
  v_mfma_f32_16x16x32_bf16 v[200:203], a[88:91], v[72:75], v[200:203]
  v_mfma_f32_16x16x32_bf16 v[204:207], a[92:95], v[72:75], v[204:207]
  buffer_load_dwordx4 v[72:75], v4, s[36:39], s7 offen offset:1024 sc1
  s_waitcnt vmcnt(12)
  v_mfma_f32_16x16x32_bf16 v[160:163], a[96:99], v[76:79], v[160:163]
  v_mfma_f32_16x16x32_bf16 v[164:167], a[100:103], v[76:79], v[164:167]
  v_mfma_f32_16x16x32_bf16 v[168:171], a[104:107], v[76:79], v[168:171]
  v_mfma_f32_16x16x32_bf16 v[172:175], a[108:111], v[76:79], v[172:175]
  buffer_load_dwordx4 v[76:79], v2, s[36:39], s7 offen offset:2048 sc1
  v_mfma_f32_16x16x32_bf16 v[176:179], a[96:99], v[80:83], v[176:179]
  v_mfma_f32_16x16x32_bf16 v[180:183], a[100:103], v[80:83], v[180:183]
  v_mfma_f32_16x16x32_bf16 v[184:187], a[104:107], v[80:83], v[184:187]
  v_mfma_f32_16x16x32_bf16 v[188:191], a[108:111], v[80:83], v[188:191]
  buffer_load_dwordx4 v[80:83], v3, s[36:39], s7 offen offset:2048 sc1
  v_mfma_f32_16x16x32_bf16 v[192:195], a[96:99], v[84:87], v[192:195]
  v_mfma_f32_16x16x32_bf16 v[196:199], a[100:103], v[84:87], v[196:199]
  v_mfma_f32_16x16x32_bf16 v[200:203], a[104:107], v[84:87], v[200:203]
  v_mfma_f32_16x16x32_bf16 v[204:207], a[108:111], v[84:87], v[204:207]
  buffer_load_dwordx4 v[84:87], v4, s[36:39], s7 offen offset:2048 sc1
  s_waitcnt vmcnt(12)
  v_mfma_f32_16x16x32_bf16 v[160:163], a[112:115], v[88:91], v[160:163]
  v_mfma_f32_16x16x32_bf16 v[164:167], a[116:119], v[88:91], v[164:167]
  v_mfma_f32_16x16x32_bf16 v[168:171], a[120:123], v[88:91], v[168:171]
  v_mfma_f32_16x16x32_bf16 v[172:175], a[124:127], v[88:91], v[172:175]
  buffer_load_dwordx4 v[88:91], v2, s[36:39], s8 offen offset:0 sc1
  v_mfma_f32_16x16x32_bf16 v[176:179], a[112:115], v[92:95], v[176:179]
  v_mfma_f32_16x16x32_bf16 v[180:183], a[116:119], v[92:95], v[180:183]
  v_mfma_f32_16x16x32_bf16 v[184:187], a[120:123], v[92:95], v[184:187]
  v_mfma_f32_16x16x32_bf16 v[188:191], a[124:127], v[92:95], v[188:191]
  buffer_load_dwordx4 v[92:95], v3, s[36:39], s8 offen offset:0 sc1
  v_mfma_f32_16x16x32_bf16 v[192:195], a[112:115], v[96:99], v[192:195]
  v_mfma_f32_16x16x32_bf16 v[196:199], a[116:119], v[96:99], v[196:199]
  v_mfma_f32_16x16x32_bf16 v[200:203], a[120:123], v[96:99], v[200:203]
  v_mfma_f32_16x16x32_bf16 v[204:207], a[124:127], v[96:99], v[204:207]
  buffer_load_dwordx4 v[96:99], v4, s[36:39], s8 offen offset:0 sc1
  s_waitcnt vmcnt(12)
  v_mfma_f32_16x16x32_bf16 v[160:163], a[128:131], v[100:103], v[160:163]
  v_mfma_f32_16x16x32_bf16 v[164:167], a[132:135], v[100:103], v[164:167]
  v_mfma_f32_16x16x32_bf16 v[168:171], a[136:139], v[100:103], v[168:171]
  v_mfma_f32_16x16x32_bf16 v[172:175], a[140:143], v[100:103], v[172:175]
  buffer_load_dwordx4 v[100:103], v2, s[36:39], s8 offen offset:1024 sc1
  v_mfma_f32_16x16x32_bf16 v[176:179], a[128:131], v[104:107], v[176:179]
  v_mfma_f32_16x16x32_bf16 v[180:183], a[132:135], v[104:107], v[180:183]
  v_mfma_f32_16x16x32_bf16 v[184:187], a[136:139], v[104:107], v[184:187]
  v_mfma_f32_16x16x32_bf16 v[188:191], a[140:143], v[104:107], v[188:191]
  buffer_load_dwordx4 v[104:107], v3, s[36:39], s8 offen offset:1024 sc1
  v_mfma_f32_16x16x32_bf16 v[192:195], a[128:131], v[108:111], v[192:195]
  v_mfma_f32_16x16x32_bf16 v[196:199], a[132:135], v[108:111], v[196:199]
  v_mfma_f32_16x16x32_bf16 v[200:203], a[136:139], v[108:111], v[200:203]
  v_mfma_f32_16x16x32_bf16 v[204:207], a[140:143], v[108:111], v[204:207]
  buffer_load_dwordx4 v[108:111], v4, s[36:39], s8 offen offset:1024 sc1
  s_waitcnt vmcnt(12)
  v_mfma_f32_16x16x32_bf16 v[160:163], a[144:147], v[112:115], v[160:163]
  v_mfma_f32_16x16x32_bf16 v[164:167], a[148:151], v[112:115], v[164:167]
  v_mfma_f32_16x16x32_bf16 v[168:171], a[152:155], v[112:115], v[168:171]
  v_mfma_f32_16x16x32_bf16 v[172:175], a[156:159], v[112:115], v[172:175]
  buffer_load_dwordx4 v[112:115], v2, s[36:39], s8 offen offset:2048 sc1
  v_mfma_f32_16x16x32_bf16 v[176:179], a[144:147], v[116:119], v[176:179]
  v_mfma_f32_16x16x32_bf16 v[180:183], a[148:151], v[116:119], v[180:183]
  v_mfma_f32_16x16x32_bf16 v[184:187], a[152:155], v[116:119], v[184:187]
  v_mfma_f32_16x16x32_bf16 v[188:191], a[156:159], v[116:119], v[188:191]
  buffer_load_dwordx4 v[116:119], v3, s[36:39], s8 offen offset:2048 sc1
  v_mfma_f32_16x16x32_bf16 v[192:195], a[144:147], v[120:123], v[192:195]
  v_mfma_f32_16x16x32_bf16 v[196:199], a[148:151], v[120:123], v[196:199]
  v_mfma_f32_16x16x32_bf16 v[200:203], a[152:155], v[120:123], v[200:203]
  v_mfma_f32_16x16x32_bf16 v[204:207], a[156:159], v[120:123], v[204:207]
  buffer_load_dwordx4 v[120:123], v4, s[36:39], s8 offen offset:2048 sc1
  s_waitcnt vmcnt(12)
  v_mfma_f32_16x16x32_bf16 v[160:163], a[160:163], v[64:67], v[160:163]
  v_mfma_f32_16x16x32_bf16 v[164:167], a[164:167], v[64:67], v[164:167]
  v_mfma_f32_16x16x32_bf16 v[168:171], a[168:171], v[64:67], v[168:171]
  v_mfma_f32_16x16x32_bf16 v[172:175], a[172:175], v[64:67], v[172:175]
  buffer_load_dwordx4 v[64:67], v2, s[36:39], s9 offen offset:0 sc1
  v_mfma_f32_16x16x32_bf16 v[176:179], a[160:163], v[68:71], v[176:179]
  v_mfma_f32_16x16x32_bf16 v[180:183], a[164:167], v[68:71], v[180:183]
  v_mfma_f32_16x16x32_bf16 v[184:187], a[168:171], v[68:71], v[184:187]
  v_mfma_f32_16x16x32_bf16 v[188:191], a[172:175], v[68:71], v[188:191]
  buffer_load_dwordx4 v[68:71], v3, s[36:39], s9 offen offset:0 sc1
  v_mfma_f32_16x16x32_bf16 v[192:195], a[160:163], v[72:75], v[192:195]
  v_mfma_f32_16x16x32_bf16 v[196:199], a[164:167], v[72:75], v[196:199]
  v_mfma_f32_16x16x32_bf16 v[200:203], a[168:171], v[72:75], v[200:203]
  v_mfma_f32_16x16x32_bf16 v[204:207], a[172:175], v[72:75], v[204:207]
  buffer_load_dwordx4 v[72:75], v4, s[36:39], s9 offen offset:0 sc1
  s_waitcnt vmcnt(12)
  v_mfma_f32_16x16x32_bf16 v[160:163], a[176:179], v[76:79], v[160:163]
  v_mfma_f32_16x16x32_bf16 v[164:167], a[180:183], v[76:79], v[164:167]
  v_mfma_f32_16x16x32_bf16 v[168:171], a[184:187], v[76:79], v[168:171]
  v_mfma_f32_16x16x32_bf16 v[172:175], a[188:191], v[76:79], v[172:175]
  buffer_load_dwordx4 v[76:79], v2, s[36:39], s9 offen offset:1024 sc1
  v_mfma_f32_16x16x32_bf16 v[176:179], a[176:179], v[80:83], v[176:179]
  v_mfma_f32_16x16x32_bf16 v[180:183], a[180:183], v[80:83], v[180:183]
  v_mfma_f32_16x16x32_bf16 v[184:187], a[184:187], v[80:83], v[184:187]
  v_mfma_f32_16x16x32_bf16 v[188:191], a[188:191], v[80:83], v[188:191]
  buffer_load_dwordx4 v[80:83], v3, s[36:39], s9 offen offset:1024 sc1
  v_mfma_f32_16x16x32_bf16 v[192:195], a[176:179], v[84:87], v[192:195]
  v_mfma_f32_16x16x32_bf16 v[196:199], a[180:183], v[84:87], v[196:199]
  v_mfma_f32_16x16x32_bf16 v[200:203], a[184:187], v[84:87], v[200:203]
  v_mfma_f32_16x16x32_bf16 v[204:207], a[188:191], v[84:87], v[204:207]
  buffer_load_dwordx4 v[84:87], v4, s[36:39], s9 offen offset:1024 sc1
  s_waitcnt vmcnt(12)
  v_mfma_f32_16x16x32_bf16 v[160:163], a[192:195], v[88:91], v[160:163]
  v_mfma_f32_16x16x32_bf16 v[164:167], a[196:199], v[88:91], v[164:167]
  v_mfma_f32_16x16x32_bf16 v[168:171], a[200:203], v[88:91], v[168:171]
  v_mfma_f32_16x16x32_bf16 v[172:175], a[204:207], v[88:91], v[172:175]
  buffer_load_dwordx4 v[88:91], v2, s[36:39], s9 offen offset:2048 sc1
  v_mfma_f32_16x16x32_bf16 v[176:179], a[192:195], v[92:95], v[176:179]
  v_mfma_f32_16x16x32_bf16 v[180:183], a[196:199], v[92:95], v[180:183]
  v_mfma_f32_16x16x32_bf16 v[184:187], a[200:203], v[92:95], v[184:187]
  v_mfma_f32_16x16x32_bf16 v[188:191], a[204:207], v[92:95], v[188:191]
  buffer_load_dwordx4 v[92:95], v3, s[36:39], s9 offen offset:2048 sc1
  v_mfma_f32_16x16x32_bf16 v[192:195], a[192:195], v[96:99], v[192:195]
  v_mfma_f32_16x16x32_bf16 v[196:199], a[196:199], v[96:99], v[196:199]
  v_mfma_f32_16x16x32_bf16 v[200:203], a[200:203], v[96:99], v[200:203]
  v_mfma_f32_16x16x32_bf16 v[204:207], a[204:207], v[96:99], v[204:207]
  buffer_load_dwordx4 v[96:99], v4, s[36:39], s9 offen offset:2048 sc1
  s_waitcnt vmcnt(12)
  v_mfma_f32_16x16x32_bf16 v[160:163], a[208:211], v[100:103], v[160:163]
  v_mfma_f32_16x16x32_bf16 v[164:167], a[212:215], v[100:103], v[164:167]
  v_mfma_f32_16x16x32_bf16 v[168:171], a[216:219], v[100:103], v[168:171]
  v_mfma_f32_16x16x32_bf16 v[172:175], a[220:223], v[100:103], v[172:175]
  buffer_load_dwordx4 v[100:103], v2, s[36:39], s20 offen offset:0 sc1
  v_mfma_f32_16x16x32_bf16 v[176:179], a[208:211], v[104:107], v[176:179]
  v_mfma_f32_16x16x32_bf16 v[180:183], a[212:215], v[104:107], v[180:183]
  v_mfma_f32_16x16x32_bf16 v[184:187], a[216:219], v[104:107], v[184:187]
  v_mfma_f32_16x16x32_bf16 v[188:191], a[220:223], v[104:107], v[188:191]
  buffer_load_dwordx4 v[104:107], v3, s[36:39], s20 offen offset:0 sc1
  v_mfma_f32_16x16x32_bf16 v[192:195], a[208:211], v[108:111], v[192:195]
  v_mfma_f32_16x16x32_bf16 v[196:199], a[212:215], v[108:111], v[196:199]
  v_mfma_f32_16x16x32_bf16 v[200:203], a[216:219], v[108:111], v[200:203]
  v_mfma_f32_16x16x32_bf16 v[204:207], a[220:223], v[108:111], v[204:207]
  buffer_load_dwordx4 v[108:111], v4, s[36:39], s20 offen offset:0 sc1
  s_waitcnt vmcnt(63) lgkmcnt(0)
  s_barrier
  s_waitcnt vmcnt(12)
  v_mfma_f32_16x16x32_bf16 v[160:163], a[224:227], v[112:115], v[160:163]
  ds_read_b64_tr_b16 a[128:129], v52 offset:0
  v_mfma_f32_16x16x32_bf16 v[164:167], a[228:231], v[112:115], v[164:167]
  ds_read_b64_tr_b16 a[130:131], v52 offset:2048
  v_mfma_f32_16x16x32_bf16 v[168:171], a[232:235], v[112:115], v[168:171]
  ds_read_b64_tr_b16 a[132:133], v53 offset:0
  v_mfma_f32_16x16x32_bf16 v[172:175], a[236:239], v[112:115], v[172:175]
  buffer_load_dwordx4 v[112:115], v2, s[36:39], s20 offen offset:1024 sc1
  v_mfma_f32_16x16x32_bf16 v[176:179], a[224:227], v[116:119], v[176:179]
  ds_read_b64_tr_b16 a[134:135], v53 offset:2048
  v_mfma_f32_16x16x32_bf16 v[180:183], a[228:231], v[116:119], v[180:183]
  ds_read_b64_tr_b16 a[136:137], v54 offset:0
  v_mfma_f32_16x16x32_bf16 v[184:187], a[232:235], v[116:119], v[184:187]
  ds_read_b64_tr_b16 a[138:139], v54 offset:2048
  v_mfma_f32_16x16x32_bf16 v[188:191], a[236:239], v[116:119], v[188:191]
  buffer_load_dwordx4 v[116:119], v3, s[36:39], s20 offen offset:1024 sc1
  v_mfma_f32_16x16x32_bf16 v[192:195], a[224:227], v[120:123], v[192:195]
  ds_read_b64_tr_b16 a[140:141], v55 offset:0
  v_mfma_f32_16x16x32_bf16 v[196:199], a[228:231], v[120:123], v[196:199]
  v_mfma_f32_16x16x32_bf16 v[200:203], a[232:235], v[120:123], v[200:203]
  ds_read_b64_tr_b16 a[142:143], v55 offset:2048
  v_mfma_f32_16x16x32_bf16 v[204:207], a[236:239], v[120:123], v[204:207]
  buffer_load_dwordx4 v[120:123], v4, s[36:39], s20 offen offset:1024 sc1
  s_waitcnt vmcnt(12)
  v_mfma_f32_16x16x32_bf16 v[160:163], a[240:243], v[64:67], v[160:163]
  ds_read_b64_tr_b16 a[144:145], v52 offset:8192
  v_mfma_f32_16x16x32_bf16 v[164:167], a[244:247], v[64:67], v[164:167]
  ds_read_b64_tr_b16 a[146:147], v52 offset:10240
  v_mfma_f32_16x16x32_bf16 v[168:171], a[248:251], v[64:67], v[168:171]
  ds_read_b64_tr_b16 a[148:149], v53 offset:8192
  v_mfma_f32_16x16x32_bf16 v[172:175], a[252:255], v[64:67], v[172:175]
  buffer_load_dwordx4 v[64:67], v2, s[36:39], s20 offen offset:2048 sc1
  v_mfma_f32_16x16x32_bf16 v[176:179], a[240:243], v[68:71], v[176:179]
  ds_read_b64_tr_b16 a[150:151], v53 offset:10240
  v_mfma_f32_16x16x32_bf16 v[180:183], a[244:247], v[68:71], v[180:183]
  ds_read_b64_tr_b16 a[152:153], v54 offset:8192
  v_mfma_f32_16x16x32_bf16 v[184:187], a[248:251], v[68:71], v[184:187]
  ds_read_b64_tr_b16 a[154:155], v54 offset:10240
  v_mfma_f32_16x16x32_bf16 v[188:191], a[252:255], v[68:71], v[188:191]
  buffer_load_dwordx4 v[68:71], v3, s[36:39], s20 offen offset:2048 sc1
  v_mfma_f32_16x16x32_bf16 v[192:195], a[240:243], v[72:75], v[192:195]
  ds_read_b64_tr_b16 a[156:157], v55 offset:8192
  v_mfma_f32_16x16x32_bf16 v[196:199], a[244:247], v[72:75], v[196:199]
  v_mfma_f32_16x16x32_bf16 v[200:203], a[248:251], v[72:75], v[200:203]
  ds_read_b64_tr_b16 a[158:159], v55 offset:10240
  v_mfma_f32_16x16x32_bf16 v[204:207], a[252:255], v[72:75], v[204:207]
  buffer_load_dwordx4 v[72:75], v4, s[36:39], s20 offen offset:2048 sc1
  s_waitcnt vmcnt(12) lgkmcnt(8)
  v_mfma_f32_16x16x32_bf16 v[160:163], a[128:131], v[76:79], v[160:163]
  ds_read_b64_tr_b16 a[160:161], v52 offset:16384
  v_mfma_f32_16x16x32_bf16 v[164:167], a[132:135], v[76:79], v[164:167]
  ds_read_b64_tr_b16 a[162:163], v52 offset:18432
  v_mfma_f32_16x16x32_bf16 v[168:171], a[136:139], v[76:79], v[168:171]
  ds_read_b64_tr_b16 a[164:165], v53 offset:16384
  v_mfma_f32_16x16x32_bf16 v[172:175], a[140:143], v[76:79], v[172:175]
  buffer_load_dwordx4 v[76:79], v2, s[36:39], s21 offen offset:0 sc1
  v_mfma_f32_16x16x32_bf16 v[176:179], a[128:131], v[80:83], v[176:179]
  ds_read_b64_tr_b16 a[166:167], v53 offset:18432
  v_mfma_f32_16x16x32_bf16 v[180:183], a[132:135], v[80:83], v[180:183]
  ds_read_b64_tr_b16 a[168:169], v54 offset:16384
  v_mfma_f32_16x16x32_bf16 v[184:187], a[136:139], v[80:83], v[184:187]
  ds_read_b64_tr_b16 a[170:171], v54 offset:18432
  v_mfma_f32_16x16x32_bf16 v[188:191], a[140:143], v[80:83], v[188:191]
  buffer_load_dwordx4 v[80:83], v3, s[36:39], s21 offen offset:0 sc1
  v_mfma_f32_16x16x32_bf16 v[192:195], a[128:131], v[84:87], v[192:195]
  ds_read_b64_tr_b16 a[172:173], v55 offset:16384
  v_mfma_f32_16x16x32_bf16 v[196:199], a[132:135], v[84:87], v[196:199]
  v_mfma_f32_16x16x32_bf16 v[200:203], a[136:139], v[84:87], v[200:203]
  ds_read_b64_tr_b16 a[174:175], v55 offset:18432
  v_mfma_f32_16x16x32_bf16 v[204:207], a[140:143], v[84:87], v[204:207]
  buffer_load_dwordx4 v[84:87], v4, s[36:39], s21 offen offset:0 sc1
  s_waitcnt vmcnt(12) lgkmcnt(8)
  v_mfma_f32_16x16x32_bf16 v[160:163], a[144:147], v[88:91], v[160:163]
  ds_read_b64_tr_b16 a[176:177], v52 offset:40960
  v_mfma_f32_16x16x32_bf16 v[164:167], a[148:151], v[88:91], v[164:167]
  ds_read_b64_tr_b16 a[178:179], v52 offset:43008
  v_mfma_f32_16x16x32_bf16 v[168:171], a[152:155], v[88:91], v[168:171]
  ds_read_b64_tr_b16 a[180:181], v53 offset:40960
  v_mfma_f32_16x16x32_bf16 v[172:175], a[156:159], v[88:91], v[172:175]
  buffer_load_dwordx4 v[88:91], v2, s[36:39], s21 offen offset:1024 sc1
  v_mfma_f32_16x16x32_bf16 v[176:179], a[144:147], v[92:95], v[176:179]
  ds_read_b64_tr_b16 a[182:183], v53 offset:43008
  v_mfma_f32_16x16x32_bf16 v[180:183], a[148:151], v[92:95], v[180:183]
  ds_read_b64_tr_b16 a[184:185], v54 offset:40960
  v_mfma_f32_16x16x32_bf16 v[184:187], a[152:155], v[92:95], v[184:187]
  ds_read_b64_tr_b16 a[186:187], v54 offset:43008
  v_mfma_f32_16x16x32_bf16 v[188:191], a[156:159], v[92:95], v[188:191]
  buffer_load_dwordx4 v[92:95], v3, s[36:39], s21 offen offset:1024 sc1
  v_mfma_f32_16x16x32_bf16 v[192:195], a[144:147], v[96:99], v[192:195]
  ds_read_b64_tr_b16 a[188:189], v55 offset:40960
  v_mfma_f32_16x16x32_bf16 v[196:199], a[148:151], v[96:99], v[196:199]
  v_mfma_f32_16x16x32_bf16 v[200:203], a[152:155], v[96:99], v[200:203]
  ds_read_b64_tr_b16 a[190:191], v55 offset:43008
  v_mfma_f32_16x16x32_bf16 v[204:207], a[156:159], v[96:99], v[204:207]
  buffer_load_dwordx4 v[96:99], v4, s[36:39], s21 offen offset:1024 sc1
  s_waitcnt vmcnt(12) lgkmcnt(8)
  v_mfma_f32_16x16x32_bf16 v[160:163], a[160:163], v[100:103], v[160:163]
  ds_read_b64_tr_b16 a[128:129], v52 offset:49152
  v_mfma_f32_16x16x32_bf16 v[164:167], a[164:167], v[100:103], v[164:167]
  ds_read_b64_tr_b16 a[130:131], v52 offset:51200
  v_mfma_f32_16x16x32_bf16 v[168:171], a[168:171], v[100:103], v[168:171]
  ds_read_b64_tr_b16 a[132:133], v53 offset:49152
  v_mfma_f32_16x16x32_bf16 v[172:175], a[172:175], v[100:103], v[172:175]
  buffer_load_dwordx4 v[100:103], v2, s[36:39], s21 offen offset:2048 sc1
  v_mfma_f32_16x16x32_bf16 v[176:179], a[160:163], v[104:107], v[176:179]
  ds_read_b64_tr_b16 a[134:135], v53 offset:51200
  v_mfma_f32_16x16x32_bf16 v[180:183], a[164:167], v[104:107], v[180:183]
  ds_read_b64_tr_b16 a[136:137], v54 offset:49152
  v_mfma_f32_16x16x32_bf16 v[184:187], a[168:171], v[104:107], v[184:187]
  ds_read_b64_tr_b16 a[138:139], v54 offset:51200
  v_mfma_f32_16x16x32_bf16 v[188:191], a[172:175], v[104:107], v[188:191]
  buffer_load_dwordx4 v[104:107], v3, s[36:39], s21 offen offset:2048 sc1
  v_mfma_f32_16x16x32_bf16 v[192:195], a[160:163], v[108:111], v[192:195]
  ds_read_b64_tr_b16 a[140:141], v55 offset:49152
  v_mfma_f32_16x16x32_bf16 v[196:199], a[164:167], v[108:111], v[196:199]
  v_mfma_f32_16x16x32_bf16 v[200:203], a[168:171], v[108:111], v[200:203]
  ds_read_b64_tr_b16 a[142:143], v55 offset:51200
  v_mfma_f32_16x16x32_bf16 v[204:207], a[172:175], v[108:111], v[204:207]
  buffer_load_dwordx4 v[108:111], v4, s[36:39], s21 offen offset:2048 sc1
  s_waitcnt vmcnt(12) lgkmcnt(8)
  v_mfma_f32_16x16x32_bf16 v[160:163], a[176:179], v[112:115], v[160:163]
  ds_read_b64_tr_b16 a[144:145], v52 offset:57344
  v_mfma_f32_16x16x32_bf16 v[164:167], a[180:183], v[112:115], v[164:167]
  ds_read_b64_tr_b16 a[146:147], v52 offset:59392
  v_mfma_f32_16x16x32_bf16 v[168:171], a[184:187], v[112:115], v[168:171]
  ds_read_b64_tr_b16 a[148:149], v53 offset:57344
  v_mfma_f32_16x16x32_bf16 v[172:175], a[188:191], v[112:115], v[172:175]
  v_mfma_f32_16x16x32_bf16 v[176:179], a[176:179], v[116:119], v[176:179]
  ds_read_b64_tr_b16 a[150:151], v53 offset:59392
  v_mfma_f32_16x16x32_bf16 v[180:183], a[180:183], v[116:119], v[180:183]
  ds_read_b64_tr_b16 a[152:153], v54 offset:57344
  v_mfma_f32_16x16x32_bf16 v[184:187], a[184:187], v[116:119], v[184:187]
  ds_read_b64_tr_b16 a[154:155], v54 offset:59392
  v_mfma_f32_16x16x32_bf16 v[188:191], a[188:191], v[116:119], v[188:191]
  v_mfma_f32_16x16x32_bf16 v[192:195], a[176:179], v[120:123], v[192:195]
  ds_read_b64_tr_b16 a[156:157], v55 offset:57344
  v_mfma_f32_16x16x32_bf16 v[196:199], a[180:183], v[120:123], v[196:199]
  v_mfma_f32_16x16x32_bf16 v[200:203], a[184:187], v[120:123], v[200:203]
  ds_read_b64_tr_b16 a[158:159], v55 offset:59392
  v_mfma_f32_16x16x32_bf16 v[204:207], a[188:191], v[120:123], v[204:207]
  s_waitcnt vmcnt(9) lgkmcnt(8)
  v_mfma_f32_16x16x32_bf16 v[160:163], a[128:131], v[64:67], v[160:163]
  v_add_u32 v52, 0x18000, v52
  v_add_u32 v53, 0x18000, v53
  v_add_u32 v54, 0x18000, v54
  v_add_u32 v55, 0x18000, v55
  ds_read_b64_tr_b16 a[160:161], v52 offset:24576
  v_mfma_f32_16x16x32_bf16 v[164:167], a[132:135], v[64:67], v[164:167]
  ds_read_b64_tr_b16 a[162:163], v52 offset:26624
  buffer_load_dword v61, v124, s[36:39], s54 offen offset:2048 sc1
  v_mfma_f32_16x16x32_bf16 v[168:171], a[136:139], v[64:67], v[168:171]
  ds_read_b64_tr_b16 a[164:165], v53 offset:24576
  v_mfma_f32_16x16x32_bf16 v[172:175], a[140:143], v[64:67], v[172:175]
  v_mfma_f32_16x16x32_bf16 v[176:179], a[128:131], v[68:71], v[176:179]
  ds_read_b64_tr_b16 a[166:167], v53 offset:26624
  v_mfma_f32_16x16x32_bf16 v[180:183], a[132:135], v[68:71], v[180:183]
  ds_read_b64_tr_b16 a[168:169], v54 offset:24576
  v_mfma_f32_16x16x32_bf16 v[184:187], a[136:139], v[68:71], v[184:187]
  ds_read_b64_tr_b16 a[170:171], v54 offset:26624
  v_mfma_f32_16x16x32_bf16 v[188:191], a[140:143], v[68:71], v[188:191]
  v_mfma_f32_16x16x32_bf16 v[192:195], a[128:131], v[72:75], v[192:195]
  ds_read_b64_tr_b16 a[172:173], v55 offset:24576
  v_mfma_f32_16x16x32_bf16 v[196:199], a[132:135], v[72:75], v[196:199]
  v_mfma_f32_16x16x32_bf16 v[200:203], a[136:139], v[72:75], v[200:203]
  ds_read_b64_tr_b16 a[174:175], v55 offset:26624
  v_mfma_f32_16x16x32_bf16 v[204:207], a[140:143], v[72:75], v[204:207]
  s_waitcnt vmcnt(7) lgkmcnt(8)
  v_mfma_f32_16x16x32_bf16 v[160:163], a[144:147], v[76:79], v[160:163]
  ds_read_b64_tr_b16 a[176:177], v52 offset:32768
  v_mfma_f32_16x16x32_bf16 v[164:167], a[148:151], v[76:79], v[164:167]
  ds_read_b64_tr_b16 a[178:179], v52 offset:34816
  v_mfma_f32_16x16x32_bf16 v[168:171], a[152:155], v[76:79], v[168:171]
  ds_read_b64_tr_b16 a[180:181], v53 offset:32768
  v_mfma_f32_16x16x32_bf16 v[172:175], a[156:159], v[76:79], v[172:175]
  v_mfma_f32_16x16x32_bf16 v[176:179], a[144:147], v[80:83], v[176:179]
  ds_read_b64_tr_b16 a[182:183], v53 offset:34816
  v_mfma_f32_16x16x32_bf16 v[180:183], a[148:151], v[80:83], v[180:183]
  ds_read_b64_tr_b16 a[184:185], v54 offset:32768
  v_mfma_f32_16x16x32_bf16 v[184:187], a[152:155], v[80:83], v[184:187]
  ds_read_b64_tr_b16 a[186:187], v54 offset:34816
  v_mfma_f32_16x16x32_bf16 v[188:191], a[156:159], v[80:83], v[188:191]
  v_mfma_f32_16x16x32_bf16 v[192:195], a[144:147], v[84:87], v[192:195]
  ds_read_b64_tr_b16 a[188:189], v55 offset:32768
  v_mfma_f32_16x16x32_bf16 v[196:199], a[148:151], v[84:87], v[196:199]
  v_mfma_f32_16x16x32_bf16 v[200:203], a[152:155], v[84:87], v[200:203]
  ds_read_b64_tr_b16 a[190:191], v55 offset:34816
  v_mfma_f32_16x16x32_bf16 v[204:207], a[156:159], v[84:87], v[204:207]
  s_waitcnt vmcnt(63) lgkmcnt(0)
  s_barrier
  s_waitcnt vmcnt(4)
  v_mfma_f32_16x16x32_bf16 v[160:163], a[160:163], v[88:91], v[160:163]
  v_add_u32 v56, 0x18000, v56
  v_add_u32 v57, 0x18000, v57
  v_add_u32 v58, 0x18000, v58
  v_add_u32 v59, 0x18000, v59
  ds_read_b64_tr_b16 a[128:129], v56 offset:40960
  v_mfma_f32_16x16x32_bf16 v[164:167], a[164:167], v[88:91], v[164:167]
  ds_read_b64_tr_b16 a[130:131], v56 offset:41472
  v_mfma_f32_16x16x32_bf16 v[168:171], a[168:171], v[88:91], v[168:171]
  ds_read_b64_tr_b16 a[132:133], v57 offset:40960
  v_mfma_f32_16x16x32_bf16 v[172:175], a[172:175], v[88:91], v[172:175]
  v_mfma_f32_16x16x32_bf16 v[176:179], a[160:163], v[92:95], v[176:179]
  ds_read_b64_tr_b16 a[134:135], v57 offset:41472
  v_mfma_f32_16x16x32_bf16 v[180:183], a[164:167], v[92:95], v[180:183]
  ds_read_b64_tr_b16 a[136:137], v58 offset:40960
  v_mfma_f32_16x16x32_bf16 v[184:187], a[168:171], v[92:95], v[184:187]
  ds_read_b64_tr_b16 a[138:139], v58 offset:41472
  v_mfma_f32_16x16x32_bf16 v[188:191], a[172:175], v[92:95], v[188:191]
  v_mfma_f32_16x16x32_bf16 v[192:195], a[160:163], v[96:99], v[192:195]
  ds_read_b64_tr_b16 a[140:141], v59 offset:40960
  v_mfma_f32_16x16x32_bf16 v[196:199], a[164:167], v[96:99], v[196:199]
  v_mfma_f32_16x16x32_bf16 v[200:203], a[168:171], v[96:99], v[200:203]
  ds_read_b64_tr_b16 a[142:143], v59 offset:41472
  v_mfma_f32_16x16x32_bf16 v[204:207], a[172:175], v[96:99], v[204:207]
  s_waitcnt vmcnt(1) lgkmcnt(8)
  v_mfma_f32_16x16x32_bf16 v[160:163], a[176:179], v[100:103], v[160:163]
  ds_read_b64_tr_b16 a[144:145], v56 offset:49152
  v_mfma_f32_16x16x32_bf16 v[164:167], a[180:183], v[100:103], v[164:167]
  ds_read_b64_tr_b16 a[146:147], v56 offset:49664
  v_mfma_f32_16x16x32_bf16 v[168:171], a[184:187], v[100:103], v[168:171]
  ds_read_b64_tr_b16 a[148:149], v57 offset:49152
  v_mfma_f32_16x16x32_bf16 v[172:175], a[188:191], v[100:103], v[172:175]
  v_mfma_f32_16x16x32_bf16 v[176:179], a[176:179], v[104:107], v[176:179]
  ds_read_b64_tr_b16 a[150:151], v57 offset:49664
  v_mfma_f32_16x16x32_bf16 v[180:183], a[180:183], v[104:107], v[180:183]
  ds_read_b64_tr_b16 a[152:153], v58 offset:49152
  v_mfma_f32_16x16x32_bf16 v[184:187], a[184:187], v[104:107], v[184:187]
  ds_read_b64_tr_b16 a[154:155], v58 offset:49664
  v_mfma_f32_16x16x32_bf16 v[188:191], a[188:191], v[104:107], v[188:191]
  v_mfma_f32_16x16x32_bf16 v[192:195], a[176:179], v[108:111], v[192:195]
  ds_read_b64_tr_b16 a[156:157], v59 offset:49152
  v_mfma_f32_16x16x32_bf16 v[196:199], a[180:183], v[108:111], v[196:199]
  v_mfma_f32_16x16x32_bf16 v[200:203], a[184:187], v[108:111], v[200:203]
  ds_read_b64_tr_b16 a[158:159], v59 offset:49664
  v_mfma_f32_16x16x32_bf16 v[204:207], a[188:191], v[108:111], v[204:207]
  v_add_u32 v2, s79, v2
  v_add_u32 v3, s79, v3
  v_add_u32 v4, s79, v4
  s_waitcnt vmcnt(0)
  v_cmp_gt_u32 vcc, s53, v61
  s_nop 0
  s_cmp_eq_u64 vcc, 0
  s_cbranch_scc0 Lslow_19
Lback_20:
  s_waitcnt lgkmcnt(0)
  s_barrier
  buffer_load_dwordx4 a[0:3], v2, s[36:39], s10 offen offset:0 sc1
  buffer_load_dwordx4 a[4:7], v3, s[36:39], s10 offen offset:0 sc1
  buffer_load_dwordx4 a[8:11], v4, s[36:39], s10 offen offset:0 sc1
  buffer_load_dwordx4 a[12:15], v2, s[36:39], s10 offen offset:1024 sc1
  buffer_load_dwordx4 a[16:19], v3, s[36:39], s10 offen offset:1024 sc1
  buffer_load_dwordx4 a[20:23], v4, s[36:39], s10 offen offset:1024 sc1
  buffer_load_dwordx4 a[24:27], v2, s[36:39], s11 offen offset:0 sc1
  buffer_load_dwordx4 a[28:31], v3, s[36:39], s11 offen offset:0 sc1
  buffer_load_dwordx4 a[32:35], v4, s[36:39], s11 offen offset:0 sc1
  ds_write_b128 v9, v[168:171] offset:0
  ds_write_b128 v9, v[172:175] offset:1024
  ds_write_b128 v9, v[184:187] offset:2048
  ds_write_b128 v9, v[188:191] offset:3072
  ds_write_b128 v9, v[200:203] offset:4096
  ds_write_b128 v9, v[204:207] offset:5120
  v_lshlrev_b32 v40, 16, v24
  v_and_b32 v41, 0xffff0000, v24
  v_lshlrev_b32 v42, 16, v25
  v_and_b32 v43, 0xffff0000, v25
  v_lshlrev_b32 v44, 16, v26
  v_and_b32 v45, 0xffff0000, v26
  v_lshlrev_b32 v46, 16, v27
  v_and_b32 v47, 0xffff0000, v27
  v_permlane16_swap_b32 v12, v14
  v_permlane16_swap_b32 v13, v15
  v_permlane16_swap_b32 v16, v18
  v_permlane16_swap_b32 v17, v19
  v_permlane16_swap_b32 v20, v22
  v_permlane16_swap_b32 v21, v23
  v_pk_add_f32 v[160:161], v[160:161], v[40:41]
  v_pk_add_f32 v[162:163], v[162:163], v[42:43]
  v_pk_add_f32 v[164:165], v[164:165], v[44:45]
  v_pk_add_f32 v[166:167], v[166:167], v[46:47]
  v_pk_add_f32 v[176:177], v[176:177], v[40:41]
  v_pk_add_f32 v[178:179], v[178:179], v[42:43]
  v_pk_add_f32 v[180:181], v[180:181], v[44:45]
  v_pk_add_f32 v[182:183], v[182:183], v[46:47]
  v_pk_add_f32 v[192:193], v[192:193], v[40:41]
  v_pk_add_f32 v[194:195], v[194:195], v[42:43]
  v_pk_add_f32 v[196:197], v[196:197], v[44:45]
  v_pk_add_f32 v[198:199], v[198:199], v[46:47]
  s_waitcnt lgkmcnt(0)
  s_barrier
  ds_read_b128 v[64:67], v10 offset:0
  ds_read_b128 v[68:71], v10 offset:1024
  ds_read_b128 v[72:75], v10 offset:2048
  ds_read_b128 v[76:79], v10 offset:3072
  ds_read_b128 v[80:83], v10 offset:4096
  ds_read_b128 v[84:87], v10 offset:5120
  buffer_load_dwordx4 a[36:39], v2, s[36:39], s11 offen offset:1024 sc1
  buffer_load_dwordx4 a[40:43], v3, s[36:39], s11 offen offset:1024 sc1
  buffer_load_dwordx4 a[44:47], v4, s[36:39], s11 offen offset:1024 sc1
  buffer_load_dwordx4 a[48:51], v2, s[36:39], s12 offen offset:0 sc1
  buffer_load_dwordx4 a[52:55], v3, s[36:39], s12 offen offset:0 sc1
  buffer_load_dwordx4 a[56:59], v4, s[36:39], s12 offen offset:0 sc1
  buffer_load_dwordx4 a[60:63], v2, s[36:39], s12 offen offset:1024 sc1
  buffer_load_dwordx4 a[64:67], v3, s[36:39], s12 offen offset:1024 sc1
  buffer_load_dwordx4 a[68:71], v4, s[36:39], s12 offen offset:1024 sc1
  v_lshlrev_b32 v88, 16, v12
  v_and_b32 v89, 0xffff0000, v12
  v_lshlrev_b32 v90, 16, v13
  v_and_b32 v91, 0xffff0000, v13
  v_lshlrev_b32 v92, 16, v14
  v_and_b32 v93, 0xffff0000, v14
  v_lshlrev_b32 v94, 16, v15
  v_and_b32 v95, 0xffff0000, v15
  v_lshlrev_b32 v96, 16, v16
  v_and_b32 v97, 0xffff0000, v16
  v_lshlrev_b32 v98, 16, v17
  v_and_b32 v99, 0xffff0000, v17
  v_lshlrev_b32 v100, 16, v18
  v_and_b32 v101, 0xffff0000, v18
  v_lshlrev_b32 v102, 16, v19
  v_and_b32 v103, 0xffff0000, v19
  v_lshlrev_b32 v104, 16, v20
  v_and_b32 v105, 0xffff0000, v20
  v_lshlrev_b32 v106, 16, v21
  v_and_b32 v107, 0xffff0000, v21
  v_lshlrev_b32 v108, 16, v22
  v_and_b32 v109, 0xffff0000, v22
  v_lshlrev_b32 v110, 16, v23
  v_and_b32 v111, 0xffff0000, v23
  s_waitcnt lgkmcnt(0)
  s_nop 0
  v_pk_add_f32 v[160:161], v[160:161], v[64:65]
  v_pk_add_f32 v[162:163], v[162:163], v[66:67]
  v_pk_add_f32 v[164:165], v[164:165], v[68:69]
  v_pk_add_f32 v[166:167], v[166:167], v[70:71]
  v_pk_add_f32 v[176:177], v[176:177], v[72:73]
  v_pk_add_f32 v[178:179], v[178:179], v[74:75]
  v_pk_add_f32 v[180:181], v[180:181], v[76:77]
  v_pk_add_f32 v[182:183], v[182:183], v[78:79]
  v_pk_add_f32 v[192:193], v[192:193], v[80:81]
  v_pk_add_f32 v[194:195], v[194:195], v[82:83]
  v_pk_add_f32 v[196:197], v[196:197], v[84:85]
  v_pk_add_f32 v[198:199], v[198:199], v[86:87]
  v_pk_mul_f32 v[168:169], v[160:161], s[80:81] op_sel_hi:[1,0] neg_lo:[1,0] neg_hi:[1,0]
  v_pk_mul_f32 v[170:171], v[162:163], s[80:81] op_sel_hi:[1,0] neg_lo:[1,0] neg_hi:[1,0]
  v_pk_mul_f32 v[172:173], v[164:165], s[80:81] op_sel_hi:[1,0] neg_lo:[1,0] neg_hi:[1,0]
  v_pk_mul_f32 v[174:175], v[166:167], s[80:81] op_sel_hi:[1,0] neg_lo:[1,0] neg_hi:[1,0]
  v_pk_mul_f32 v[184:185], v[176:177], s[80:81] op_sel_hi:[1,0] neg_lo:[1,0] neg_hi:[1,0]
  v_pk_mul_f32 v[186:187], v[178:179], s[80:81] op_sel_hi:[1,0] neg_lo:[1,0] neg_hi:[1,0]
  v_pk_mul_f32 v[188:189], v[180:181], s[80:81] op_sel_hi:[1,0] neg_lo:[1,0] neg_hi:[1,0]
  v_pk_mul_f32 v[190:191], v[182:183], s[80:81] op_sel_hi:[1,0] neg_lo:[1,0] neg_hi:[1,0]
  v_pk_mul_f32 v[200:201], v[192:193], s[80:81] op_sel_hi:[1,0] neg_lo:[1,0] neg_hi:[1,0]
  v_pk_mul_f32 v[202:203], v[194:195], s[80:81] op_sel_hi:[1,0] neg_lo:[1,0] neg_hi:[1,0]
  v_pk_mul_f32 v[204:205], v[196:197], s[80:81] op_sel_hi:[1,0] neg_lo:[1,0] neg_hi:[1,0]
  v_pk_mul_f32 v[206:207], v[198:199], s[80:81] op_sel_hi:[1,0] neg_lo:[1,0] neg_hi:[1,0]
  v_exp_f32 v168, v168
  v_exp_f32 v169, v169
  v_exp_f32 v170, v170
  v_exp_f32 v171, v171
  v_exp_f32 v172, v172
  v_exp_f32 v173, v173
  v_exp_f32 v174, v174
  v_exp_f32 v175, v175
  v_exp_f32 v184, v184
  v_exp_f32 v185, v185
  v_exp_f32 v186, v186
  v_exp_f32 v187, v187
  v_exp_f32 v188, v188
  v_exp_f32 v189, v189
  v_exp_f32 v190, v190
  v_exp_f32 v191, v191
  v_exp_f32 v200, v200
  v_exp_f32 v201, v201
  v_exp_f32 v202, v202
  v_exp_f32 v203, v203
  v_exp_f32 v204, v204
  v_exp_f32 v205, v205
  v_exp_f32 v206, v206
  v_exp_f32 v207, v207
  v_pk_add_f32 v[168:169], v[168:169], s[90:91] op_sel_hi:[1,0]
  v_pk_add_f32 v[170:171], v[170:171], s[90:91] op_sel_hi:[1,0]
  v_pk_add_f32 v[172:173], v[172:173], s[90:91] op_sel_hi:[1,0]
  v_pk_add_f32 v[174:175], v[174:175], s[90:91] op_sel_hi:[1,0]
  v_pk_add_f32 v[184:185], v[184:185], s[90:91] op_sel_hi:[1,0]
  v_pk_add_f32 v[186:187], v[186:187], s[90:91] op_sel_hi:[1,0]
  v_pk_add_f32 v[188:189], v[188:189], s[90:91] op_sel_hi:[1,0]
  v_pk_add_f32 v[190:191], v[190:191], s[90:91] op_sel_hi:[1,0]
  v_pk_add_f32 v[200:201], v[200:201], s[90:91] op_sel_hi:[1,0]
  v_pk_add_f32 v[202:203], v[202:203], s[90:91] op_sel_hi:[1,0]
  v_pk_add_f32 v[204:205], v[204:205], s[90:91] op_sel_hi:[1,0]
  v_pk_add_f32 v[206:207], v[206:207], s[90:91] op_sel_hi:[1,0]
  v_rcp_f32 v168, v168
  v_rcp_f32 v169, v169
  v_rcp_f32 v170, v170
  v_rcp_f32 v171, v171
  v_rcp_f32 v172, v172
  v_rcp_f32 v173, v173
  v_rcp_f32 v174, v174
  v_rcp_f32 v175, v175
  v_rcp_f32 v184, v184
  v_rcp_f32 v185, v185
  v_rcp_f32 v186, v186
  v_rcp_f32 v187, v187
  v_rcp_f32 v188, v188
  v_rcp_f32 v189, v189
  v_rcp_f32 v190, v190
  v_rcp_f32 v191, v191
  v_rcp_f32 v200, v200
  v_rcp_f32 v201, v201
  v_rcp_f32 v202, v202
  v_rcp_f32 v203, v203
  v_rcp_f32 v204, v204
  v_rcp_f32 v205, v205
  v_rcp_f32 v206, v206
  v_rcp_f32 v207, v207
  v_pk_mul_f32 v[160:161], v[160:161], v[168:169]
  v_pk_mul_f32 v[162:163], v[162:163], v[170:171]
  v_pk_mul_f32 v[164:165], v[164:165], v[172:173]
  v_pk_mul_f32 v[166:167], v[166:167], v[174:175]
  v_pk_mul_f32 v[176:177], v[176:177], v[184:185]
  v_pk_mul_f32 v[178:179], v[178:179], v[186:187]
  v_pk_mul_f32 v[180:181], v[180:181], v[188:189]
  v_pk_mul_f32 v[182:183], v[182:183], v[190:191]
  v_pk_mul_f32 v[192:193], v[192:193], v[200:201]
  v_pk_mul_f32 v[194:195], v[194:195], v[202:203]
  v_pk_mul_f32 v[196:197], v[196:197], v[204:205]
  v_pk_mul_f32 v[198:199], v[198:199], v[206:207]
  s_waitcnt vmcnt(15)
  v_mfma_f32_16x16x32_bf16 v[208:211], a[128:131], a[0:3], 0
  v_add_u32 v56, 0xfffec000, v56
  v_add_u32 v57, 0xfffec000, v57
  v_add_u32 v58, 0xfffec000, v58
  v_add_u32 v59, 0xfffec000, v59
  ds_read_b64_tr_b16 a[160:161], v56 offset:49152
  v_mfma_f32_16x16x32_bf16 v[212:215], a[132:135], a[0:3], 0
  ds_read_b64_tr_b16 a[162:163], v56 offset:49664
  buffer_load_dwordx4 a[72:75], v2, s[36:39], s13 offen offset:0 sc1
  v_mfma_f32_16x16x32_bf16 v[216:219], a[136:139], a[0:3], 0
  ds_read_b64_tr_b16 a[164:165], v57 offset:49152
  v_mfma_f32_16x16x32_bf16 v[220:223], a[140:143], a[0:3], 0
  buffer_load_dwordx4 a[76:79], v3, s[36:39], s13 offen offset:0 sc1
  v_mfma_f32_16x16x32_bf16 v[224:227], a[128:131], a[4:7], 0
  ds_read_b64_tr_b16 a[166:167], v57 offset:49664
  v_mfma_f32_16x16x32_bf16 v[228:231], a[132:135], a[4:7], 0
  ds_read_b64_tr_b16 a[168:169], v58 offset:49152
  buffer_load_dwordx4 a[80:83], v4, s[36:39], s13 offen offset:0 sc1
  v_mfma_f32_16x16x32_bf16 v[232:235], a[136:139], a[4:7], 0
  ds_read_b64_tr_b16 a[170:171], v58 offset:49664
  v_mfma_f32_16x16x32_bf16 v[236:239], a[140:143], a[4:7], 0
  buffer_load_dwordx4 a[84:87], v2, s[36:39], s13 offen offset:1024 sc1
  v_mfma_f32_16x16x32_bf16 v[240:243], a[128:131], a[8:11], 0
  ds_read_b64_tr_b16 a[172:173], v59 offset:49152
  v_mfma_f32_16x16x32_bf16 v[244:247], a[132:135], a[8:11], 0
  buffer_load_dwordx4 a[88:91], v3, s[36:39], s13 offen offset:1024 sc1
  v_mfma_f32_16x16x32_bf16 v[248:251], a[136:139], a[8:11], 0
  ds_read_b64_tr_b16 a[174:175], v59 offset:49664
  v_mfma_f32_16x16x32_bf16 v[252:255], a[140:143], a[8:11], 0
  buffer_load_dwordx4 a[92:95], v4, s[36:39], s13 offen offset:1024 sc1
  s_waitcnt vmcnt(18) lgkmcnt(8)
  v_mfma_f32_16x16x32_bf16 v[208:211], a[144:147], a[12:15], v[208:211]
  ds_read_b64_tr_b16 a[176:177], v56 offset:57344
  v_mfma_f32_16x16x32_bf16 v[212:215], a[148:151], a[12:15], v[212:215]
  ds_read_b64_tr_b16 a[178:179], v56 offset:57856
  buffer_load_dwordx4 a[96:99], v2, s[36:39], s16 offen offset:0 sc1
  v_mfma_f32_16x16x32_bf16 v[216:219], a[152:155], a[12:15], v[216:219]
  ds_read_b64_tr_b16 a[180:181], v57 offset:57344
  v_mfma_f32_16x16x32_bf16 v[220:223], a[156:159], a[12:15], v[220:223]
  buffer_load_dwordx4 a[100:103], v3, s[36:39], s16 offen offset:0 sc1
  v_mfma_f32_16x16x32_bf16 v[224:227], a[144:147], a[16:19], v[224:227]
  ds_read_b64_tr_b16 a[182:183], v57 offset:57856
  v_mfma_f32_16x16x32_bf16 v[228:231], a[148:151], a[16:19], v[228:231]
  ds_read_b64_tr_b16 a[184:185], v58 offset:57344
  buffer_load_dwordx4 a[104:107], v4, s[36:39], s16 offen offset:0 sc1
  v_mfma_f32_16x16x32_bf16 v[232:235], a[152:155], a[16:19], v[232:235]
  ds_read_b64_tr_b16 a[186:187], v58 offset:57856
  v_mfma_f32_16x16x32_bf16 v[236:239], a[156:159], a[16:19], v[236:239]
  buffer_load_dwordx4 a[108:111], v2, s[36:39], s16 offen offset:1024 sc1
  v_mfma_f32_16x16x32_bf16 v[240:243], a[144:147], a[20:23], v[240:243]
  ds_read_b64_tr_b16 a[188:189], v59 offset:57344
  v_mfma_f32_16x16x32_bf16 v[244:247], a[148:151], a[20:23], v[244:247]
  buffer_load_dwordx4 a[112:115], v3, s[36:39], s16 offen offset:1024 sc1
  v_mfma_f32_16x16x32_bf16 v[248:251], a[152:155], a[20:23], v[248:251]
  ds_read_b64_tr_b16 a[190:191], v59 offset:57856
  v_mfma_f32_16x16x32_bf16 v[252:255], a[156:159], a[20:23], v[252:255]
  buffer_load_dwordx4 a[116:119], v4, s[36:39], s16 offen offset:1024 sc1
  s_waitcnt vmcnt(21) lgkmcnt(8)
  v_mfma_f32_16x16x32_bf16 v[208:211], a[160:163], a[24:27], v[208:211]
  v_add_u32 v56, 0x10000, v56
  v_add_u32 v57, 0x10000, v57
  v_add_u32 v58, 0x10000, v58
  v_add_u32 v59, 0x10000, v59
  ds_read_b64_tr_b16 a[128:129], v56 offset:0
  v_mfma_f32_16x16x32_bf16 v[212:215], a[164:167], a[24:27], v[212:215]
  ds_read_b64_tr_b16 a[130:131], v56 offset:512
  v_mfma_f32_16x16x32_bf16 v[216:219], a[168:171], a[24:27], v[216:219]
  ds_read_b64_tr_b16 a[132:133], v57 offset:0
  v_mfma_f32_16x16x32_bf16 v[220:223], a[172:175], a[24:27], v[220:223]
  v_mfma_f32_16x16x32_bf16 v[224:227], a[160:163], a[28:31], v[224:227]
  ds_read_b64_tr_b16 a[134:135], v57 offset:512
  v_mfma_f32_16x16x32_bf16 v[228:231], a[164:167], a[28:31], v[228:231]
  ds_read_b64_tr_b16 a[136:137], v58 offset:0
  v_mfma_f32_16x16x32_bf16 v[232:235], a[168:171], a[28:31], v[232:235]
  ds_read_b64_tr_b16 a[138:139], v58 offset:512
  v_mfma_f32_16x16x32_bf16 v[236:239], a[172:175], a[28:31], v[236:239]
  v_mfma_f32_16x16x32_bf16 v[240:243], a[160:163], a[32:35], v[240:243]
  ds_read_b64_tr_b16 a[140:141], v59 offset:0
  v_mfma_f32_16x16x32_bf16 v[244:247], a[164:167], a[32:35], v[244:247]
  v_mfma_f32_16x16x32_bf16 v[248:251], a[168:171], a[32:35], v[248:251]
  ds_read_b64_tr_b16 a[142:143], v59 offset:512
  v_mfma_f32_16x16x32_bf16 v[252:255], a[172:175], a[32:35], v[252:255]
  s_waitcnt vmcnt(18) lgkmcnt(8)
  v_mfma_f32_16x16x32_bf16 v[208:211], a[176:179], a[36:39], v[208:211]
  ds_read_b64_tr_b16 a[144:145], v56 offset:8192
  v_mfma_f32_16x16x32_bf16 v[212:215], a[180:183], a[36:39], v[212:215]
  ds_read_b64_tr_b16 a[146:147], v56 offset:8704
  v_mfma_f32_16x16x32_bf16 v[216:219], a[184:187], a[36:39], v[216:219]
  ds_read_b64_tr_b16 a[148:149], v57 offset:8192
  v_mfma_f32_16x16x32_bf16 v[220:223], a[188:191], a[36:39], v[220:223]
  v_mfma_f32_16x16x32_bf16 v[224:227], a[176:179], a[40:43], v[224:227]
  ds_read_b64_tr_b16 a[150:151], v57 offset:8704
  v_mfma_f32_16x16x32_bf16 v[228:231], a[180:183], a[40:43], v[228:231]
  ds_read_b64_tr_b16 a[152:153], v58 offset:8192
  v_mfma_f32_16x16x32_bf16 v[232:235], a[184:187], a[40:43], v[232:235]
  ds_read_b64_tr_b16 a[154:155], v58 offset:8704
  v_mfma_f32_16x16x32_bf16 v[236:239], a[188:191], a[40:43], v[236:239]
  v_mfma_f32_16x16x32_bf16 v[240:243], a[176:179], a[44:47], v[240:243]
  ds_read_b64_tr_b16 a[156:157], v59 offset:8192
  v_mfma_f32_16x16x32_bf16 v[244:247], a[180:183], a[44:47], v[244:247]
  v_mfma_f32_16x16x32_bf16 v[248:251], a[184:187], a[44:47], v[248:251]
  ds_read_b64_tr_b16 a[158:159], v59 offset:8704
  v_mfma_f32_16x16x32_bf16 v[252:255], a[188:191], a[44:47], v[252:255]
  s_waitcnt vmcnt(15) lgkmcnt(8)
  v_mfma_f32_16x16x32_bf16 v[208:211], a[128:131], a[48:51], v[208:211]
  ds_read_b64_tr_b16 a[160:161], v56 offset:16384
  v_mfma_f32_16x16x32_bf16 v[212:215], a[132:135], a[48:51], v[212:215]
  ds_read_b64_tr_b16 a[162:163], v56 offset:16896
  v_mfma_f32_16x16x32_bf16 v[216:219], a[136:139], a[48:51], v[216:219]
  ds_read_b64_tr_b16 a[164:165], v57 offset:16384
  v_mfma_f32_16x16x32_bf16 v[220:223], a[140:143], a[48:51], v[220:223]
  v_mfma_f32_16x16x32_bf16 v[224:227], a[128:131], a[52:55], v[224:227]
  ds_read_b64_tr_b16 a[166:167], v57 offset:16896
  v_mfma_f32_16x16x32_bf16 v[228:231], a[132:135], a[52:55], v[228:231]
  ds_read_b64_tr_b16 a[168:169], v58 offset:16384
  v_mfma_f32_16x16x32_bf16 v[232:235], a[136:139], a[52:55], v[232:235]
  ds_read_b64_tr_b16 a[170:171], v58 offset:16896
  v_mfma_f32_16x16x32_bf16 v[236:239], a[140:143], a[52:55], v[236:239]
  v_mfma_f32_16x16x32_bf16 v[240:243], a[128:131], a[56:59], v[240:243]
  ds_read_b64_tr_b16 a[172:173], v59 offset:16384
  v_mfma_f32_16x16x32_bf16 v[244:247], a[132:135], a[56:59], v[244:247]
  v_mfma_f32_16x16x32_bf16 v[248:251], a[136:139], a[56:59], v[248:251]
  ds_read_b64_tr_b16 a[174:175], v59 offset:16896
  v_mfma_f32_16x16x32_bf16 v[252:255], a[140:143], a[56:59], v[252:255]
  s_waitcnt vmcnt(12) lgkmcnt(8)
  v_mfma_f32_16x16x32_bf16 v[208:211], a[144:147], a[60:63], v[208:211]
  ds_read_b64_tr_b16 a[176:177], v56 offset:24576
  v_mfma_f32_16x16x32_bf16 v[212:215], a[148:151], a[60:63], v[212:215]
  ds_read_b64_tr_b16 a[178:179], v56 offset:25088
  v_mfma_f32_16x16x32_bf16 v[216:219], a[152:155], a[60:63], v[216:219]
  ds_read_b64_tr_b16 a[180:181], v57 offset:24576
  v_mfma_f32_16x16x32_bf16 v[220:223], a[156:159], a[60:63], v[220:223]
  v_mfma_f32_16x16x32_bf16 v[224:227], a[144:147], a[64:67], v[224:227]
  ds_read_b64_tr_b16 a[182:183], v57 offset:25088
  v_mfma_f32_16x16x32_bf16 v[228:231], a[148:151], a[64:67], v[228:231]
  ds_read_b64_tr_b16 a[184:185], v58 offset:24576
  v_mfma_f32_16x16x32_bf16 v[232:235], a[152:155], a[64:67], v[232:235]
  ds_read_b64_tr_b16 a[186:187], v58 offset:25088
  v_mfma_f32_16x16x32_bf16 v[236:239], a[156:159], a[64:67], v[236:239]
  v_mfma_f32_16x16x32_bf16 v[240:243], a[144:147], a[68:71], v[240:243]
  ds_read_b64_tr_b16 a[188:189], v59 offset:24576
  v_mfma_f32_16x16x32_bf16 v[244:247], a[148:151], a[68:71], v[244:247]
  v_mfma_f32_16x16x32_bf16 v[248:251], a[152:155], a[68:71], v[248:251]
  ds_read_b64_tr_b16 a[190:191], v59 offset:25088
  v_mfma_f32_16x16x32_bf16 v[252:255], a[156:159], a[68:71], v[252:255]
  ds_read_b64_tr_b16 a[128:129], v56 offset:32768
  ds_read_b64_tr_b16 a[130:131], v56 offset:33280
  ds_read_b64_tr_b16 a[132:133], v57 offset:32768
  ds_read_b64_tr_b16 a[134:135], v57 offset:33280
  ds_read_b64_tr_b16 a[136:137], v58 offset:32768
  ds_read_b64_tr_b16 a[138:139], v58 offset:33280
  ds_read_b64_tr_b16 a[140:141], v59 offset:32768
  ds_read_b64_tr_b16 a[142:143], v59 offset:33280
  s_waitcnt lgkmcnt(8) vmcnt(0)
  v_mfma_f32_16x16x32_bf16 v[216:219], a[168:171], a[72:75], v[216:219]
  v_add_u32 v56, 0xfffec000, v56
  v_mfma_f32_16x16x32_bf16 v[220:223], a[172:175], a[72:75], v[220:223]
  v_add_u32 v57, 0xfffec000, v57
  v_mfma_f32_16x16x32_bf16 v[208:211], a[160:163], a[72:75], v[208:211]
  v_add_u32 v58, 0xfffec000, v58
  v_mfma_f32_16x16x32_bf16 v[212:215], a[164:167], a[72:75], v[212:215]
  v_add_u32 v59, 0xfffec000, v59
  v_mfma_f32_16x16x32_bf16 v[216:219], a[184:187], a[84:87], v[216:219]
  ds_read_b64_tr_b16 a[144:145], v56 offset:24576
  v_mfma_f32_16x16x32_bf16 v[220:223], a[188:191], a[84:87], v[220:223]
  ds_read_b64_tr_b16 a[146:147], v56 offset:25088
  v_mfma_f32_16x16x32_bf16 v[208:211], a[176:179], a[84:87], v[208:211]
  ds_read_b64_tr_b16 a[148:149], v57 offset:24576
  ds_read_b64_tr_b16 a[150:151], v57 offset:25088
  ds_read_b64_tr_b16 a[152:153], v58 offset:24576
  ds_read_b64_tr_b16 a[154:155], v58 offset:25088
  ds_read_b64_tr_b16 a[156:157], v59 offset:24576
  ds_read_b64_tr_b16 a[158:159], v59 offset:25088
  v_mfma_f32_16x16x32_bf16 v[212:215], a[180:183], a[84:87], v[212:215]
  s_waitcnt lgkmcnt(8)
  v_mfma_f32_16x16x32_bf16 v[216:219], a[136:139], a[96:99], v[216:219]
  v_mfma_f32_16x16x32_bf16 v[220:223], a[140:143], a[96:99], v[220:223]
  v_mfma_f32_16x16x32_bf16 v[208:211], a[128:131], a[96:99], v[208:211]
  v_mfma_f32_16x16x32_bf16 v[212:215], a[132:135], a[96:99], v[212:215]
  s_waitcnt lgkmcnt(0)
  v_mfma_f32_16x16x32_bf16 v[216:219], a[152:155], a[108:111], v[216:219]
  v_mfma_f32_16x16x32_bf16 v[220:223], a[156:159], a[108:111], v[220:223]
  v_mfma_f32_16x16x32_bf16 v[208:211], a[144:147], a[108:111], v[208:211]
  v_mfma_f32_16x16x32_bf16 v[212:215], a[148:151], a[108:111], v[212:215]
  v_mfma_f32_16x16x32_bf16 v[232:235], a[168:171], a[76:79], v[232:235]
  s_nop 1
  v_mfma_f32_16x16x32_bf16 v[236:239], a[172:175], a[76:79], v[236:239]
  s_nop 1
  v_mfma_f32_16x16x32_bf16 v[224:227], a[160:163], a[76:79], v[224:227]
  ds_write_b128 v28, v[216:219] offset:0
  v_mfma_f32_16x16x32_bf16 v[228:231], a[164:167], a[76:79], v[228:231]
  ds_write_b128 v28, v[220:223] offset:1024
  v_mfma_f32_16x16x32_bf16 v[232:235], a[184:187], a[88:91], v[232:235]
  v_fmac_f32 v88, v160, v208
  v_mfma_f32_16x16x32_bf16 v[236:239], a[188:191], a[88:91], v[236:239]
  v_fmac_f32 v89, v161, v209
  v_mfma_f32_16x16x32_bf16 v[224:227], a[176:179], a[88:91], v[224:227]
  v_fmac_f32 v90, v162, v210
  v_mfma_f32_16x16x32_bf16 v[228:231], a[180:183], a[88:91], v[228:231]
  v_fmac_f32 v91, v163, v211
  v_mfma_f32_16x16x32_bf16 v[232:235], a[136:139], a[100:103], v[232:235]
  v_fmac_f32 v92, v164, v212
  v_mfma_f32_16x16x32_bf16 v[236:239], a[140:143], a[100:103], v[236:239]
  v_fmac_f32 v93, v165, v213
  v_mfma_f32_16x16x32_bf16 v[224:227], a[128:131], a[100:103], v[224:227]
  v_fmac_f32 v94, v166, v214
  v_mfma_f32_16x16x32_bf16 v[228:231], a[132:135], a[100:103], v[228:231]
  v_fmac_f32 v95, v167, v215
  v_mfma_f32_16x16x32_bf16 v[232:235], a[152:155], a[112:115], v[232:235]
  s_waitcnt lgkmcnt(0)
  v_mfma_f32_16x16x32_bf16 v[236:239], a[156:159], a[112:115], v[236:239]
  s_barrier
  v_mfma_f32_16x16x32_bf16 v[224:227], a[144:147], a[112:115], v[224:227]
  ds_read_b128 v[64:67], v29 offset:0
  v_mfma_f32_16x16x32_bf16 v[228:231], a[148:151], a[112:115], v[228:231]
  ds_read_b128 v[68:71], v29 offset:1024
  v_mfma_f32_16x16x32_bf16 v[248:251], a[168:171], a[80:83], v[248:251]
  s_waitcnt lgkmcnt(0)
  v_fmac_f32 v88, v160, v64
  v_mfma_f32_16x16x32_bf16 v[252:255], a[172:175], a[80:83], v[252:255]
  v_fmac_f32 v89, v161, v65
  v_fmac_f32 v90, v162, v66
  v_mfma_f32_16x16x32_bf16 v[240:243], a[160:163], a[80:83], v[240:243]
  v_fmac_f32 v91, v163, v67
  v_fmac_f32 v92, v164, v68
  v_mfma_f32_16x16x32_bf16 v[244:247], a[164:167], a[80:83], v[244:247]
  v_fmac_f32 v93, v165, v69
  v_fmac_f32 v94, v166, v70
  v_mfma_f32_16x16x32_bf16 v[248:251], a[184:187], a[92:95], v[248:251]
  v_fmac_f32 v95, v167, v71
  v_cvt_pk_bf16_f32 v12, v88, v89
  v_mfma_f32_16x16x32_bf16 v[252:255], a[188:191], a[92:95], v[252:255]
  v_cvt_pk_bf16_f32 v13, v90, v91
  v_cvt_pk_bf16_f32 v14, v92, v93
  v_mfma_f32_16x16x32_bf16 v[240:243], a[176:179], a[92:95], v[240:243]
  v_cvt_pk_bf16_f32 v15, v94, v95
  v_permlane16_swap_b32 v12, v14
  v_mfma_f32_16x16x32_bf16 v[244:247], a[180:183], a[92:95], v[244:247]
  v_permlane16_swap_b32 v13, v15
  v_mfma_f32_16x16x32_bf16 v[248:251], a[136:139], a[104:107], v[248:251]
  buffer_store_dwordx4 v[12:15], v5, s[48:51], 0 offen sc0 sc1
  ds_write_b128 v28, v[232:235] offset:2048
  v_mfma_f32_16x16x32_bf16 v[252:255], a[140:143], a[104:107], v[252:255]
  ds_write_b128 v28, v[236:239] offset:3072
  v_fmac_f32 v96, v176, v224
  v_mfma_f32_16x16x32_bf16 v[240:243], a[128:131], a[104:107], v[240:243]
  v_fmac_f32 v97, v177, v225
  v_fmac_f32 v98, v178, v226
  v_mfma_f32_16x16x32_bf16 v[244:247], a[132:135], a[104:107], v[244:247]
  v_fmac_f32 v99, v179, v227
  v_fmac_f32 v100, v180, v228
  v_mfma_f32_16x16x32_bf16 v[248:251], a[152:155], a[116:119], v[248:251]
  v_fmac_f32 v101, v181, v229
  v_fmac_f32 v102, v182, v230
  v_mfma_f32_16x16x32_bf16 v[252:255], a[156:159], a[116:119], v[252:255]
  v_fmac_f32 v103, v183, v231
  s_waitcnt lgkmcnt(0)
  v_mfma_f32_16x16x32_bf16 v[240:243], a[144:147], a[116:119], v[240:243]
  s_barrier
  ds_read_b128 v[72:75], v29 offset:2048
  v_mfma_f32_16x16x32_bf16 v[244:247], a[148:151], a[116:119], v[244:247]
  ds_read_b128 v[76:79], v29 offset:3072
  s_waitcnt lgkmcnt(0)
  v_fmac_f32 v96, v176, v72
  v_fmac_f32 v97, v177, v73
  v_fmac_f32 v98, v178, v74
  v_fmac_f32 v99, v179, v75
  v_fmac_f32 v100, v180, v76
  v_fmac_f32 v101, v181, v77
  ds_write_b128 v28, v[248:251] offset:4096
  ds_write_b128 v28, v[252:255] offset:5120
  v_fmac_f32 v102, v182, v78
  v_fmac_f32 v103, v183, v79
  v_cvt_pk_bf16_f32 v16, v96, v97
  v_cvt_pk_bf16_f32 v17, v98, v99
  v_cvt_pk_bf16_f32 v18, v100, v101
  v_cvt_pk_bf16_f32 v19, v102, v103
  s_nop 0
  v_permlane16_swap_b32 v16, v18
  v_permlane16_swap_b32 v17, v19
  buffer_store_dwordx4 v[16:19], v6, s[48:51], 0 offen sc0 sc1
  v_pk_fma_f32 v[104:105], v[192:193], v[240:241], v[104:105]
  v_pk_fma_f32 v[106:107], v[194:195], v[242:243], v[106:107]
  v_pk_fma_f32 v[108:109], v[196:197], v[244:245], v[108:109]
  v_pk_fma_f32 v[110:111], v[198:199], v[246:247], v[110:111]
  s_waitcnt lgkmcnt(0)
  s_barrier
  ds_read_b128 v[80:83], v29 offset:4096
  ds_read_b128 v[84:87], v29 offset:5120
  s_waitcnt lgkmcnt(0)
  s_nop 0
  v_pk_fma_f32 v[104:105], v[192:193], v[80:81], v[104:105]
  v_pk_fma_f32 v[106:107], v[194:195], v[82:83], v[106:107]
  v_pk_fma_f32 v[108:109], v[196:197], v[84:85], v[108:109]
  v_pk_fma_f32 v[110:111], v[198:199], v[86:87], v[110:111]
  v_cvt_pk_bf16_f32 v20, v104, v105
  v_cvt_pk_bf16_f32 v21, v106, v107
  v_cvt_pk_bf16_f32 v22, v108, v109
  v_cvt_pk_bf16_f32 v23, v110, v111
  s_nop 0
  v_permlane16_swap_b32 v20, v22
  v_permlane16_swap_b32 v21, v23
  buffer_store_dwordx4 v[20:23], v7, s[48:51], 0 offen sc0 sc1
LHend:
  s_endpgm
Linit_11:
  s_mov_b32 s70, 10682368
  v_lshl_add_u32 v46, v1, 4, s70
  buffer_store_dwordx4 v[32:35], v46, s[36:39], 0 offen offset:0 sc1
  buffer_store_dwordx4 v[32:35], v46, s[36:39], 0 offen offset:1024 sc1
  buffer_store_dwordx4 v[32:35], v46, s[36:39], 0 offen offset:2048 sc1
  buffer_store_dwordx4 v[32:35], v46, s[36:39], 0 offen offset:3072 sc1
  v_add_u32 v46, 4096, v46
  buffer_store_dwordx4 v[32:35], v46, s[36:39], 0 offen offset:0 sc1
  buffer_store_dwordx4 v[32:35], v46, s[36:39], 0 offen offset:1024 sc1
  s_branch Linitb_12
Lslow_13:
  s_mov_b32 s92, 0
Lslow_13b:
  s_sleep 2
  buffer_load_dword v60, off, s[0:3], s54 sc1
  s_add_u32 s92, s92, 1
  s_waitcnt vmcnt(0)
  v_cmp_gt_u32 vcc, s53, v60
  s_nop 0
  s_cmp_eq_u64 vcc, 0
  s_cbranch_scc1 Lback_14
  s_cmp_lt_u32 s92, 0x8000
  s_cbranch_scc1 Lslow_13b
  s_branch Lback_14
Lslow_15:
  s_mov_b32 s92, 0
Lslow_15b:
  s_sleep 2
  buffer_load_dwordx2 v[60:61], v62, s[36:39], s54 offen sc1
  s_add_u32 s92, s92, 1
  s_waitcnt vmcnt(0)
  v_and_b32 v60, v60, v61
  v_cmp_gt_u32 vcc, s53, v60
  s_nop 0
  s_cmp_eq_u64 vcc, 0
  s_cbranch_scc1 Lback_16
  s_cmp_lt_u32 s92, 0x8000
  s_cbranch_scc1 Lslow_15b
  s_branch Lback_16
Lslow_17:
  s_mov_b32 s92, 0
Lslow_17b:
  s_sleep 2
  buffer_load_dword v60, v124, s[36:39], s54 offen sc1
  s_add_u32 s92, s92, 1
  s_waitcnt vmcnt(0)
  v_cmp_gt_u32 vcc, s53, v60
  s_nop 0
  s_cmp_eq_u64 vcc, 0
  s_cbranch_scc1 Lback_18
  s_cmp_lt_u32 s92, 0x8000
  s_cbranch_scc1 Lslow_17b
  s_branch Lback_18
Lslow_19:
  s_mov_b32 s92, 0
Lslow_19b:
  s_sleep 2
  buffer_load_dword v61, v124, s[36:39], s54 offen offset:2048 sc1
  s_add_u32 s92, s92, 1
  s_waitcnt vmcnt(0)
  v_cmp_gt_u32 vcc, s53, v61
  s_nop 0
  s_cmp_eq_u64 vcc, 0
  s_cbranch_scc1 Lback_20
  s_cmp_lt_u32 s92, 0x8000
  s_cbranch_scc1 Lslow_19b
  s_branch Lback_20
.section .rodata,"a"
.p2align 6
.amdhsa_kernel recurrent_scan__linear_attn_block__mixer_channel_mlp__prompt_kernel
  .amdhsa_next_free_vgpr 512
  .amdhsa_next_free_sgpr 102
  .amdhsa_accum_offset 256
  .amdhsa_group_segment_fixed_size 0
  .amdhsa_kernarg_size 88
  .amdhsa_user_sgpr_count 2
  .amdhsa_user_sgpr_kernarg_segment_ptr 1
  .amdhsa_system_sgpr_workgroup_id_x 1
  .amdhsa_float_denorm_mode_32 3
.end_amdhsa_kernel
```
